```python
import torch

def _softmax(x, axis=-1):
    return torch.softmax(x, dim=axis)
def _gelu(x):
    return torch.nn.functional.gelu(x, approximate="tanh")
def _silu(x):
    return torch.nn.functional.silu(x)
def _sigmoid(x):
    return torch.sigmoid(x)
def _layernorm(x, axis=-1, eps=1e-5):
    m = x.mean(dim=axis, keepdim=True)
    v = x.var(dim=axis, keepdim=True, unbiased=False)
    return (x - m) / torch.sqrt(v + eps)
def _scatter_add(tgt, idx, src, axis=0):
    return tgt.clone().index_add_(axis, idx, src)
def _segment_sum(src, seg, n):
    out = torch.zeros((n,) + src.shape[1:], dtype=src.dtype)
    return out.index_add_(0, seg, src)
def _pad(x, pw):
    flat = tuple(v for pair in reversed(pw) for v in pair)
    return torch.nn.functional.pad(x, flat)

kernel_name = 'parallel_sum__softmax_full_mha__dense_activation_relu__prompt'

def setup_inputs():

    _w = (lambda a: (lambda t: t.to(torch.bfloat16) if t.is_floating_point() else t)(torch.as_tensor(a)))
    def _A_setup():
        B, S, D = 1, 2048, 1024
        return {
            "x": _w((lambda *s: torch.randn(*s, dtype=torch.bfloat16) * 0.05)(B, S, D)),
            "wqkv": _w((lambda *s: torch.randn(*s, dtype=torch.bfloat16) * 0.05)(D, 3 * D)),
            "wo": _w((lambda *s: torch.randn(*s, dtype=torch.bfloat16) * 0.05)(D, D)),
        }
    _A_in = _A_setup()

    def _B_setup():
        B, S, D, Dff = 1, 2048, 1024, 3584
        return {
            "x": _w((lambda *s: torch.randn(*s, dtype=torch.bfloat16) * 0.05)(B, S, D)),
            "w1": _w((lambda *s: torch.randn(*s, dtype=torch.bfloat16) * 0.05)(D, Dff)),
            "w2": _w((lambda *s: torch.randn(*s, dtype=torch.bfloat16) * 0.05)(Dff, D)),
        }
    _B_in = _B_setup()

    return {
        "A_x": _A_in["x"],
        "A_wqkv": _A_in["wqkv"],
        "A_wo": _A_in["wo"],
        "B_x": _B_in["x"],
        "B_w1": _B_in["w1"],
        "B_w2": _B_in["w2"],
    }

def reference(A_x, A_wqkv, A_wo, B_x, B_w1, B_w2):
    def _A_ref(x, wqkv, wo):
        B, S, D = x.shape
        H = 32; Dh = D // H
        qkv = (lambda x, *d: x.permute(*d))((x @ wqkv).reshape(B, S, 3, H, Dh), 2, 0, 3, 1, 4)
        q, k, v = qkv[0], qkv[1], qkv[2]
        scale = Dh ** -0.5
        scores = torch.einsum("bhqd,bhkd->bhqk", q, k) * scale
        p = _softmax(scores, axis=-1)
        o = torch.einsum("bhqk,bhkd->bhqd", p, v)
        return (lambda x, *d: x.permute(*d))(o, 0, 2, 1, 3).reshape(B, S, D) @ wo

    def _B_ref(x, w1, w2):
        h = torch.einsum("bsd,df->bsf", x, w1)
        zero = torch.zeros_like(h)
        h = torch.maximum(h, zero)
        return torch.einsum("bsf,fd->bsd", h, w2)

    x = A_x
    xn = _layernorm(x, axis=-1)
    return x + _A_ref(xn, A_wqkv, A_wo) + _B_ref(xn, B_w1, B_w2)
```

```asm
; @launch grid=(256,1,1) block=(256,1,1) lds=163840
.amdgcn_target "amdgcn-amd-amdhsa--gfx950"
.text
.globl parallel_sum__softmax_full_mha__dense_activation_relu__prompt_kernel
.p2align 8
.type parallel_sum__softmax_full_mha__dense_activation_relu__prompt_kernel,@function
parallel_sum__softmax_full_mha__dense_activation_relu__prompt_kernel:
    s_cmp_ge_u32 s2, 256
    s_cbranch_scc1 L_end
    s_load_dwordx2 s[34:35], s[0:1], 0
    s_load_dwordx2 s[6:7], s[0:1], 8
    s_load_dwordx4 s[28:31], s[0:1], 32
    s_load_dwordx2 s[4:5], s[0:1], 64
    s_load_dwordx2 s[32:33], s[0:1], 16
    s_load_dwordx4 s[36:39], s[0:1], 48
    s_memrealtime s[92:93]
    v_lshrrev_b32 v238, 6, v0
    v_and_b32 v250, 63, v0
    v_readfirstlane_b32 s40, v238
    v_lshlrev_b32 v251, 4, v250
    s_and_b32 s41, s2, 7
    s_lshr_b32 s42, s2, 3
    s_and_b32 s50, s42, 7
    s_lshr_b32 s51, s42, 3
    s_lshr_b32 s48, s40, 1
    s_and_b32 s49, s40, 1
    v_bfe_u32 v3, v250, 2, 1
    v_lshl_add_u32 v3, v238, 1, v3
    s_lshl_b32 s52, s2, 3
    v_add_u32 v3, s52, v3
    v_and_b32 v4, 3, v250
    v_lshrrev_b32 v5, 3, v250
    v_lshlrev_b32 v6, 11, v3
    v_lshl_add_u32 v6, v5, 6, v6
    v_lshl_add_u32 v6, v4, 4, v6
    v_lshrrev_b32 v239, 4, v250
    v_and_b32 v240, 7, v250
    v_xor_b32 v240, v240, v239
    v_lshlrev_b32 v240, 4, v240
    v_lshl_add_u32 v240, v5, 11, v240
    s_lshl_b32 s52, s50, 19
    s_lshl_b32 s53, s40, 17
    s_add_u32 s52, s52, s53
    v_add_u32 v224, s52, v240
    v_xor_b32 v225, 64, v224
    v_add_u32 v227, 46080, v225
    v_add_u32 v225, 15360, v225
    v_add_u32 v226, 30720, v224
    s_lshl_b32 s45, s40, 13
    s_lshl_b32 s46, s40, 12
    s_add_u32 s46, s46, 98304
    s_and_b32 s47, s50, 7
    s_mul_i32 s47, s47, 1
    s_lshl_b32 s43, s47, 8
    v_lshrrev_b32 v241, 5, v250
    v_bfe_u32 v242, v250, 4, 1
    v_bfe_u32 v243, v250, 2, 2
    s_lshl_b32 s52, s48, 4
    s_lshl_b32 s53, s49, 2
    s_add_u32 s52, s52, s53
    v_lshl_add_u32 v244, v242, 3, v243
    v_add_u32 v244, s52, v244
    v_lshlrev_b32 v245, 1, v242
    v_xor_b32 v245, v245, v4
    v_lshlrev_b32 v245, 4, v245
    v_lshl_add_u32 v245, v241, 6, v245
    v_xor_b32 v246, v242, v4
    v_lshlrev_b32 v246, 4, v246
    s_cmp_lt_u32 s51, 2
    s_cbranch_scc0 L_g1_qkv
    s_mul_i32 s52, s41, 896
    s_mul_i32 s53, s51, 384
    s_add_u32 s53, s53, s52
    s_lshl_b32 s54, s51, 6
    s_add_u32 s54, s54, s52
    s_add_u32 s54, s54, 1792
    s_mul_i32 s44, s47, 917504
    v_mul_u32_u24 v244, 7168, v244
    v_add3_u32 v245, v245, v244, s53
    v_add_u32 v228, 4096, v245
    v_add_u32 v229, 3200, v245
    v_add_u32 v230, 2304, v245
    v_add3_u32 v246, v246, v244, s54
    v_lshlrev_b32 v247, 30, v241
    v_or_b32 v231, v246, v247
    v_mov_b32 v12, 0
    v_mov_b32 v13, 0
    v_mov_b32 v14, 0
    v_mov_b32 v15, 0
    s_mov_b32 s23, 0x00020000
    s_mov_b32 s19, 0x00020000
    s_mov_b32 s15, 0x00020000
    s_mov_b32 s22, 4194304
    s_mov_b32 s18, 4128768
    s_mov_b32 s14, 7344128
    s_waitcnt lgkmcnt(0)
    s_mov_b32 s20, s34
    s_mov_b32 s21, s35
    s_add_u32 m0, s45, 0
    s_nop 0
    buffer_load_dwordx4 v224, s[20:23], s43 offen offset:0  lds
    v_mfma_f32_32x32x16_bf16 a[128:143], v[12:15], v[12:15], 0
    buffer_load_dwordx4 v225, s[20:23], s43 offen offset:1024  lds
    v_mfma_f32_32x32x16_bf16 a[144:159], v[12:15], v[12:15], 0
    buffer_load_dwordx4 v226, s[20:23], s43 offen offset:2048  lds
    v_mfma_f32_32x32x16_bf16 a[176:191], v[12:15], v[12:15], 0
    buffer_load_dwordx4 v227, s[20:23], s43 offen offset:3072  lds
    v_mfma_f32_32x32x16_bf16 a[192:207], v[12:15], v[12:15], 0
    s_sub_u32 s12, s28, 4096
    s_subb_u32 s13, s29, 0
    s_add_u32 m0, s46, 0
    s_nop 0
    buffer_load_dwordx4 v228, s[12:15], s44 offen offset:0  lds
    v_mfma_f32_32x32x16_bf16 a[208:223], v[12:15], v[12:15], 0
    buffer_load_dwordx4 v229, s[12:15], s44 offen offset:1024  lds
    v_mfma_f32_32x32x16_bf16 a[224:239], v[12:15], v[12:15], 0
    buffer_load_dwordx4 v230, s[12:15], s44 offen offset:2048  lds
    v_mfma_f32_32x32x16_bf16 a[240:255], v[12:15], v[12:15], 0
    buffer_load_dwordx4 v231, s[12:15], s44 offen offset:3072  lds
    v_mfma_f32_32x32x16_bf16 v[16:31], v[12:15], v[12:15], 0
    s_add_u32 s44, s44, 229376
    s_add_u32 s16, s34, 65536
    s_addc_u32 s17, s35, 0
    s_add_u32 m0, s45, 4096
    s_nop 0
    buffer_load_dwordx4 v224, s[16:19], s43 offen offset:0  lds
    v_mfma_f32_32x32x16_bf16 v[32:47], v[12:15], v[12:15], 0
    buffer_load_dwordx4 v225, s[16:19], s43 offen offset:1024  lds
    v_mfma_f32_32x32x16_bf16 v[48:63], v[12:15], v[12:15], 0
    buffer_load_dwordx4 v226, s[16:19], s43 offen offset:2048  lds
    v_mfma_f32_32x32x16_bf16 v[64:79], v[12:15], v[12:15], 0
    buffer_load_dwordx4 v227, s[16:19], s43 offen offset:3072  lds
    v_mfma_f32_32x32x16_bf16 v[80:95], v[12:15], v[12:15], 0
    s_add_u32 s43, s43, 128
    s_add_u32 s88, s38, 248
    s_addc_u32 s89, s39, 0
    s_mov_b32 s90, 8
    s_mov_b32 s91, 0x00020000
    s_or_b32 s52, s2, s40
    s_cbranch_scc1 L_nonon_ffn
    s_or_b32 s92, s92, 1
    v_mov_b32 v8, s92
    v_mov_b32 v9, s93
    buffer_store_dwordx2 v[8:9], off, s[88:91], 0 sc1
L_nonon_ffn:
    s_add_u32 s8, s4, 0
    s_addc_u32 s9, s5, 0
    s_add_u32 m0, s46, 16384
    s_mov_b32 s10, 36700160
    s_mov_b32 s11, 0x00020000
    v_and_b32 v247, 15, v250
    v_mfma_f32_32x32x16_bf16 v[96:111], v[12:15], v[12:15], 0
    v_lshrrev_b32 v248, 1, v247
    v_xor_b32 v248, v248, v239
    v_lshlrev_b32 v248, 4, v248
    v_lshl_add_u32 v248, v247, 7, v248
    s_lshl_b32 s52, s48, 14
    v_mfma_f32_32x32x16_bf16 v[112:127], v[12:15], v[12:15], 0
    v_add_u32 v234, s52, v248
    v_mov_b32 v232, v234
    buffer_load_dwordx4 v228, s[12:15], s44 offen offset:0  lds
    v_xor_b32 v233, 64, v234
    s_mov_b32 s97, 0
    v_lshlrev_b32 v248, 13, v241
    v_mfma_f32_32x32x16_bf16 v[128:143], v[12:15], v[12:15], 0
    v_lshl_add_u32 v248, v242, 8, v248
    v_lshl_add_u32 v248, v243, 6, v248
    v_add_u32 v248, 98304, v248
    v_lshl_add_u32 v249, v242, 5, v248
    v_lshl_add_u32 v249, v4, 3, v249
    v_mfma_f32_32x32x16_bf16 v[144:159], v[12:15], v[12:15], 0
    s_mul_i32 s52, s49, 1536
    v_add_u32 v235, s52, v249
    v_xor_b32 v236, 32, v235
    buffer_load_dwordx4 v229, s[12:15], s44 offen offset:1024  lds
    v_and_b32 v249, 1, v4
    v_lshlrev_b32 v249, 1, v249
    v_mfma_f32_32x32x16_bf16 v[160:175], v[12:15], v[12:15], 0
    v_add_u32 v249, s49, v249
    v_xor_b32 v249, v249, v242
    v_lshl_add_u32 v249, v249, 4, v248
    v_lshrrev_b32 v248, 1, v4
    v_lshl_add_u32 v237, v248, 3, v249
    v_mfma_f32_32x32x16_bf16 v[176:191], v[12:15], v[12:15], 0
    v_mov_b32 v248, 0x3f803f80
    v_accvgpr_write_b32 a124, v248
    v_accvgpr_write_b32 a125, v248
    v_accvgpr_write_b32 a126, v248
    buffer_load_dwordx4 v230, s[12:15], s44 offen offset:2048  lds
    v_accvgpr_write_b32 a127, v248
    v_mfma_f32_32x32x16_bf16 v[192:207], v[12:15], v[12:15], 0
    s_lshl_b32 s101, s41, 2
    s_add_u32 s101, s101, s51
    s_and_b32 s52, s51, 1
    s_lshl_b32 s52, s52, 1
    s_lshl_b32 s100, s41, 2
    v_mfma_f32_32x32x16_bf16 v[208:223], v[12:15], v[12:15], 0
    s_add_u32 s100, s100, s52
    s_add_u32 s100, s100, 1
    s_lshl_b32 s52, s50, 2
    s_add_u32 s52, s52, s40
    s_lshl_b32 s52, s52, 12
    s_lshl_b32 s53, s100, 17
    buffer_load_dwordx4 v231, s[12:15], s44 offen offset:3072  lds
    s_add_u32 s99, s52, s53
    s_add_u32 s99, s99, 4194304
    s_lshl_b32 s94, s50, 15
    s_lshl_b32 s95, s40, 12
    v_add_u32 v252, s95, v251
    s_lshr_b32 s52, s100, 1
    s_lshl_b32 s52, s52, 7
    v_and_b32 v253, 7, v250
    v_lshl_add_u32 v253, v253, 3, s52
    s_add_u32 s24, s30, 0
    s_addc_u32 s25, s31, 0
    s_add_u32 s44, s44, 229376
    s_mov_b32 s26, 7340032
    s_mov_b32 s27, 0x00020000
    s_lshl_b32 s58, s2, 2
    s_add_u32 s58, s58, s40
    s_lshl_b32 s58, s58, 10
    v_and_b32 v246, 0x3b, v250
    v_min_u32 v246, 1, v246
    v_lshlrev_b32 v246, 30, v246
    v_lshl_add_u32 v246, v3, 2, v246
    v_mov_b32 v241, 0
    v_mov_b32 v242, 0
    v_mov_b32 v247, v6
    s_lshl_b32 s52, s41, 1
    s_add_u32 s52, s52, s51
    s_lshl_b32 s52, s52, 3
    s_lshl_b32 s53, s50, 7
    s_add_u32 s52, s52, s53
    s_add_u32 s92, s52, 2048
    s_lshl_b32 s52, s50, 8
    s_lshl_b32 s93, s100, 3
    s_add_u32 s93, s93, s52
    s_add_u32 s93, s93, 4096
    s_getpc_b64 s[52:53]
L_pc_0:
    s_sub_u32 s52, s52, L_pc_0-parallel_sum__softmax_full_mha__dense_activation_relu__prompt_kernel
    s_subb_u32 s53, s53, 0
    s_lshl_b32 s54, s42, 2
    s_add_u32 s54, s54, s40
    s_and_b32 s54, s54, 63
    s_lshl_b32 s54, s54, 10
    v_add_u32 v254, s54, v251
    v_min_u32 v254, L_code_end-parallel_sum__softmax_full_mha__dense_activation_relu__prompt_kernel-16, v254
    v_mov_b32 v255, s53
    v_add_co_u32 v254, vcc, s52, v254
    s_nop 1
    v_addc_co_u32 v255, vcc, 0, v255, vcc
    s_nop 1
    v_mfma_f32_32x32x16_bf16 v[0:15], a[128:131], a[128:131], 0
    s_waitcnt vmcnt(4)
    s_barrier
    ds_read_b64_tr_b16 a[32:33], v235 offset:0
    ds_read_b64_tr_b16 a[34:35], v235 offset:4096
    ds_read_b128 a[0:3], v232 offset:0
    ds_read_b128 a[4:7], v232 offset:2048
    ds_read_b128 a[8:11], v232 offset:4096
    ds_read_b128 a[12:15], v232 offset:6144
    ds_read_b128 a[16:19], v232 offset:8192
    ds_read_b128 a[20:23], v232 offset:10240
    ds_read_b128 a[24:27], v232 offset:12288
    ds_read_b128 a[28:31], v232 offset:14336
    ds_read_b64_tr_b16 a[36:37], v236 offset:0
    ds_read_b64_tr_b16 a[38:39], v236 offset:4096
    ds_read_b64_tr_b16 a[40:41], v235 offset:512
    ds_read_b64_tr_b16 a[42:43], v235 offset:4608
    ds_read_b64_tr_b16 a[44:45], v236 offset:512
    ds_read_b64_tr_b16 a[46:47], v236 offset:4608
    ds_read_b64_tr_b16 a[48:49], v235 offset:1024
    ds_read_b64_tr_b16 a[50:51], v235 offset:5120
    ds_read_b64_tr_b16 a[52:53], v236 offset:1024
    ds_read_b64_tr_b16 a[54:55], v236 offset:5120
    ds_read_b64_tr_b16 a[56:57], v237 offset:3072
    ds_read_b64_tr_b16 a[58:59], v237 offset:7168
    s_waitcnt lgkmcnt(0)
    v_mfma_f32_16x16x32_bf16 a[128:131], a[32:35], a[124:127], a[128:131]
    s_add_u32 m0, s46, 32768
    v_mfma_f32_16x16x32_bf16 a[132:135], a[36:39], a[124:127], a[132:135]
    buffer_load_dwordx4 v228, s[12:15], s44 offen offset:0  lds
    v_mfma_f32_16x16x32_bf16 a[136:139], a[40:43], a[124:127], a[136:139]
    ds_read_b128 a[60:63], v233 offset:0
    v_mfma_f32_16x16x32_bf16 a[140:143], a[44:47], a[124:127], a[140:143]
    buffer_load_dwordx4 v229, s[12:15], s44 offen offset:1024  lds
    v_mfma_f32_16x16x32_bf16 a[144:147], a[48:51], a[124:127], a[144:147]
    buffer_load_dwordx4 v230, s[12:15], s44 offen offset:2048  lds
    v_mfma_f32_16x16x32_bf16 a[148:151], a[52:55], a[124:127], a[148:151]
    ds_read_b128 a[64:67], v233 offset:2048
    v_mfma_f32_16x16x32_bf16 a[152:155], a[56:59], a[124:127], a[152:155]
    buffer_load_dwordx4 v231, s[12:15], s44 offen offset:3072  lds
    v_mfma_f32_16x16x32_bf16 v[0:3], a[32:35], a[0:3], v[0:3]
    v_mfma_f32_16x16x32_bf16 v[4:7], a[32:35], a[4:7], v[4:7]
    s_add_u32 s44, s44, 229376
    ds_read_b128 a[68:71], v233 offset:4096
    v_mfma_f32_16x16x32_bf16 v[8:11], a[32:35], a[8:11], v[8:11]
    s_add_u32 m0, s45, 32768
    v_mfma_f32_16x16x32_bf16 v[12:15], a[32:35], a[12:15], v[12:15]
    v_mfma_f32_16x16x32_bf16 v[16:19], a[32:35], a[16:19], v[16:19]
    buffer_load_dwordx4 v224, s[20:23], s43 offen offset:0  lds
    ds_read_b128 a[72:75], v233 offset:6144
    v_mfma_f32_16x16x32_bf16 v[20:23], a[32:35], a[20:23], v[20:23]
    buffer_load_dwordx4 v225, s[20:23], s43 offen offset:1024  lds
    v_mfma_f32_16x16x32_bf16 v[24:27], a[32:35], a[24:27], v[24:27]
    v_mfma_f32_16x16x32_bf16 v[28:31], a[32:35], a[28:31], v[28:31]
    buffer_load_dwordx4 v226, s[20:23], s43 offen offset:2048  lds
    ds_read_b128 a[76:79], v233 offset:8192
    v_mfma_f32_16x16x32_bf16 v[60:63], a[36:39], a[28:31], v[60:63]
    v_mfma_f32_16x16x32_bf16 v[56:59], a[36:39], a[24:27], v[56:59]
    buffer_load_dwordx4 v227, s[20:23], s43 offen offset:3072  lds
    v_mfma_f32_16x16x32_bf16 v[52:55], a[36:39], a[20:23], v[52:55]
    s_add_u32 m0, s45, 36864
    ds_read_b128 a[80:83], v233 offset:10240
    v_mfma_f32_16x16x32_bf16 v[48:51], a[36:39], a[16:19], v[48:51]
    v_mfma_f32_16x16x32_bf16 v[44:47], a[36:39], a[12:15], v[44:47]
    buffer_load_dwordx4 v224, s[16:19], s43 offen offset:0  lds
    v_mfma_f32_16x16x32_bf16 v[40:43], a[36:39], a[8:11], v[40:43]
    buffer_load_dwordx4 v225, s[16:19], s43 offen offset:1024  lds
    ds_read_b128 a[84:87], v233 offset:12288
    v_mfma_f32_16x16x32_bf16 v[36:39], a[36:39], a[4:7], v[36:39]
    v_mfma_f32_16x16x32_bf16 v[32:35], a[36:39], a[0:3], v[32:35]
    buffer_load_dwordx4 v226, s[16:19], s43 offen offset:2048  lds
    v_mfma_f32_16x16x32_bf16 v[64:67], a[40:43], a[0:3], v[64:67]
    ds_read_b128 a[88:91], v233 offset:14336
    v_mfma_f32_16x16x32_bf16 v[68:71], a[40:43], a[4:7], v[68:71]
    buffer_load_dwordx4 v227, s[16:19], s43 offen offset:3072  lds
    v_mfma_f32_16x16x32_bf16 v[72:75], a[40:43], a[8:11], v[72:75]
    s_add_u32 s43, s43, 128
    v_mfma_f32_16x16x32_bf16 v[76:79], a[40:43], a[12:15], v[76:79]
    v_mfma_f32_16x16x32_bf16 v[80:83], a[40:43], a[16:19], v[80:83]
    s_and_b32 s43, s43, 2047
    v_mfma_f32_16x16x32_bf16 v[84:87], a[40:43], a[20:23], v[84:87]
    v_mfma_f32_16x16x32_bf16 v[88:91], a[40:43], a[24:27], v[88:91]
    v_mfma_f32_16x16x32_bf16 v[92:95], a[40:43], a[28:31], v[92:95]
    s_waitcnt vmcnt(12)
    s_barrier
    v_mfma_f32_16x16x32_bf16 v[124:127], a[44:47], a[28:31], v[124:127]
    global_load_dwordx4 a[120:123], v[254:255], off
    ds_read_b64_tr_b16 a[92:93], v235 offset:16384
    v_mfma_f32_16x16x32_bf16 v[120:123], a[44:47], a[24:27], v[120:123]
    buffer_load_dwordx4 a[160:163], v247, s[20:23], 0 offen offset:0
    ds_read_b64_tr_b16 a[94:95], v235 offset:20480
    v_mfma_f32_16x16x32_bf16 v[116:119], a[44:47], a[20:23], v[116:119]
    v_mfma_f32_16x16x32_bf16 v[112:115], a[44:47], a[16:19], v[112:115]
    buffer_load_dwordx4 a[164:167], v247, s[20:23], 0 offen offset:512
    ds_read_b64_tr_b16 a[96:97], v236 offset:16384
    v_mfma_f32_16x16x32_bf16 v[108:111], a[44:47], a[12:15], v[108:111]
    ds_read_b64_tr_b16 a[98:99], v236 offset:20480
    v_mfma_f32_16x16x32_bf16 v[104:107], a[44:47], a[8:11], v[104:107]
    buffer_load_dwordx4 a[168:171], v247, s[20:23], 0 offen offset:1024
    v_mfma_f32_16x16x32_bf16 v[100:103], a[44:47], a[4:7], v[100:103]
    ds_read_b64_tr_b16 a[100:101], v235 offset:16896
    v_mfma_f32_16x16x32_bf16 v[96:99], a[44:47], a[0:3], v[96:99]
    buffer_load_dwordx4 a[172:175], v247, s[20:23], 0 offen offset:1536
    ds_read_b64_tr_b16 a[102:103], v235 offset:20992
    v_mfma_f32_16x16x32_bf16 v[128:131], a[48:51], a[0:3], v[128:131]
    s_add_u32 m0, s46, 49152
    v_mfma_f32_16x16x32_bf16 v[132:135], a[48:51], a[4:7], v[132:135]
    ds_read_b64_tr_b16 a[104:105], v236 offset:16896
    v_mfma_f32_16x16x32_bf16 v[136:139], a[48:51], a[8:11], v[136:139]
    buffer_load_dwordx4 v228, s[12:15], s44 offen offset:0  lds
    ds_read_b64_tr_b16 a[106:107], v236 offset:20992
    v_mfma_f32_16x16x32_bf16 v[140:143], a[48:51], a[12:15], v[140:143]
    v_mfma_f32_16x16x32_bf16 v[144:147], a[48:51], a[16:19], v[144:147]
    buffer_load_dwordx4 v229, s[12:15], s44 offen offset:1024  lds
    ds_read_b64_tr_b16 a[108:109], v235 offset:17408
    v_mfma_f32_16x16x32_bf16 v[148:151], a[48:51], a[20:23], v[148:151]
    ds_read_b64_tr_b16 a[110:111], v235 offset:21504
    v_mfma_f32_16x16x32_bf16 v[152:155], a[48:51], a[24:27], v[152:155]
    buffer_load_dwordx4 v230, s[12:15], s44 offen offset:2048  lds
    v_mfma_f32_16x16x32_bf16 v[156:159], a[48:51], a[28:31], v[156:159]
    buffer_load_dwordx4 v231, s[12:15], s44 offen offset:3072  lds
    ds_read_b64_tr_b16 a[112:113], v236 offset:17408
    v_mfma_f32_16x16x32_bf16 v[188:191], a[52:55], a[28:31], v[188:191]
    ds_read_b64_tr_b16 a[114:115], v236 offset:21504
    v_mfma_f32_16x16x32_bf16 v[184:187], a[52:55], a[24:27], v[184:187]
    s_add_u32 s44, s44, 229376
    v_mfma_f32_16x16x32_bf16 v[180:183], a[52:55], a[20:23], v[180:183]
    ds_read_b64_tr_b16 a[116:117], v237 offset:19456
    v_mfma_f32_16x16x32_bf16 v[176:179], a[52:55], a[16:19], v[176:179]
    s_cmp_eq_u32 s44, 7340032
    s_cselect_b32 s44, 0, s44
    ds_read_b64_tr_b16 a[118:119], v237 offset:23552
    v_mfma_f32_16x16x32_bf16 v[172:175], a[52:55], a[12:15], v[172:175]
    v_mfma_f32_16x16x32_bf16 v[168:171], a[52:55], a[8:11], v[168:171]
    s_add_u32 s96, s97, s45
    v_mfma_f32_16x16x32_bf16 v[164:167], a[52:55], a[4:7], v[164:167]
    s_add_u32 s97, s97, 32768
    v_mfma_f32_16x16x32_bf16 v[160:163], a[52:55], a[0:3], v[160:163]
    v_mfma_f32_16x16x32_bf16 v[192:195], a[56:59], a[0:3], v[192:195]
    s_cmp_eq_u32 s97, 98304
    s_cselect_b32 s97, 0, s97
    v_mfma_f32_16x16x32_bf16 v[196:199], a[56:59], a[4:7], v[196:199]
    v_mfma_f32_16x16x32_bf16 v[200:203], a[56:59], a[8:11], v[200:203]
    v_add_u32 v232, s97, v234
    v_mfma_f32_16x16x32_bf16 v[204:207], a[56:59], a[12:15], v[204:207]
    v_mfma_f32_16x16x32_bf16 v[208:211], a[56:59], a[16:19], v[208:211]
    v_xor_b32 v233, 64, v232
    v_mfma_f32_16x16x32_bf16 v[212:215], a[56:59], a[20:23], v[212:215]
    v_mfma_f32_16x16x32_bf16 v[216:219], a[56:59], a[24:27], v[216:219]
    v_mfma_f32_16x16x32_bf16 v[220:223], a[56:59], a[28:31], v[220:223]
    s_waitcnt vmcnt(9) lgkmcnt(0)
    s_barrier
    v_mfma_f32_16x16x32_bf16 a[128:131], a[92:95], a[124:127], a[128:131]
    s_add_u32 m0, s45, 65536
    ds_read_b64_tr_b16 a[32:33], v235 offset:32768
    v_mfma_f32_16x16x32_bf16 a[132:135], a[96:99], a[124:127], a[132:135]
    v_mfma_f32_16x16x32_bf16 a[136:139], a[100:103], a[124:127], a[136:139]
    buffer_load_dwordx4 v224, s[20:23], s43 offen offset:0  lds
    ds_read_b64_tr_b16 a[34:35], v235 offset:36864
    v_mfma_f32_16x16x32_bf16 a[140:143], a[104:107], a[124:127], a[140:143]
    v_mfma_f32_16x16x32_bf16 a[144:147], a[108:111], a[124:127], a[144:147]
    buffer_load_dwordx4 v225, s[20:23], s43 offen offset:1024  lds
    ds_read_b128 a[0:3], v232 offset:0
    v_mfma_f32_16x16x32_bf16 a[148:151], a[112:115], a[124:127], a[148:151]
    v_mfma_f32_16x16x32_bf16 a[152:155], a[116:119], a[124:127], a[152:155]
    buffer_load_dwordx4 v226, s[20:23], s43 offen offset:2048  lds
    ds_read_b128 a[4:7], v232 offset:2048
    v_mfma_f32_16x16x32_bf16 v[0:3], a[92:95], a[60:63], v[0:3]
    v_mfma_f32_16x16x32_bf16 v[4:7], a[92:95], a[64:67], v[4:7]
    ds_read_b128 a[8:11], v232 offset:4096
    v_mfma_f32_16x16x32_bf16 v[8:11], a[92:95], a[68:71], v[8:11]
    buffer_load_dwordx4 v227, s[20:23], s43 offen offset:3072  lds
    v_mfma_f32_16x16x32_bf16 v[12:15], a[92:95], a[72:75], v[12:15]
    ds_read_b128 a[12:15], v232 offset:6144
    v_mfma_f32_16x16x32_bf16 v[16:19], a[92:95], a[76:79], v[16:19]
    s_add_u32 m0, s45, 69632
    v_mfma_f32_16x16x32_bf16 v[20:23], a[92:95], a[80:83], v[20:23]
    ds_read_b128 a[16:19], v232 offset:8192
    v_mfma_f32_16x16x32_bf16 v[24:27], a[92:95], a[84:87], v[24:27]
    buffer_load_dwordx4 v224, s[16:19], s43 offen offset:0  lds
    v_mfma_f32_16x16x32_bf16 v[28:31], a[92:95], a[88:91], v[28:31]
    ds_read_b128 a[20:23], v232 offset:10240
    v_mfma_f32_16x16x32_bf16 v[60:63], a[96:99], a[88:91], v[60:63]
    v_mfma_f32_16x16x32_bf16 v[56:59], a[96:99], a[84:87], v[56:59]
    buffer_load_dwordx4 v225, s[16:19], s43 offen offset:1024  lds
    v_mfma_f32_16x16x32_bf16 v[52:55], a[96:99], a[80:83], v[52:55]
    ds_read_b128 a[24:27], v232 offset:12288
    v_mfma_f32_16x16x32_bf16 v[48:51], a[96:99], a[76:79], v[48:51]
    buffer_load_dwordx4 v226, s[16:19], s43 offen offset:2048  lds
    v_mfma_f32_16x16x32_bf16 v[44:47], a[96:99], a[72:75], v[44:47]
    ds_read_b128 a[28:31], v232 offset:14336
    v_mfma_f32_16x16x32_bf16 v[40:43], a[96:99], a[68:71], v[40:43]
    buffer_load_dwordx4 v227, s[16:19], s43 offen offset:3072  lds
    v_mfma_f32_16x16x32_bf16 v[36:39], a[96:99], a[64:67], v[36:39]
    ds_read_b64_tr_b16 a[36:37], v236 offset:32768
    v_mfma_f32_16x16x32_bf16 v[32:35], a[96:99], a[60:63], v[32:35]
    v_mfma_f32_16x16x32_bf16 v[64:67], a[100:103], a[60:63], v[64:67]
    s_add_u32 s43, s43, 128
    ds_read_b64_tr_b16 a[38:39], v236 offset:36864
    v_mfma_f32_16x16x32_bf16 v[68:71], a[100:103], a[64:67], v[68:71]
    v_mfma_f32_16x16x32_bf16 v[72:75], a[100:103], a[68:71], v[72:75]
    s_add_u32 m0, s46, 0
    ds_read_b64_tr_b16 a[40:41], v235 offset:33280
    v_mfma_f32_16x16x32_bf16 v[76:79], a[100:103], a[72:75], v[76:79]
    v_mfma_f32_16x16x32_bf16 v[80:83], a[100:103], a[76:79], v[80:83]
    buffer_load_dwordx4 v228, s[12:15], s44 offen offset:0  lds
    ds_read_b64_tr_b16 a[42:43], v235 offset:37376
    v_mfma_f32_16x16x32_bf16 v[84:87], a[100:103], a[80:83], v[84:87]
    v_mfma_f32_16x16x32_bf16 v[88:91], a[100:103], a[84:87], v[88:91]
    buffer_load_dwordx4 v229, s[12:15], s44 offen offset:1024  lds
    ds_read_b64_tr_b16 a[44:45], v236 offset:33280
    v_mfma_f32_16x16x32_bf16 v[92:95], a[100:103], a[88:91], v[92:95]
    v_mfma_f32_16x16x32_bf16 v[124:127], a[104:107], a[88:91], v[124:127]
    v_mfma_f32_16x16x32_bf16 v[120:123], a[104:107], a[84:87], v[120:123]
    buffer_load_dwordx4 v230, s[12:15], s44 offen offset:2048  lds
    ds_read_b64_tr_b16 a[46:47], v236 offset:37376
    v_mfma_f32_16x16x32_bf16 v[116:119], a[104:107], a[80:83], v[116:119]
    v_mfma_f32_16x16x32_bf16 v[112:115], a[104:107], a[76:79], v[112:115]
    buffer_load_dwordx4 v231, s[12:15], s44 offen offset:3072  lds
    ds_read_b64_tr_b16 a[48:49], v235 offset:33792
    v_mfma_f32_16x16x32_bf16 v[108:111], a[104:107], a[72:75], v[108:111]
    v_mfma_f32_16x16x32_bf16 v[104:107], a[104:107], a[68:71], v[104:107]
    s_add_u32 s44, s44, 229376
    ds_read_b64_tr_b16 a[50:51], v235 offset:37888
    v_mfma_f32_16x16x32_bf16 v[100:103], a[104:107], a[64:67], v[100:103]
    v_mfma_f32_16x16x32_bf16 v[96:99], a[104:107], a[60:63], v[96:99]
    ds_read_b64_tr_b16 a[52:53], v236 offset:33792
    v_mfma_f32_16x16x32_bf16 v[128:131], a[108:111], a[60:63], v[128:131]
    s_add_u32 m0, s46, 16384
    v_mfma_f32_16x16x32_bf16 v[132:135], a[108:111], a[64:67], v[132:135]
    ds_read_b64_tr_b16 a[54:55], v236 offset:37888
    v_mfma_f32_16x16x32_bf16 v[136:139], a[108:111], a[68:71], v[136:139]
    buffer_load_dwordx4 v228, s[12:15], s44 offen offset:0  lds
    v_mfma_f32_16x16x32_bf16 v[140:143], a[108:111], a[72:75], v[140:143]
    ds_read_b64_tr_b16 a[56:57], v237 offset:35840
    v_mfma_f32_16x16x32_bf16 v[144:147], a[108:111], a[76:79], v[144:147]
    buffer_load_dwordx4 v229, s[12:15], s44 offen offset:1024  lds
    v_mfma_f32_16x16x32_bf16 v[148:151], a[108:111], a[80:83], v[148:151]
    ds_read_b64_tr_b16 a[58:59], v237 offset:39936
    v_mfma_f32_16x16x32_bf16 v[152:155], a[108:111], a[84:87], v[152:155]
    v_mfma_f32_16x16x32_bf16 v[156:159], a[108:111], a[88:91], v[156:159]
    buffer_load_dwordx4 v230, s[12:15], s44 offen offset:2048  lds
    v_mfma_f32_16x16x32_bf16 v[188:191], a[112:115], a[88:91], v[188:191]
    v_mfma_f32_16x16x32_bf16 v[184:187], a[112:115], a[84:87], v[184:187]
    buffer_load_dwordx4 v231, s[12:15], s44 offen offset:3072  lds
    v_mfma_f32_16x16x32_bf16 v[180:183], a[112:115], a[80:83], v[180:183]
    v_mfma_f32_16x16x32_bf16 v[176:179], a[112:115], a[76:79], v[176:179]
    s_add_u32 s44, s44, 229376
    v_mfma_f32_16x16x32_bf16 v[172:175], a[112:115], a[72:75], v[172:175]
    v_mfma_f32_16x16x32_bf16 v[168:171], a[112:115], a[68:71], v[168:171]
    v_mfma_f32_16x16x32_bf16 v[164:167], a[112:115], a[64:67], v[164:167]
    v_mfma_f32_16x16x32_bf16 v[160:163], a[112:115], a[60:63], v[160:163]
    v_mfma_f32_16x16x32_bf16 v[192:195], a[116:119], a[60:63], v[192:195]
    v_mfma_f32_16x16x32_bf16 v[196:199], a[116:119], a[64:67], v[196:199]
    v_mfma_f32_16x16x32_bf16 v[200:203], a[116:119], a[68:71], v[200:203]
    v_mfma_f32_16x16x32_bf16 v[204:207], a[116:119], a[72:75], v[204:207]
    v_mfma_f32_16x16x32_bf16 v[208:211], a[116:119], a[76:79], v[208:211]
    v_mfma_f32_16x16x32_bf16 v[212:215], a[116:119], a[80:83], v[212:215]
    v_mfma_f32_16x16x32_bf16 v[216:219], a[116:119], a[84:87], v[216:219]
    v_mfma_f32_16x16x32_bf16 v[220:223], a[116:119], a[88:91], v[220:223]
    s_waitcnt vmcnt(20)
    v_accvgpr_read_b32 v244, a160
    v_dot2c_f32_bf16 v241, v244, v248
    v_dot2c_f32_bf16 v242, v244, v244
    v_accvgpr_read_b32 v245, a161
    v_dot2c_f32_bf16 v241, v245, v248
    v_dot2c_f32_bf16 v242, v245, v245
    v_accvgpr_read_b32 v244, a162
    v_dot2c_f32_bf16 v241, v244, v248
    v_dot2c_f32_bf16 v242, v244, v244
    v_accvgpr_read_b32 v245, a163
    v_dot2c_f32_bf16 v241, v245, v248
    v_dot2c_f32_bf16 v242, v245, v245
    v_accvgpr_read_b32 v244, a164
    v_dot2c_f32_bf16 v241, v244, v248
    v_dot2c_f32_bf16 v242, v244, v244
    v_accvgpr_read_b32 v245, a165
    v_dot2c_f32_bf16 v241, v245, v248
    v_dot2c_f32_bf16 v242, v245, v245
    v_accvgpr_read_b32 v244, a166
    v_dot2c_f32_bf16 v241, v244, v248
    v_dot2c_f32_bf16 v242, v244, v244
    v_accvgpr_read_b32 v245, a167
    v_dot2c_f32_bf16 v241, v245, v248
    v_dot2c_f32_bf16 v242, v245, v245
    v_accvgpr_read_b32 v244, a168
    v_dot2c_f32_bf16 v241, v244, v248
    v_dot2c_f32_bf16 v242, v244, v244
    v_accvgpr_read_b32 v245, a169
    v_dot2c_f32_bf16 v241, v245, v248
    v_dot2c_f32_bf16 v242, v245, v245
    v_accvgpr_read_b32 v244, a170
    v_dot2c_f32_bf16 v241, v244, v248
    v_dot2c_f32_bf16 v242, v244, v244
    v_accvgpr_read_b32 v245, a171
    v_dot2c_f32_bf16 v241, v245, v248
    v_dot2c_f32_bf16 v242, v245, v245
    v_accvgpr_read_b32 v244, a172
    v_dot2c_f32_bf16 v241, v244, v248
    v_dot2c_f32_bf16 v242, v244, v244
    v_accvgpr_read_b32 v245, a173
    v_dot2c_f32_bf16 v241, v245, v248
    v_dot2c_f32_bf16 v242, v245, v245
    v_accvgpr_read_b32 v244, a174
    v_dot2c_f32_bf16 v241, v244, v248
    v_dot2c_f32_bf16 v242, v244, v244
    v_accvgpr_read_b32 v245, a175
    v_dot2c_f32_bf16 v241, v245, v248
    v_dot2c_f32_bf16 v242, v245, v245
    s_nop 1
    s_nop 1
    v_add_f32_dpp v243, v241, v241 quad_perm:[1,0,3,2] row_mask:0xf bank_mask:0xf
    s_nop 1
    v_add_f32_dpp v241, v243, v243 quad_perm:[2,3,0,1] row_mask:0xf bank_mask:0xf
    s_nop 1
    v_add_f32_dpp v243, v241, v241 row_ror:8 row_mask:0xf bank_mask:0xf
    v_mov_b32 v241, v243
    s_nop 1
    v_permlane16_swap_b32 v243, v241
    v_add_f32 v241, v243, v241
    v_mov_b32 v243, v241
    s_nop 1
    v_permlane32_swap_b32 v243, v241
    v_add_f32 v241, v243, v241
    s_nop 1
    v_add_f32_dpp v243, v242, v242 quad_perm:[1,0,3,2] row_mask:0xf bank_mask:0xf
    s_nop 1
    v_add_f32_dpp v242, v243, v243 quad_perm:[2,3,0,1] row_mask:0xf bank_mask:0xf
    s_nop 1
    v_add_f32_dpp v243, v242, v242 row_ror:8 row_mask:0xf bank_mask:0xf
    v_mov_b32 v242, v243
    s_nop 1
    v_permlane16_swap_b32 v243, v242
    v_add_f32 v242, v243, v242
    v_mov_b32 v243, v242
    s_nop 1
    v_permlane32_swap_b32 v243, v242
    v_add_f32 v242, v243, v242
    v_mul_f32 v241, 0xba800000, v241
    v_mul_f32 v242, 0x3a800000, v242
    v_fma_f32 v242, -v241, v241, v242
    v_max_f32 v242, 0, v242
    v_cvt_pk_bf16_f32 v241, v241, v241
    v_and_b32 v241, 0xffff0000, v241
    v_cvt_pk_bf16_f32 v242, v242, v242
    v_and_b32 v242, 0xffff0000, v242
    v_add_f32 v242, 0x3727c5ac, v242
    v_cvt_pk_bf16_f32 v242, v242, v242
    v_and_b32 v242, 0xffff0000, v242
    v_sqrt_f32 v242, v242
    s_mov_b32 s54, 16384
    v_cvt_pk_bf16_f32 v242, v242, v242
    v_and_b32 v242, 0xffff0000, v242
    v_rcp_f32 v243, v242
    s_mov_b32 s55, 24576
    s_mov_b32 s56, 32768
    buffer_store_dword v241, v246, s[8:11], s54 offen sc1
    buffer_store_dword v243, v246, s[8:11], s55 offen sc1
    buffer_store_dword v242, v246, s[8:11], s56 offen sc1
    s_waitcnt vmcnt(19) lgkmcnt(0)
    s_barrier
    v_mfma_f32_16x16x32_bf16 a[128:131], a[32:35], a[124:127], a[128:131]
    s_add_u32 m0, s46, 32768
    ds_read_b64_tr_b16 a[92:93], v235 offset:49152
    v_mfma_f32_16x16x32_bf16 a[132:135], a[36:39], a[124:127], a[132:135]
    v_mfma_f32_16x16x32_bf16 a[136:139], a[40:43], a[124:127], a[136:139]
    buffer_load_dwordx4 v228, s[12:15], s44 offen offset:0  lds
    ds_read_b64_tr_b16 a[94:95], v235 offset:53248
    v_mfma_f32_16x16x32_bf16 a[140:143], a[44:47], a[124:127], a[140:143]
    v_mfma_f32_16x16x32_bf16 a[144:147], a[48:51], a[124:127], a[144:147]
    ds_read_b128 a[60:63], v233 offset:0
    v_mfma_f32_16x16x32_bf16 a[148:151], a[52:55], a[124:127], a[148:151]
    buffer_load_dwordx4 v229, s[12:15], s44 offen offset:1024  lds
    v_mfma_f32_16x16x32_bf16 a[152:155], a[56:59], a[124:127], a[152:155]
    ds_read_b128 a[64:67], v233 offset:2048
    v_mfma_f32_16x16x32_bf16 v[0:3], a[32:35], a[0:3], v[0:3]
    buffer_load_dwordx4 v230, s[12:15], s44 offen offset:2048  lds
    v_mfma_f32_16x16x32_bf16 v[4:7], a[32:35], a[4:7], v[4:7]
    ds_read_b128 a[68:71], v233 offset:4096
    v_mfma_f32_16x16x32_bf16 v[8:11], a[32:35], a[8:11], v[8:11]
    v_mfma_f32_16x16x32_bf16 v[12:15], a[32:35], a[12:15], v[12:15]
    buffer_load_dwordx4 v231, s[12:15], s44 offen offset:3072  lds
    ds_read_b128 a[72:75], v233 offset:6144
    v_mfma_f32_16x16x32_bf16 v[16:19], a[32:35], a[16:19], v[16:19]
    v_mfma_f32_16x16x32_bf16 v[20:23], a[32:35], a[20:23], v[20:23]
    ds_read_b128 a[76:79], v233 offset:8192
    v_mfma_f32_16x16x32_bf16 v[24:27], a[32:35], a[24:27], v[24:27]
    s_add_u32 s44, s44, 229376
    v_mfma_f32_16x16x32_bf16 v[28:31], a[32:35], a[28:31], v[28:31]
    ds_read_b128 a[80:83], v233 offset:10240
    v_mfma_f32_16x16x32_bf16 v[60:63], a[36:39], a[28:31], v[60:63]
    s_add_u32 m0, s96, 0
    v_mfma_f32_16x16x32_bf16 v[56:59], a[36:39], a[24:27], v[56:59]
    v_mfma_f32_16x16x32_bf16 v[52:55], a[36:39], a[20:23], v[52:55]
    ds_read_b128 a[84:87], v233 offset:12288
    v_mfma_f32_16x16x32_bf16 v[48:51], a[36:39], a[16:19], v[48:51]
    buffer_load_dwordx4 v224, s[20:23], s43 offen offset:0  lds
    v_mfma_f32_16x16x32_bf16 v[44:47], a[36:39], a[12:15], v[44:47]
    ds_read_b128 a[88:91], v233 offset:14336
    v_mfma_f32_16x16x32_bf16 v[40:43], a[36:39], a[8:11], v[40:43]
    buffer_load_dwordx4 v225, s[20:23], s43 offen offset:1024  lds
    v_mfma_f32_16x16x32_bf16 v[36:39], a[36:39], a[4:7], v[36:39]
    ds_read_b64_tr_b16 a[96:97], v236 offset:49152
    v_mfma_f32_16x16x32_bf16 v[32:35], a[36:39], a[0:3], v[32:35]
    v_mfma_f32_16x16x32_bf16 v[64:67], a[40:43], a[0:3], v[64:67]
    buffer_load_dwordx4 v226, s[20:23], s43 offen offset:2048  lds
    ds_read_b64_tr_b16 a[98:99], v236 offset:53248
    v_mfma_f32_16x16x32_bf16 v[68:71], a[40:43], a[4:7], v[68:71]
    v_mfma_f32_16x16x32_bf16 v[72:75], a[40:43], a[8:11], v[72:75]
    ds_read_b64_tr_b16 a[100:101], v235 offset:49664
    v_mfma_f32_16x16x32_bf16 v[76:79], a[40:43], a[12:15], v[76:79]
    buffer_load_dwordx4 v227, s[20:23], s43 offen offset:3072  lds
    v_mfma_f32_16x16x32_bf16 v[80:83], a[40:43], a[16:19], v[80:83]
    ds_read_b64_tr_b16 a[102:103], v235 offset:53760
    v_mfma_f32_16x16x32_bf16 v[84:87], a[40:43], a[20:23], v[84:87]
    s_add_u32 m0, s96, 4096
    v_mfma_f32_16x16x32_bf16 v[88:91], a[40:43], a[24:27], v[88:91]
    ds_read_b64_tr_b16 a[104:105], v236 offset:49664
    v_mfma_f32_16x16x32_bf16 v[92:95], a[40:43], a[28:31], v[92:95]
    v_mfma_f32_16x16x32_bf16 v[124:127], a[44:47], a[28:31], v[124:127]
    buffer_load_dwordx4 v224, s[16:19], s43 offen offset:0  lds
    v_mfma_f32_16x16x32_bf16 v[120:123], a[44:47], a[24:27], v[120:123]
    ds_read_b64_tr_b16 a[106:107], v236 offset:53760
    v_mfma_f32_16x16x32_bf16 v[116:119], a[44:47], a[20:23], v[116:119]
    buffer_load_dwordx4 v225, s[16:19], s43 offen offset:1024  lds
    v_mfma_f32_16x16x32_bf16 v[112:115], a[44:47], a[16:19], v[112:115]
    ds_read_b64_tr_b16 a[108:109], v235 offset:50176
    v_mfma_f32_16x16x32_bf16 v[108:111], a[44:47], a[12:15], v[108:111]
    v_mfma_f32_16x16x32_bf16 v[104:107], a[44:47], a[8:11], v[104:107]
    buffer_load_dwordx4 v226, s[16:19], s43 offen offset:2048  lds
    ds_read_b64_tr_b16 a[110:111], v235 offset:54272
    v_mfma_f32_16x16x32_bf16 v[100:103], a[44:47], a[4:7], v[100:103]
    v_mfma_f32_16x16x32_bf16 v[96:99], a[44:47], a[0:3], v[96:99]
    ds_read_b64_tr_b16 a[112:113], v236 offset:50176
    v_mfma_f32_16x16x32_bf16 v[128:131], a[48:51], a[0:3], v[128:131]
    buffer_load_dwordx4 v227, s[16:19], s43 offen offset:3072  lds
    v_mfma_f32_16x16x32_bf16 v[132:135], a[48:51], a[4:7], v[132:135]
    ds_read_b64_tr_b16 a[114:115], v236 offset:54272
    v_mfma_f32_16x16x32_bf16 v[136:139], a[48:51], a[8:11], v[136:139]
    s_add_u32 s43, s43, 128
    v_mfma_f32_16x16x32_bf16 v[140:143], a[48:51], a[12:15], v[140:143]
    ds_read_b64_tr_b16 a[116:117], v237 offset:52224
    v_mfma_f32_16x16x32_bf16 v[144:147], a[48:51], a[16:19], v[144:147]
    v_mfma_f32_16x16x32_bf16 v[148:151], a[48:51], a[20:23], v[148:151]
    s_and_b32 s43, s43, 2047
    ds_read_b64_tr_b16 a[118:119], v237 offset:56320
    v_mfma_f32_16x16x32_bf16 v[152:155], a[48:51], a[24:27], v[152:155]
    v_mfma_f32_16x16x32_bf16 v[156:159], a[48:51], a[28:31], v[156:159]
    v_mfma_f32_16x16x32_bf16 v[188:191], a[52:55], a[28:31], v[188:191]
    v_mfma_f32_16x16x32_bf16 v[184:187], a[52:55], a[24:27], v[184:187]
    v_mfma_f32_16x16x32_bf16 v[180:183], a[52:55], a[20:23], v[180:183]
    v_mfma_f32_16x16x32_bf16 v[176:179], a[52:55], a[16:19], v[176:179]
    v_mfma_f32_16x16x32_bf16 v[172:175], a[52:55], a[12:15], v[172:175]
    s_add_u32 s96, s97, s45
    v_mfma_f32_16x16x32_bf16 v[168:171], a[52:55], a[8:11], v[168:171]
    v_mfma_f32_16x16x32_bf16 v[164:167], a[52:55], a[4:7], v[164:167]
    s_add_u32 s97, s97, 32768
    v_mfma_f32_16x16x32_bf16 v[160:163], a[52:55], a[0:3], v[160:163]
    v_mfma_f32_16x16x32_bf16 v[192:195], a[56:59], a[0:3], v[192:195]
    s_cmp_eq_u32 s97, 98304
    s_cselect_b32 s97, 0, s97
    v_mfma_f32_16x16x32_bf16 v[196:199], a[56:59], a[4:7], v[196:199]
    v_mfma_f32_16x16x32_bf16 v[200:203], a[56:59], a[8:11], v[200:203]
    v_add_u32 v232, s97, v234
    v_mfma_f32_16x16x32_bf16 v[204:207], a[56:59], a[12:15], v[204:207]
    v_mfma_f32_16x16x32_bf16 v[208:211], a[56:59], a[16:19], v[208:211]
    v_xor_b32 v233, 64, v232
    v_mfma_f32_16x16x32_bf16 v[212:215], a[56:59], a[20:23], v[212:215]
    v_mfma_f32_16x16x32_bf16 v[216:219], a[56:59], a[24:27], v[216:219]
    v_mfma_f32_16x16x32_bf16 v[220:223], a[56:59], a[28:31], v[220:223]
    s_waitcnt vmcnt(19) lgkmcnt(0)
    s_barrier
    v_mfma_f32_16x16x32_bf16 a[128:131], a[92:95], a[124:127], a[128:131]
    s_add_u32 m0, s46, 49152
    ds_read_b64_tr_b16 a[32:33], v235 offset:0
    v_mfma_f32_16x16x32_bf16 a[132:135], a[96:99], a[124:127], a[132:135]
    v_mfma_f32_16x16x32_bf16 a[136:139], a[100:103], a[124:127], a[136:139]
    ds_read_b64_tr_b16 a[34:35], v235 offset:4096
    v_mfma_f32_16x16x32_bf16 a[140:143], a[104:107], a[124:127], a[140:143]
    buffer_load_dwordx4 v228, s[12:15], s44 offen offset:0  lds
    v_mfma_f32_16x16x32_bf16 a[144:147], a[108:111], a[124:127], a[144:147]
    ds_read_b128 a[0:3], v232 offset:0
    v_mfma_f32_16x16x32_bf16 a[148:151], a[112:115], a[124:127], a[148:151]
    v_mfma_f32_16x16x32_bf16 a[152:155], a[116:119], a[124:127], a[152:155]
    buffer_load_dwordx4 v229, s[12:15], s44 offen offset:1024  lds
    ds_read_b128 a[4:7], v232 offset:2048
    v_mfma_f32_16x16x32_bf16 v[0:3], a[92:95], a[60:63], v[0:3]
    v_mfma_f32_16x16x32_bf16 v[4:7], a[92:95], a[64:67], v[4:7]
    ds_read_b128 a[8:11], v232 offset:4096
    v_mfma_f32_16x16x32_bf16 v[8:11], a[92:95], a[68:71], v[8:11]
    buffer_load_dwordx4 v230, s[12:15], s44 offen offset:2048  lds
    v_mfma_f32_16x16x32_bf16 v[12:15], a[92:95], a[72:75], v[12:15]
    ds_read_b128 a[12:15], v232 offset:6144
    v_mfma_f32_16x16x32_bf16 v[16:19], a[92:95], a[76:79], v[16:19]
    v_mfma_f32_16x16x32_bf16 v[20:23], a[92:95], a[80:83], v[20:23]
    buffer_load_dwordx4 v231, s[12:15], s44 offen offset:3072  lds
    ds_read_b128 a[16:19], v232 offset:8192
    v_mfma_f32_16x16x32_bf16 v[24:27], a[92:95], a[84:87], v[24:27]
    s_lshl_b32 s52, s101, 13
    v_mfma_f32_16x16x32_bf16 v[28:31], a[92:95], a[88:91], v[28:31]
    ds_read_b128 a[20:23], v232 offset:10240
    s_lshl_b32 s53, s50, 10
    v_mfma_f32_16x16x32_bf16 v[60:63], a[96:99], a[88:91], v[60:63]
    s_add_u32 s44, s44, 229376
    v_mfma_f32_16x16x32_bf16 v[56:59], a[96:99], a[84:87], v[56:59]
    s_add_u32 s52, s52, s53
    v_mfma_f32_16x16x32_bf16 v[52:55], a[96:99], a[80:83], v[52:55]
    ds_read_b128 a[24:27], v232 offset:12288
    v_mfma_f32_16x16x32_bf16 v[48:51], a[96:99], a[76:79], v[48:51]
    s_cmp_eq_u32 s44, 7340032
    s_cselect_b32 s44, 0, s44
    s_mul_i32 s53, s49, 448
    v_mfma_f32_16x16x32_bf16 v[44:47], a[96:99], a[72:75], v[44:47]
    ds_read_b128 a[28:31], v232 offset:14336
    v_mfma_f32_16x16x32_bf16 v[40:43], a[96:99], a[68:71], v[40:43]
    s_add_u32 s52, s52, s53
    v_mfma_f32_16x16x32_bf16 v[36:39], a[96:99], a[64:67], v[36:39]
    s_add_u32 m0, s96, 0
    ds_read_b64_tr_b16 a[36:37], v236 offset:0
    v_mfma_f32_16x16x32_bf16 v[32:35], a[96:99], a[60:63], v[32:35]
    s_add_u32 s52, s52, 65536
    v_mfma_f32_16x16x32_bf16 v[64:67], a[100:103], a[60:63], v[64:67]
    ds_read_b64_tr_b16 a[38:39], v236 offset:4096
    v_mfma_f32_16x16x32_bf16 v[68:71], a[100:103], a[64:67], v[68:71]
    buffer_load_dwordx4 v224, s[20:23], s43 offen offset:0  lds
    v_and_b32 v238, 15, v250
    v_mfma_f32_16x16x32_bf16 v[72:75], a[100:103], a[68:71], v[72:75]
    ds_read_b64_tr_b16 a[40:41], v235 offset:512
    v_mfma_f32_16x16x32_bf16 v[76:79], a[100:103], a[72:75], v[76:79]
    v_or_b32 v238, s48, v238
    v_mfma_f32_16x16x32_bf16 v[80:83], a[100:103], a[76:79], v[80:83]
    buffer_load_dwordx4 v225, s[20:23], s43 offen offset:1024  lds
    ds_read_b64_tr_b16 a[42:43], v235 offset:4608
    v_mfma_f32_16x16x32_bf16 v[84:87], a[100:103], a[80:83], v[84:87]
    v_lshlrev_b32 v238, 27, v238
    v_mfma_f32_16x16x32_bf16 v[88:91], a[100:103], a[84:87], v[88:91]
    ds_read_b64_tr_b16 a[44:45], v236 offset:512
    v_mfma_f32_16x16x32_bf16 v[92:95], a[100:103], a[88:91], v[92:95]
    buffer_load_dwordx4 v226, s[20:23], s43 offen offset:2048  lds
    v_and_b32 v239, 48, v250
    v_mfma_f32_16x16x32_bf16 v[124:127], a[104:107], a[88:91], v[124:127]
    v_mfma_f32_16x16x32_bf16 v[120:123], a[104:107], a[84:87], v[120:123]
    ds_read_b64_tr_b16 a[46:47], v236 offset:4608
    v_or_b32 v238, v238, v239
    v_mfma_f32_16x16x32_bf16 v[116:119], a[104:107], a[80:83], v[116:119]
    buffer_load_dwordx4 v227, s[20:23], s43 offen offset:3072  lds
    v_mfma_f32_16x16x32_bf16 v[112:115], a[104:107], a[76:79], v[112:115]
    ds_read_b64_tr_b16 a[48:49], v235 offset:1024
    s_mov_b32 s47, 6
    v_mfma_f32_16x16x32_bf16 v[108:111], a[104:107], a[72:75], v[108:111]
    v_mfma_f32_16x16x32_bf16 v[104:107], a[104:107], a[68:71], v[104:107]
    ds_read_b64_tr_b16 a[50:51], v235 offset:5120
    buffer_load_dwordx2 v[254:255], off, s[88:91], 0  sc1
    v_mfma_f32_16x16x32_bf16 v[100:103], a[104:107], a[64:67], v[100:103]
    v_mfma_f32_16x16x32_bf16 v[96:99], a[104:107], a[60:63], v[96:99]
    ds_read_b64_tr_b16 a[52:53], v236 offset:1024
    buffer_store_dwordx4 a[128:131], v238, s[8:11], s52 offen offset:0 sc1
    v_mfma_f32_16x16x32_bf16 v[128:131], a[108:111], a[60:63], v[128:131]
    v_mfma_f32_16x16x32_bf16 v[132:135], a[108:111], a[64:67], v[132:135]
    ds_read_b64_tr_b16 a[54:55], v236 offset:5120
    buffer_store_dwordx4 a[132:135], v238, s[8:11], s52 offen offset:64 sc1
    v_mfma_f32_16x16x32_bf16 v[136:139], a[108:111], a[68:71], v[136:139]
    v_mfma_f32_16x16x32_bf16 v[140:143], a[108:111], a[72:75], v[140:143]
    ds_read_b64_tr_b16 a[56:57], v237 offset:3072
    buffer_store_dwordx4 a[136:139], v238, s[8:11], s52 offen offset:128 sc1
    v_mfma_f32_16x16x32_bf16 v[144:147], a[108:111], a[76:79], v[144:147]
    v_mfma_f32_16x16x32_bf16 v[148:151], a[108:111], a[80:83], v[148:151]
    ds_read_b64_tr_b16 a[58:59], v237 offset:7168
    buffer_store_dwordx4 a[140:143], v238, s[8:11], s52 offen offset:192 sc1
    v_mfma_f32_16x16x32_bf16 v[152:155], a[108:111], a[84:87], v[152:155]
    v_mfma_f32_16x16x32_bf16 v[156:159], a[108:111], a[88:91], v[156:159]
    buffer_store_dwordx4 a[144:147], v238, s[8:11], s52 offen offset:256 sc1
    v_mfma_f32_16x16x32_bf16 v[188:191], a[112:115], a[88:91], v[188:191]
    v_mfma_f32_16x16x32_bf16 v[184:187], a[112:115], a[84:87], v[184:187]
    buffer_store_dwordx4 a[148:151], v238, s[8:11], s52 offen offset:320 sc1
    v_mfma_f32_16x16x32_bf16 v[180:183], a[112:115], a[80:83], v[180:183]
    v_mfma_f32_16x16x32_bf16 v[176:179], a[112:115], a[76:79], v[176:179]
    buffer_store_dwordx4 a[152:155], v238, s[8:11], s52 offen offset:384 sc1
    v_mfma_f32_16x16x32_bf16 v[172:175], a[112:115], a[72:75], v[172:175]
    v_mfma_f32_16x16x32_bf16 v[168:171], a[112:115], a[68:71], v[168:171]
    v_mfma_f32_16x16x32_bf16 v[164:167], a[112:115], a[64:67], v[164:167]
    v_mfma_f32_16x16x32_bf16 v[160:163], a[112:115], a[60:63], v[160:163]
    v_mfma_f32_16x16x32_bf16 v[192:195], a[116:119], a[60:63], v[192:195]
    v_mfma_f32_16x16x32_bf16 v[196:199], a[116:119], a[64:67], v[196:199]
    v_mfma_f32_16x16x32_bf16 v[200:203], a[116:119], a[68:71], v[200:203]
    v_mfma_f32_16x16x32_bf16 v[204:207], a[116:119], a[72:75], v[204:207]
    v_mfma_f32_16x16x32_bf16 v[208:211], a[116:119], a[76:79], v[208:211]
    v_mfma_f32_16x16x32_bf16 v[212:215], a[116:119], a[80:83], v[212:215]
    v_mfma_f32_16x16x32_bf16 v[216:219], a[116:119], a[84:87], v[216:219]
    v_mfma_f32_16x16x32_bf16 v[220:223], a[116:119], a[88:91], v[220:223]
    s_waitcnt vmcnt(23) lgkmcnt(0)
    s_barrier
.p2align 6
L_g1_ffn_loop:
    v_mfma_f32_16x16x32_bf16 v[0:3], a[32:35], a[0:3], v[0:3]
    s_add_u32 m0, s46, 0
    ds_read_b64_tr_b16 a[92:93], v235 offset:16384
    v_mfma_f32_16x16x32_bf16 v[4:7], a[32:35], a[4:7], v[4:7]
    ds_read_b64_tr_b16 a[94:95], v235 offset:20480
    v_mfma_f32_16x16x32_bf16 v[8:11], a[32:35], a[8:11], v[8:11]
    buffer_load_dwordx4 v228, s[12:15], s44 offen offset:0  lds
    v_mfma_f32_16x16x32_bf16 v[12:15], a[32:35], a[12:15], v[12:15]
    ds_read_b128 a[60:63], v233 offset:0
    v_mfma_f32_16x16x32_bf16 v[16:19], a[32:35], a[16:19], v[16:19]
    buffer_load_dwordx4 v229, s[12:15], s44 offen offset:1024  lds
    v_mfma_f32_16x16x32_bf16 v[20:23], a[32:35], a[20:23], v[20:23]
    ds_read_b128 a[64:67], v233 offset:2048
    v_mfma_f32_16x16x32_bf16 v[24:27], a[32:35], a[24:27], v[24:27]
    v_mfma_f32_16x16x32_bf16 v[28:31], a[32:35], a[28:31], v[28:31]
    buffer_load_dwordx4 v230, s[12:15], s44 offen offset:2048  lds
    v_mfma_f32_16x16x32_bf16 v[60:63], a[36:39], a[28:31], v[60:63]
    ds_read_b128 a[68:71], v233 offset:4096
    v_mfma_f32_16x16x32_bf16 v[56:59], a[36:39], a[24:27], v[56:59]
    buffer_load_dwordx4 v231, s[12:15], s44 offen offset:3072  lds
    v_mfma_f32_16x16x32_bf16 v[52:55], a[36:39], a[20:23], v[52:55]
    ds_read_b128 a[72:75], v233 offset:6144
    v_mfma_f32_16x16x32_bf16 v[48:51], a[36:39], a[16:19], v[48:51]
    s_add_u32 s44, s44, 229376
    ds_read_b128 a[76:79], v233 offset:8192
    v_mfma_f32_16x16x32_bf16 v[44:47], a[36:39], a[12:15], v[44:47]
    v_mfma_f32_16x16x32_bf16 v[40:43], a[36:39], a[8:11], v[40:43]
    ds_read_b128 a[80:83], v233 offset:10240
    v_mfma_f32_16x16x32_bf16 v[36:39], a[36:39], a[4:7], v[36:39]
    s_add_u32 m0, s96, 4096
    v_mfma_f32_16x16x32_bf16 v[32:35], a[36:39], a[0:3], v[32:35]
    ds_read_b128 a[84:87], v233 offset:12288
    v_mfma_f32_16x16x32_bf16 v[64:67], a[40:43], a[0:3], v[64:67]
    buffer_load_dwordx4 v224, s[16:19], s43 offen offset:0  lds
    v_mfma_f32_16x16x32_bf16 v[68:71], a[40:43], a[4:7], v[68:71]
    ds_read_b128 a[88:91], v233 offset:14336
    v_mfma_f32_16x16x32_bf16 v[72:75], a[40:43], a[8:11], v[72:75]
    buffer_load_dwordx4 v225, s[16:19], s43 offen offset:1024  lds
    v_mfma_f32_16x16x32_bf16 v[76:79], a[40:43], a[12:15], v[76:79]
    ds_read_b64_tr_b16 a[96:97], v236 offset:16384
    v_mfma_f32_16x16x32_bf16 v[80:83], a[40:43], a[16:19], v[80:83]
    v_mfma_f32_16x16x32_bf16 v[84:87], a[40:43], a[20:23], v[84:87]
    buffer_load_dwordx4 v226, s[16:19], s43 offen offset:2048  lds
    v_mfma_f32_16x16x32_bf16 v[88:91], a[40:43], a[24:27], v[88:91]
    ds_read_b64_tr_b16 a[98:99], v236 offset:20480
    v_mfma_f32_16x16x32_bf16 v[92:95], a[40:43], a[28:31], v[92:95]
    ds_read_b64_tr_b16 a[100:101], v235 offset:16896
    v_mfma_f32_16x16x32_bf16 v[124:127], a[44:47], a[28:31], v[124:127]
    buffer_load_dwordx4 v227, s[16:19], s43 offen offset:3072  lds
    v_mfma_f32_16x16x32_bf16 v[120:123], a[44:47], a[24:27], v[120:123]
    ds_read_b64_tr_b16 a[102:103], v235 offset:20992
    v_mfma_f32_16x16x32_bf16 v[116:119], a[44:47], a[20:23], v[116:119]
    s_add_u32 s43, s43, 128
    ds_read_b64_tr_b16 a[104:105], v236 offset:16896
    v_mfma_f32_16x16x32_bf16 v[112:115], a[44:47], a[16:19], v[112:115]
    v_mfma_f32_16x16x32_bf16 v[108:111], a[44:47], a[12:15], v[108:111]
    buffer_load_dwordx4 a[120:123], v251, s[24:27], s58 offen
    v_mfma_f32_16x16x32_bf16 v[104:107], a[44:47], a[8:11], v[104:107]
    ds_read_b64_tr_b16 a[106:107], v236 offset:20992
    v_mfma_f32_16x16x32_bf16 v[100:103], a[44:47], a[4:7], v[100:103]
    s_add_u32 s58, s58, 1048576
    ds_read_b64_tr_b16 a[108:109], v235 offset:17408
    v_mfma_f32_16x16x32_bf16 v[96:99], a[44:47], a[0:3], v[96:99]
    v_mfma_f32_16x16x32_bf16 v[128:131], a[48:51], a[0:3], v[128:131]
    ds_read_b64_tr_b16 a[110:111], v235 offset:21504
    v_mfma_f32_16x16x32_bf16 v[132:135], a[48:51], a[4:7], v[132:135]
    v_mfma_f32_16x16x32_bf16 v[136:139], a[48:51], a[8:11], v[136:139]
    ds_read_b64_tr_b16 a[112:113], v236 offset:17408
    v_mfma_f32_16x16x32_bf16 v[140:143], a[48:51], a[12:15], v[140:143]
    v_mfma_f32_16x16x32_bf16 v[144:147], a[48:51], a[16:19], v[144:147]
    ds_read_b64_tr_b16 a[114:115], v236 offset:21504
    v_mfma_f32_16x16x32_bf16 v[148:151], a[48:51], a[20:23], v[148:151]
    v_mfma_f32_16x16x32_bf16 v[152:155], a[48:51], a[24:27], v[152:155]
    ds_read_b64_tr_b16 a[116:117], v237 offset:19456
    v_mfma_f32_16x16x32_bf16 v[156:159], a[48:51], a[28:31], v[156:159]
    v_mfma_f32_16x16x32_bf16 v[188:191], a[52:55], a[28:31], v[188:191]
    ds_read_b64_tr_b16 a[118:119], v237 offset:23552
    v_mfma_f32_16x16x32_bf16 v[184:187], a[52:55], a[24:27], v[184:187]
    v_mfma_f32_16x16x32_bf16 v[180:183], a[52:55], a[20:23], v[180:183]
    v_mfma_f32_16x16x32_bf16 v[176:179], a[52:55], a[16:19], v[176:179]
    v_mfma_f32_16x16x32_bf16 v[172:175], a[52:55], a[12:15], v[172:175]
    s_add_u32 s96, s97, s45
    v_mfma_f32_16x16x32_bf16 v[168:171], a[52:55], a[8:11], v[168:171]
    v_mfma_f32_16x16x32_bf16 v[164:167], a[52:55], a[4:7], v[164:167]
    s_add_u32 s97, s97, 32768
    v_mfma_f32_16x16x32_bf16 v[160:163], a[52:55], a[0:3], v[160:163]
    v_mfma_f32_16x16x32_bf16 v[192:195], a[56:59], a[0:3], v[192:195]
    s_cmp_eq_u32 s97, 98304
    s_cselect_b32 s97, 0, s97
    v_mfma_f32_16x16x32_bf16 v[196:199], a[56:59], a[4:7], v[196:199]
    v_mfma_f32_16x16x32_bf16 v[200:203], a[56:59], a[8:11], v[200:203]
    v_add_u32 v232, s97, v234
    v_mfma_f32_16x16x32_bf16 v[204:207], a[56:59], a[12:15], v[204:207]
    v_mfma_f32_16x16x32_bf16 v[208:211], a[56:59], a[16:19], v[208:211]
    v_xor_b32 v233, 64, v232
    v_mfma_f32_16x16x32_bf16 v[212:215], a[56:59], a[20:23], v[212:215]
    v_mfma_f32_16x16x32_bf16 v[216:219], a[56:59], a[24:27], v[216:219]
    v_mfma_f32_16x16x32_bf16 v[220:223], a[56:59], a[28:31], v[220:223]
    s_waitcnt vmcnt(17) lgkmcnt(0)
    s_barrier
    v_mfma_f32_16x16x32_bf16 v[0:3], a[92:95], a[60:63], v[0:3]
    s_add_u32 m0, s46, 16384
    ds_read_b64_tr_b16 a[32:33], v235 offset:32768
    v_mfma_f32_16x16x32_bf16 v[4:7], a[92:95], a[64:67], v[4:7]
    ds_read_b64_tr_b16 a[34:35], v235 offset:36864
    v_mfma_f32_16x16x32_bf16 v[8:11], a[92:95], a[68:71], v[8:11]
    v_mfma_f32_16x16x32_bf16 v[12:15], a[92:95], a[72:75], v[12:15]
    buffer_load_dwordx4 v228, s[12:15], s44 offen offset:0  lds
    v_mfma_f32_16x16x32_bf16 v[16:19], a[92:95], a[76:79], v[16:19]
    ds_read_b128 a[0:3], v232 offset:0
    v_mfma_f32_16x16x32_bf16 v[20:23], a[92:95], a[80:83], v[20:23]
    ds_read_b128 a[4:7], v232 offset:2048
    v_mfma_f32_16x16x32_bf16 v[24:27], a[92:95], a[84:87], v[24:27]
    buffer_load_dwordx4 v229, s[12:15], s44 offen offset:1024  lds
    v_mfma_f32_16x16x32_bf16 v[28:31], a[92:95], a[88:91], v[28:31]
    ds_read_b128 a[8:11], v232 offset:4096
    v_mfma_f32_16x16x32_bf16 v[60:63], a[96:99], a[88:91], v[60:63]
    v_mfma_f32_16x16x32_bf16 v[56:59], a[96:99], a[84:87], v[56:59]
    buffer_load_dwordx4 v230, s[12:15], s44 offen offset:2048  lds
    v_mfma_f32_16x16x32_bf16 v[52:55], a[96:99], a[80:83], v[52:55]
    ds_read_b128 a[12:15], v232 offset:6144
    v_mfma_f32_16x16x32_bf16 v[48:51], a[96:99], a[76:79], v[48:51]
    ds_read_b128 a[16:19], v232 offset:8192
    v_mfma_f32_16x16x32_bf16 v[44:47], a[96:99], a[72:75], v[44:47]
    buffer_load_dwordx4 v231, s[12:15], s44 offen offset:3072  lds
    v_mfma_f32_16x16x32_bf16 v[40:43], a[96:99], a[68:71], v[40:43]
    ds_read_b128 a[20:23], v232 offset:10240
    v_mfma_f32_16x16x32_bf16 v[36:39], a[96:99], a[64:67], v[36:39]
    v_mfma_f32_16x16x32_bf16 v[32:35], a[96:99], a[60:63], v[32:35]
    s_add_u32 s44, s44, 229376
    ds_read_b128 a[24:27], v232 offset:12288
    v_mfma_f32_16x16x32_bf16 v[64:67], a[100:103], a[60:63], v[64:67]
    v_mfma_f32_16x16x32_bf16 v[68:71], a[100:103], a[64:67], v[68:71]
    ds_read_b128 a[28:31], v232 offset:14336
    v_mfma_f32_16x16x32_bf16 v[72:75], a[100:103], a[68:71], v[72:75]
    s_add_u32 m0, s96, 0
    v_mfma_f32_16x16x32_bf16 v[76:79], a[100:103], a[72:75], v[76:79]
    ds_read_b64_tr_b16 a[36:37], v236 offset:32768
    v_mfma_f32_16x16x32_bf16 v[80:83], a[100:103], a[76:79], v[80:83]
    v_mfma_f32_16x16x32_bf16 v[84:87], a[100:103], a[80:83], v[84:87]
    buffer_load_dwordx4 v224, s[20:23], s43 offen offset:0  lds
    v_mfma_f32_16x16x32_bf16 v[88:91], a[100:103], a[84:87], v[88:91]
    ds_read_b64_tr_b16 a[38:39], v236 offset:36864
    v_mfma_f32_16x16x32_bf16 v[92:95], a[100:103], a[88:91], v[92:95]
    ds_read_b64_tr_b16 a[40:41], v235 offset:33280
    v_mfma_f32_16x16x32_bf16 v[124:127], a[104:107], a[88:91], v[124:127]
    buffer_load_dwordx4 v225, s[20:23], s43 offen offset:1024  lds
    v_mfma_f32_16x16x32_bf16 v[120:123], a[104:107], a[84:87], v[120:123]
    ds_read_b64_tr_b16 a[42:43], v235 offset:37376
    v_mfma_f32_16x16x32_bf16 v[116:119], a[104:107], a[80:83], v[116:119]
    ds_read_b64_tr_b16 a[44:45], v236 offset:33280
    v_mfma_f32_16x16x32_bf16 v[112:115], a[104:107], a[76:79], v[112:115]
    buffer_load_dwordx4 v226, s[20:23], s43 offen offset:2048  lds
    v_mfma_f32_16x16x32_bf16 v[108:111], a[104:107], a[72:75], v[108:111]
    ds_read_b64_tr_b16 a[46:47], v236 offset:37376
    v_mfma_f32_16x16x32_bf16 v[104:107], a[104:107], a[68:71], v[104:107]
    v_mfma_f32_16x16x32_bf16 v[100:103], a[104:107], a[64:67], v[100:103]
    buffer_load_dwordx4 v227, s[20:23], s43 offen offset:3072  lds
    v_mfma_f32_16x16x32_bf16 v[96:99], a[104:107], a[60:63], v[96:99]
    ds_read_b64_tr_b16 a[48:49], v235 offset:33792
    v_mfma_f32_16x16x32_bf16 v[128:131], a[108:111], a[60:63], v[128:131]
    ds_read_b64_tr_b16 a[50:51], v235 offset:37888
    v_mfma_f32_16x16x32_bf16 v[132:135], a[108:111], a[64:67], v[132:135]
    v_mfma_f32_16x16x32_bf16 v[136:139], a[108:111], a[68:71], v[136:139]
    ds_read_b64_tr_b16 a[52:53], v236 offset:33792
    v_mfma_f32_16x16x32_bf16 v[140:143], a[108:111], a[72:75], v[140:143]
    v_mfma_f32_16x16x32_bf16 v[144:147], a[108:111], a[76:79], v[144:147]
    ds_read_b64_tr_b16 a[54:55], v236 offset:37888
    v_mfma_f32_16x16x32_bf16 v[148:151], a[108:111], a[80:83], v[148:151]
    v_mfma_f32_16x16x32_bf16 v[152:155], a[108:111], a[84:87], v[152:155]
    ds_read_b64_tr_b16 a[56:57], v237 offset:35840
    v_mfma_f32_16x16x32_bf16 v[156:159], a[108:111], a[88:91], v[156:159]
    v_mfma_f32_16x16x32_bf16 v[188:191], a[112:115], a[88:91], v[188:191]
    ds_read_b64_tr_b16 a[58:59], v237 offset:39936
    v_mfma_f32_16x16x32_bf16 v[184:187], a[112:115], a[84:87], v[184:187]
    v_mfma_f32_16x16x32_bf16 v[180:183], a[112:115], a[80:83], v[180:183]
    v_mfma_f32_16x16x32_bf16 v[176:179], a[112:115], a[76:79], v[176:179]
    v_mfma_f32_16x16x32_bf16 v[172:175], a[112:115], a[72:75], v[172:175]
    v_mfma_f32_16x16x32_bf16 v[168:171], a[112:115], a[68:71], v[168:171]
    v_mfma_f32_16x16x32_bf16 v[164:167], a[112:115], a[64:67], v[164:167]
    v_mfma_f32_16x16x32_bf16 v[160:163], a[112:115], a[60:63], v[160:163]
    v_mfma_f32_16x16x32_bf16 v[192:195], a[116:119], a[60:63], v[192:195]
    v_mfma_f32_16x16x32_bf16 v[196:199], a[116:119], a[64:67], v[196:199]
    v_mfma_f32_16x16x32_bf16 v[200:203], a[116:119], a[68:71], v[200:203]
    v_mfma_f32_16x16x32_bf16 v[204:207], a[116:119], a[72:75], v[204:207]
    v_mfma_f32_16x16x32_bf16 v[208:211], a[116:119], a[76:79], v[208:211]
    v_mfma_f32_16x16x32_bf16 v[212:215], a[116:119], a[80:83], v[212:215]
    v_mfma_f32_16x16x32_bf16 v[216:219], a[116:119], a[84:87], v[216:219]
    v_mfma_f32_16x16x32_bf16 v[220:223], a[116:119], a[88:91], v[220:223]
    s_waitcnt vmcnt(21) lgkmcnt(0)
    s_barrier
    v_mfma_f32_16x16x32_bf16 v[0:3], a[32:35], a[0:3], v[0:3]
    s_add_u32 m0, s46, 32768
    ds_read_b64_tr_b16 a[92:93], v235 offset:49152
    v_mfma_f32_16x16x32_bf16 v[4:7], a[32:35], a[4:7], v[4:7]
    ds_read_b64_tr_b16 a[94:95], v235 offset:53248
    v_mfma_f32_16x16x32_bf16 v[8:11], a[32:35], a[8:11], v[8:11]
    buffer_load_dwordx4 v228, s[12:15], s44 offen offset:0  lds
    v_mfma_f32_16x16x32_bf16 v[12:15], a[32:35], a[12:15], v[12:15]
    ds_read_b128 a[60:63], v233 offset:0
    v_mfma_f32_16x16x32_bf16 v[16:19], a[32:35], a[16:19], v[16:19]
    buffer_load_dwordx4 v229, s[12:15], s44 offen offset:1024  lds
    v_mfma_f32_16x16x32_bf16 v[20:23], a[32:35], a[20:23], v[20:23]
    ds_read_b128 a[64:67], v233 offset:2048
    v_mfma_f32_16x16x32_bf16 v[24:27], a[32:35], a[24:27], v[24:27]
    buffer_load_dwordx4 v230, s[12:15], s44 offen offset:2048  lds
    v_mfma_f32_16x16x32_bf16 v[28:31], a[32:35], a[28:31], v[28:31]
    ds_read_b128 a[68:71], v233 offset:4096
    v_mfma_f32_16x16x32_bf16 v[60:63], a[36:39], a[28:31], v[60:63]
    buffer_load_dwordx4 v231, s[12:15], s44 offen offset:3072  lds
    v_mfma_f32_16x16x32_bf16 v[56:59], a[36:39], a[24:27], v[56:59]
    ds_read_b128 a[72:75], v233 offset:6144
    v_mfma_f32_16x16x32_bf16 v[52:55], a[36:39], a[20:23], v[52:55]
    v_mfma_f32_16x16x32_bf16 v[48:51], a[36:39], a[16:19], v[48:51]
    s_add_u32 s44, s44, 229376
    ds_read_b128 a[76:79], v233 offset:8192
    v_mfma_f32_16x16x32_bf16 v[44:47], a[36:39], a[12:15], v[44:47]
    v_mfma_f32_16x16x32_bf16 v[40:43], a[36:39], a[8:11], v[40:43]
    s_add_u32 m0, s96, 4096
    ds_read_b128 a[80:83], v233 offset:10240
    v_mfma_f32_16x16x32_bf16 v[36:39], a[36:39], a[4:7], v[36:39]
    v_mfma_f32_16x16x32_bf16 v[32:35], a[36:39], a[0:3], v[32:35]
    buffer_load_dwordx4 v224, s[16:19], s43 offen offset:0  lds
    v_mfma_f32_16x16x32_bf16 v[64:67], a[40:43], a[0:3], v[64:67]
    ds_read_b128 a[84:87], v233 offset:12288
    v_mfma_f32_16x16x32_bf16 v[68:71], a[40:43], a[4:7], v[68:71]
    buffer_load_dwordx4 v225, s[16:19], s43 offen offset:1024  lds
    v_mfma_f32_16x16x32_bf16 v[72:75], a[40:43], a[8:11], v[72:75]
    ds_read_b128 a[88:91], v233 offset:14336
    v_mfma_f32_16x16x32_bf16 v[76:79], a[40:43], a[12:15], v[76:79]
    buffer_load_dwordx4 v226, s[16:19], s43 offen offset:2048  lds
    v_mfma_f32_16x16x32_bf16 v[80:83], a[40:43], a[16:19], v[80:83]
    ds_read_b64_tr_b16 a[96:97], v236 offset:49152
    v_mfma_f32_16x16x32_bf16 v[84:87], a[40:43], a[20:23], v[84:87]
    ds_read_b64_tr_b16 a[98:99], v236 offset:53248
    v_mfma_f32_16x16x32_bf16 v[88:91], a[40:43], a[24:27], v[88:91]
    buffer_load_dwordx4 v227, s[16:19], s43 offen offset:3072  lds
    v_mfma_f32_16x16x32_bf16 v[92:95], a[40:43], a[28:31], v[92:95]
    ds_read_b64_tr_b16 a[100:101], v235 offset:49664
    v_mfma_f32_16x16x32_bf16 v[124:127], a[44:47], a[28:31], v[124:127]
    s_add_u32 s43, s43, 128
    ds_read_b64_tr_b16 a[102:103], v235 offset:53760
    v_mfma_f32_16x16x32_bf16 v[120:123], a[44:47], a[24:27], v[120:123]
    v_mfma_f32_16x16x32_bf16 v[116:119], a[44:47], a[20:23], v[116:119]
    s_and_b32 s43, s43, 2047
    ds_read_b64_tr_b16 a[104:105], v236 offset:49664
    v_mfma_f32_16x16x32_bf16 v[112:115], a[44:47], a[16:19], v[112:115]
    v_mfma_f32_16x16x32_bf16 v[108:111], a[44:47], a[12:15], v[108:111]
    buffer_load_dwordx4 a[120:123], v251, s[24:27], s58 offen
    v_mfma_f32_16x16x32_bf16 v[104:107], a[44:47], a[8:11], v[104:107]
    ds_read_b64_tr_b16 a[106:107], v236 offset:53760
    v_mfma_f32_16x16x32_bf16 v[100:103], a[44:47], a[4:7], v[100:103]
    s_add_u32 s58, s58, 1048576
    ds_read_b64_tr_b16 a[108:109], v235 offset:50176
    v_mfma_f32_16x16x32_bf16 v[96:99], a[44:47], a[0:3], v[96:99]
    v_mfma_f32_16x16x32_bf16 v[128:131], a[48:51], a[0:3], v[128:131]
    ds_read_b64_tr_b16 a[110:111], v235 offset:54272
    v_mfma_f32_16x16x32_bf16 v[132:135], a[48:51], a[4:7], v[132:135]
    v_mfma_f32_16x16x32_bf16 v[136:139], a[48:51], a[8:11], v[136:139]
    ds_read_b64_tr_b16 a[112:113], v236 offset:50176
    v_mfma_f32_16x16x32_bf16 v[140:143], a[48:51], a[12:15], v[140:143]
    v_mfma_f32_16x16x32_bf16 v[144:147], a[48:51], a[16:19], v[144:147]
    ds_read_b64_tr_b16 a[114:115], v236 offset:54272
    v_mfma_f32_16x16x32_bf16 v[148:151], a[48:51], a[20:23], v[148:151]
    v_mfma_f32_16x16x32_bf16 v[152:155], a[48:51], a[24:27], v[152:155]
    ds_read_b64_tr_b16 a[116:117], v237 offset:52224
    v_mfma_f32_16x16x32_bf16 v[156:159], a[48:51], a[28:31], v[156:159]
    v_mfma_f32_16x16x32_bf16 v[188:191], a[52:55], a[28:31], v[188:191]
    ds_read_b64_tr_b16 a[118:119], v237 offset:56320
    v_mfma_f32_16x16x32_bf16 v[184:187], a[52:55], a[24:27], v[184:187]
    v_mfma_f32_16x16x32_bf16 v[180:183], a[52:55], a[20:23], v[180:183]
    v_mfma_f32_16x16x32_bf16 v[176:179], a[52:55], a[16:19], v[176:179]
    v_mfma_f32_16x16x32_bf16 v[172:175], a[52:55], a[12:15], v[172:175]
    s_add_u32 s96, s97, s45
    v_mfma_f32_16x16x32_bf16 v[168:171], a[52:55], a[8:11], v[168:171]
    v_mfma_f32_16x16x32_bf16 v[164:167], a[52:55], a[4:7], v[164:167]
    s_add_u32 s97, s97, 32768
    v_mfma_f32_16x16x32_bf16 v[160:163], a[52:55], a[0:3], v[160:163]
    v_mfma_f32_16x16x32_bf16 v[192:195], a[56:59], a[0:3], v[192:195]
    s_cmp_eq_u32 s97, 98304
    s_cselect_b32 s97, 0, s97
    v_mfma_f32_16x16x32_bf16 v[196:199], a[56:59], a[4:7], v[196:199]
    v_mfma_f32_16x16x32_bf16 v[200:203], a[56:59], a[8:11], v[200:203]
    v_add_u32 v232, s97, v234
    v_mfma_f32_16x16x32_bf16 v[204:207], a[56:59], a[12:15], v[204:207]
    v_mfma_f32_16x16x32_bf16 v[208:211], a[56:59], a[16:19], v[208:211]
    v_xor_b32 v233, 64, v232
    v_mfma_f32_16x16x32_bf16 v[212:215], a[56:59], a[20:23], v[212:215]
    v_mfma_f32_16x16x32_bf16 v[216:219], a[56:59], a[24:27], v[216:219]
    v_mfma_f32_16x16x32_bf16 v[220:223], a[56:59], a[28:31], v[220:223]
    s_waitcnt vmcnt(18) lgkmcnt(0)
    s_barrier
    v_mfma_f32_16x16x32_bf16 v[0:3], a[92:95], a[60:63], v[0:3]
    s_cmp_eq_u32 s47, 1
    s_cselect_b32 s22, 0, s22
    v_mfma_f32_16x16x32_bf16 v[4:7], a[92:95], a[64:67], v[4:7]
    ds_read_b64_tr_b16 a[32:33], v235 offset:0
    v_mfma_f32_16x16x32_bf16 v[8:11], a[92:95], a[68:71], v[8:11]
    ds_read_b64_tr_b16 a[34:35], v235 offset:4096
    v_mfma_f32_16x16x32_bf16 v[12:15], a[92:95], a[72:75], v[12:15]
    s_add_u32 m0, s46, 49152
    ds_read_b128 a[0:3], v232 offset:0
    v_mfma_f32_16x16x32_bf16 v[16:19], a[92:95], a[76:79], v[16:19]
    buffer_load_dwordx4 v228, s[12:15], s44 offen offset:0  lds
    v_mfma_f32_16x16x32_bf16 v[20:23], a[92:95], a[80:83], v[20:23]
    ds_read_b128 a[4:7], v232 offset:2048
    v_mfma_f32_16x16x32_bf16 v[24:27], a[92:95], a[84:87], v[24:27]
    buffer_load_dwordx4 v229, s[12:15], s44 offen offset:1024  lds
    v_mfma_f32_16x16x32_bf16 v[28:31], a[92:95], a[88:91], v[28:31]
    ds_read_b128 a[8:11], v232 offset:4096
    v_mfma_f32_16x16x32_bf16 v[60:63], a[96:99], a[88:91], v[60:63]
    buffer_load_dwordx4 v230, s[12:15], s44 offen offset:2048  lds
    v_mfma_f32_16x16x32_bf16 v[56:59], a[96:99], a[84:87], v[56:59]
    ds_read_b128 a[12:15], v232 offset:6144
    v_mfma_f32_16x16x32_bf16 v[52:55], a[96:99], a[80:83], v[52:55]
    v_mfma_f32_16x16x32_bf16 v[48:51], a[96:99], a[76:79], v[48:51]
    buffer_load_dwordx4 v231, s[12:15], s44 offen offset:3072  lds
    v_mfma_f32_16x16x32_bf16 v[44:47], a[96:99], a[72:75], v[44:47]
    ds_read_b128 a[16:19], v232 offset:8192
    v_mfma_f32_16x16x32_bf16 v[40:43], a[96:99], a[68:71], v[40:43]
    s_add_u32 s44, s44, 229376
    ds_read_b128 a[20:23], v232 offset:10240
    v_mfma_f32_16x16x32_bf16 v[36:39], a[96:99], a[64:67], v[36:39]
    v_mfma_f32_16x16x32_bf16 v[32:35], a[96:99], a[60:63], v[32:35]
    s_cmp_eq_u32 s44, 7340032
    s_cselect_b32 s44, 0, s44
    v_mfma_f32_16x16x32_bf16 v[64:67], a[100:103], a[60:63], v[64:67]
    ds_read_b128 a[24:27], v232 offset:12288
    v_mfma_f32_16x16x32_bf16 v[68:71], a[100:103], a[64:67], v[68:71]
    s_add_u32 m0, s96, 0
    ds_read_b128 a[28:31], v232 offset:14336
    v_mfma_f32_16x16x32_bf16 v[72:75], a[100:103], a[68:71], v[72:75]
    v_mfma_f32_16x16x32_bf16 v[76:79], a[100:103], a[72:75], v[76:79]
    buffer_load_dwordx4 v224, s[20:23], s43 offen offset:0  lds
    v_mfma_f32_16x16x32_bf16 v[80:83], a[100:103], a[76:79], v[80:83]
    ds_read_b64_tr_b16 a[36:37], v236 offset:0
    v_mfma_f32_16x16x32_bf16 v[84:87], a[100:103], a[80:83], v[84:87]
    ds_read_b64_tr_b16 a[38:39], v236 offset:4096
    v_mfma_f32_16x16x32_bf16 v[88:91], a[100:103], a[84:87], v[88:91]
    buffer_load_dwordx4 v225, s[20:23], s43 offen offset:1024  lds
    v_mfma_f32_16x16x32_bf16 v[92:95], a[100:103], a[88:91], v[92:95]
    ds_read_b64_tr_b16 a[40:41], v235 offset:512
    v_mfma_f32_16x16x32_bf16 v[124:127], a[104:107], a[88:91], v[124:127]
    buffer_load_dwordx4 v226, s[20:23], s43 offen offset:2048  lds
    v_mfma_f32_16x16x32_bf16 v[120:123], a[104:107], a[84:87], v[120:123]
    ds_read_b64_tr_b16 a[42:43], v235 offset:4608
    v_mfma_f32_16x16x32_bf16 v[116:119], a[104:107], a[80:83], v[116:119]
    buffer_load_dwordx4 v227, s[20:23], s43 offen offset:3072  lds
    v_mfma_f32_16x16x32_bf16 v[112:115], a[104:107], a[76:79], v[112:115]
    ds_read_b64_tr_b16 a[44:45], v236 offset:512
    v_mfma_f32_16x16x32_bf16 v[108:111], a[104:107], a[72:75], v[108:111]
    s_sub_u32 s47, s47, 1
    ds_read_b64_tr_b16 a[46:47], v236 offset:4608
    v_mfma_f32_16x16x32_bf16 v[104:107], a[104:107], a[68:71], v[104:107]
    v_mfma_f32_16x16x32_bf16 v[100:103], a[104:107], a[64:67], v[100:103]
    s_bitcmp1_b32 0x3d, s47
    ds_read_b64_tr_b16 a[48:49], v235 offset:1024
    v_mfma_f32_16x16x32_bf16 v[96:99], a[104:107], a[60:63], v[96:99]
    v_mfma_f32_16x16x32_bf16 v[128:131], a[108:111], a[60:63], v[128:131]
    ds_read_b64_tr_b16 a[50:51], v235 offset:5120
    v_mfma_f32_16x16x32_bf16 v[132:135], a[108:111], a[64:67], v[132:135]
    v_mfma_f32_16x16x32_bf16 v[136:139], a[108:111], a[68:71], v[136:139]
    ds_read_b64_tr_b16 a[52:53], v236 offset:1024
    v_mfma_f32_16x16x32_bf16 v[140:143], a[108:111], a[72:75], v[140:143]
    v_mfma_f32_16x16x32_bf16 v[144:147], a[108:111], a[76:79], v[144:147]
    ds_read_b64_tr_b16 a[54:55], v236 offset:5120
    v_mfma_f32_16x16x32_bf16 v[148:151], a[108:111], a[80:83], v[148:151]
    v_mfma_f32_16x16x32_bf16 v[152:155], a[108:111], a[84:87], v[152:155]
    ds_read_b64_tr_b16 a[56:57], v237 offset:3072
    v_mfma_f32_16x16x32_bf16 v[156:159], a[108:111], a[88:91], v[156:159]
    v_mfma_f32_16x16x32_bf16 v[188:191], a[112:115], a[88:91], v[188:191]
    ds_read_b64_tr_b16 a[58:59], v237 offset:7168
    v_mfma_f32_16x16x32_bf16 v[184:187], a[112:115], a[84:87], v[184:187]
    v_mfma_f32_16x16x32_bf16 v[180:183], a[112:115], a[80:83], v[180:183]
    v_mfma_f32_16x16x32_bf16 v[176:179], a[112:115], a[76:79], v[176:179]
    v_mfma_f32_16x16x32_bf16 v[172:175], a[112:115], a[72:75], v[172:175]
    v_mfma_f32_16x16x32_bf16 v[168:171], a[112:115], a[68:71], v[168:171]
    v_mfma_f32_16x16x32_bf16 v[164:167], a[112:115], a[64:67], v[164:167]
    v_mfma_f32_16x16x32_bf16 v[160:163], a[112:115], a[60:63], v[160:163]
    v_mfma_f32_16x16x32_bf16 v[192:195], a[116:119], a[60:63], v[192:195]
    v_mfma_f32_16x16x32_bf16 v[196:199], a[116:119], a[64:67], v[196:199]
    v_mfma_f32_16x16x32_bf16 v[200:203], a[116:119], a[68:71], v[200:203]
    v_mfma_f32_16x16x32_bf16 v[204:207], a[116:119], a[72:75], v[204:207]
    v_mfma_f32_16x16x32_bf16 v[208:211], a[116:119], a[76:79], v[208:211]
    v_mfma_f32_16x16x32_bf16 v[212:215], a[116:119], a[80:83], v[212:215]
    v_mfma_f32_16x16x32_bf16 v[216:219], a[116:119], a[84:87], v[216:219]
    v_mfma_f32_16x16x32_bf16 v[220:223], a[116:119], a[88:91], v[220:223]
    s_waitcnt vmcnt(21) lgkmcnt(0)
    s_barrier
    s_cbranch_scc0 L_g1_ffn_loop
    s_cmp_lg_u32 s47, 0
    s_cbranch_scc1 L_hk5_ffn
    v_mfma_f32_16x16x32_bf16 v[0:3], a[32:35], a[0:3], v[0:3]
    ds_read_b64_tr_b16 a[92:93], v235 offset:16384
    v_mfma_f32_16x16x32_bf16 v[4:7], a[32:35], a[4:7], v[4:7]
    ds_read_b64_tr_b16 a[94:95], v235 offset:20480
    v_mfma_f32_16x16x32_bf16 v[8:11], a[32:35], a[8:11], v[8:11]
    v_add_f32 v240, v240, v241
    v_mfma_f32_16x16x32_bf16 v[12:15], a[32:35], a[12:15], v[12:15]
    ds_read_b128 a[60:63], v233 offset:0
    v_mfma_f32_16x16x32_bf16 v[16:19], a[32:35], a[16:19], v[16:19]
    v_mfma_f32_16x16x32_bf16 v[20:23], a[32:35], a[20:23], v[20:23]
    ds_read_b128 a[64:67], v233 offset:2048
    v_add_f32 v242, v242, v243
    v_mfma_f32_16x16x32_bf16 v[24:27], a[32:35], a[24:27], v[24:27]
    v_mfma_f32_16x16x32_bf16 v[28:31], a[32:35], a[28:31], v[28:31]
    ds_read_b128 a[68:71], v233 offset:4096
    v_mfma_f32_16x16x32_bf16 v[60:63], a[36:39], a[28:31], v[60:63]
    v_add_f32 v244, v244, v245
    v_mfma_f32_16x16x32_bf16 v[56:59], a[36:39], a[24:27], v[56:59]
    ds_read_b128 a[72:75], v233 offset:6144
    v_mfma_f32_16x16x32_bf16 v[52:55], a[36:39], a[20:23], v[52:55]
    v_mfma_f32_16x16x32_bf16 v[48:51], a[36:39], a[16:19], v[48:51]
    ds_read_b128 a[76:79], v233 offset:8192
    v_add_f32 v246, v246, v247
    v_mfma_f32_16x16x32_bf16 v[44:47], a[36:39], a[12:15], v[44:47]
    v_mfma_f32_16x16x32_bf16 v[40:43], a[36:39], a[8:11], v[40:43]
    ds_read_b128 a[80:83], v233 offset:10240
    v_mfma_f32_16x16x32_bf16 v[36:39], a[36:39], a[4:7], v[36:39]
    v_add_f32 v240, v240, v242
    v_mfma_f32_16x16x32_bf16 v[32:35], a[36:39], a[0:3], v[32:35]
    ds_read_b128 a[84:87], v233 offset:12288
    v_mfma_f32_16x16x32_bf16 v[64:67], a[40:43], a[0:3], v[64:67]
    v_mfma_f32_16x16x32_bf16 v[68:71], a[40:43], a[4:7], v[68:71]
    ds_read_b128 a[88:91], v233 offset:14336
    v_add_f32 v244, v244, v246
    v_mfma_f32_16x16x32_bf16 v[72:75], a[40:43], a[8:11], v[72:75]
    v_mfma_f32_16x16x32_bf16 v[76:79], a[40:43], a[12:15], v[76:79]
    ds_read_b64_tr_b16 a[96:97], v236 offset:16384
    v_mfma_f32_16x16x32_bf16 v[80:83], a[40:43], a[16:19], v[80:83]
    v_add_f32 v240, v240, v244
    v_mfma_f32_16x16x32_bf16 v[84:87], a[40:43], a[20:23], v[84:87]
    ds_read_b64_tr_b16 a[98:99], v236 offset:20480
    v_mfma_f32_16x16x32_bf16 v[88:91], a[40:43], a[24:27], v[88:91]
    ds_read_b64_tr_b16 a[100:101], v235 offset:16896
    v_mfma_f32_16x16x32_bf16 v[92:95], a[40:43], a[28:31], v[92:95]
    v_add_u32 v238, 90112, v238
    v_mfma_f32_16x16x32_bf16 v[124:127], a[44:47], a[28:31], v[124:127]
    ds_read_b64_tr_b16 a[102:103], v235 offset:20992
    v_mfma_f32_16x16x32_bf16 v[120:123], a[44:47], a[24:27], v[120:123]
    v_mfma_f32_16x16x32_bf16 v[116:119], a[44:47], a[20:23], v[116:119]
    ds_read_b64_tr_b16 a[104:105], v236 offset:16896
    v_mfma_f32_16x16x32_bf16 v[112:115], a[44:47], a[16:19], v[112:115]
    v_mfma_f32_16x16x32_bf16 v[108:111], a[44:47], a[12:15], v[108:111]
    ds_read_b64_tr_b16 a[106:107], v236 offset:20992
    v_mfma_f32_16x16x32_bf16 v[104:107], a[44:47], a[8:11], v[104:107]
    v_mfma_f32_16x16x32_bf16 v[100:103], a[44:47], a[4:7], v[100:103]
    ds_read_b64_tr_b16 a[108:109], v235 offset:17408
    v_mfma_f32_16x16x32_bf16 v[96:99], a[44:47], a[0:3], v[96:99]
    v_mfma_f32_16x16x32_bf16 v[128:131], a[48:51], a[0:3], v[128:131]
    ds_read_b64_tr_b16 a[110:111], v235 offset:21504
    v_mfma_f32_16x16x32_bf16 v[132:135], a[48:51], a[4:7], v[132:135]
    v_mfma_f32_16x16x32_bf16 v[136:139], a[48:51], a[8:11], v[136:139]
    ds_read_b64_tr_b16 a[112:113], v236 offset:17408
    v_mfma_f32_16x16x32_bf16 v[140:143], a[48:51], a[12:15], v[140:143]
    v_mfma_f32_16x16x32_bf16 v[144:147], a[48:51], a[16:19], v[144:147]
    ds_read_b64_tr_b16 a[114:115], v236 offset:21504
    v_mfma_f32_16x16x32_bf16 v[148:151], a[48:51], a[20:23], v[148:151]
    v_mfma_f32_16x16x32_bf16 v[152:155], a[48:51], a[24:27], v[152:155]
    ds_read_b64_tr_b16 a[116:117], v237 offset:19456
    v_mfma_f32_16x16x32_bf16 v[156:159], a[48:51], a[28:31], v[156:159]
    v_mfma_f32_16x16x32_bf16 v[188:191], a[52:55], a[28:31], v[188:191]
    ds_read_b64_tr_b16 a[118:119], v237 offset:23552
    v_mfma_f32_16x16x32_bf16 v[184:187], a[52:55], a[24:27], v[184:187]
    v_mfma_f32_16x16x32_bf16 v[180:183], a[52:55], a[20:23], v[180:183]
    v_mfma_f32_16x16x32_bf16 v[176:179], a[52:55], a[16:19], v[176:179]
    v_mfma_f32_16x16x32_bf16 v[172:175], a[52:55], a[12:15], v[172:175]
    s_add_u32 s96, s97, s45
    v_mfma_f32_16x16x32_bf16 v[168:171], a[52:55], a[8:11], v[168:171]
    v_mfma_f32_16x16x32_bf16 v[164:167], a[52:55], a[4:7], v[164:167]
    s_add_u32 s97, s97, 32768
    v_mfma_f32_16x16x32_bf16 v[160:163], a[52:55], a[0:3], v[160:163]
    v_mfma_f32_16x16x32_bf16 v[192:195], a[56:59], a[0:3], v[192:195]
    s_cmp_eq_u32 s97, 98304
    s_cselect_b32 s97, 0, s97
    v_mfma_f32_16x16x32_bf16 v[196:199], a[56:59], a[4:7], v[196:199]
    v_mfma_f32_16x16x32_bf16 v[200:203], a[56:59], a[8:11], v[200:203]
    v_add_u32 v232, s97, v234
    v_mfma_f32_16x16x32_bf16 v[204:207], a[56:59], a[12:15], v[204:207]
    v_mfma_f32_16x16x32_bf16 v[208:211], a[56:59], a[16:19], v[208:211]
    v_xor_b32 v233, 64, v232
    v_mfma_f32_16x16x32_bf16 v[212:215], a[56:59], a[20:23], v[212:215]
    v_mfma_f32_16x16x32_bf16 v[216:219], a[56:59], a[24:27], v[216:219]
    v_mfma_f32_16x16x32_bf16 v[220:223], a[56:59], a[28:31], v[220:223]
    s_waitcnt vmcnt(8) lgkmcnt(0)
    s_barrier
    v_mfma_f32_16x16x32_bf16 v[0:3], a[92:95], a[60:63], v[0:3]
    ds_read_b64_tr_b16 a[32:33], v235 offset:32768
    v_mfma_f32_16x16x32_bf16 v[4:7], a[92:95], a[64:67], v[4:7]
    ds_read_b64_tr_b16 a[34:35], v235 offset:36864
    v_mfma_f32_16x16x32_bf16 v[8:11], a[92:95], a[68:71], v[8:11]
    v_mfma_f32_16x16x32_bf16 v[12:15], a[92:95], a[72:75], v[12:15]
    ds_read_b128 a[0:3], v232 offset:0
    v_mfma_f32_16x16x32_bf16 v[16:19], a[92:95], a[76:79], v[16:19]
    v_mfma_f32_16x16x32_bf16 v[20:23], a[92:95], a[80:83], v[20:23]
    ds_read_b128 a[4:7], v232 offset:2048
    v_mfma_f32_16x16x32_bf16 v[24:27], a[92:95], a[84:87], v[24:27]
    v_mfma_f32_16x16x32_bf16 v[28:31], a[92:95], a[88:91], v[28:31]
    ds_read_b128 a[8:11], v232 offset:4096
    v_mfma_f32_16x16x32_bf16 v[60:63], a[96:99], a[88:91], v[60:63]
    v_mfma_f32_16x16x32_bf16 v[56:59], a[96:99], a[84:87], v[56:59]
    ds_read_b128 a[12:15], v232 offset:6144
    v_mfma_f32_16x16x32_bf16 v[52:55], a[96:99], a[80:83], v[52:55]
    v_mfma_f32_16x16x32_bf16 v[48:51], a[96:99], a[76:79], v[48:51]
    ds_read_b128 a[16:19], v232 offset:8192
    v_mfma_f32_16x16x32_bf16 v[44:47], a[96:99], a[72:75], v[44:47]
    v_mfma_f32_16x16x32_bf16 v[40:43], a[96:99], a[68:71], v[40:43]
    ds_read_b128 a[20:23], v232 offset:10240
    v_mfma_f32_16x16x32_bf16 v[36:39], a[96:99], a[64:67], v[36:39]
    v_mfma_f32_16x16x32_bf16 v[32:35], a[96:99], a[60:63], v[32:35]
    ds_read_b128 a[24:27], v232 offset:12288
    v_mfma_f32_16x16x32_bf16 v[64:67], a[100:103], a[60:63], v[64:67]
    v_mfma_f32_16x16x32_bf16 v[68:71], a[100:103], a[64:67], v[68:71]
    ds_read_b128 a[28:31], v232 offset:14336
    v_mfma_f32_16x16x32_bf16 v[72:75], a[100:103], a[68:71], v[72:75]
    v_mfma_f32_16x16x32_bf16 v[76:79], a[100:103], a[72:75], v[76:79]
    ds_read_b64_tr_b16 a[36:37], v236 offset:32768
    v_mfma_f32_16x16x32_bf16 v[80:83], a[100:103], a[76:79], v[80:83]
    v_mfma_f32_16x16x32_bf16 v[84:87], a[100:103], a[80:83], v[84:87]
    ds_read_b64_tr_b16 a[38:39], v236 offset:36864
    v_mfma_f32_16x16x32_bf16 v[88:91], a[100:103], a[84:87], v[88:91]
    ds_read_b64_tr_b16 a[40:41], v235 offset:33280
    v_mfma_f32_16x16x32_bf16 v[92:95], a[100:103], a[88:91], v[92:95]
    v_mfma_f32_16x16x32_bf16 v[124:127], a[104:107], a[88:91], v[124:127]
    ds_read_b64_tr_b16 a[42:43], v235 offset:37376
    v_mfma_f32_16x16x32_bf16 v[120:123], a[104:107], a[84:87], v[120:123]
    v_mfma_f32_16x16x32_bf16 v[116:119], a[104:107], a[80:83], v[116:119]
    ds_read_b64_tr_b16 a[44:45], v236 offset:33280
    v_mfma_f32_16x16x32_bf16 v[112:115], a[104:107], a[76:79], v[112:115]
    v_mfma_f32_16x16x32_bf16 v[108:111], a[104:107], a[72:75], v[108:111]
    ds_read_b64_tr_b16 a[46:47], v236 offset:37376
    v_mfma_f32_16x16x32_bf16 v[104:107], a[104:107], a[68:71], v[104:107]
    v_mfma_f32_16x16x32_bf16 v[100:103], a[104:107], a[64:67], v[100:103]
    ds_read_b64_tr_b16 a[48:49], v235 offset:33792
    v_mfma_f32_16x16x32_bf16 v[96:99], a[104:107], a[60:63], v[96:99]
    v_mfma_f32_16x16x32_bf16 v[128:131], a[108:111], a[60:63], v[128:131]
    ds_read_b64_tr_b16 a[50:51], v235 offset:37888
    v_mfma_f32_16x16x32_bf16 v[132:135], a[108:111], a[64:67], v[132:135]
    v_mfma_f32_16x16x32_bf16 v[136:139], a[108:111], a[68:71], v[136:139]
    ds_read_b64_tr_b16 a[52:53], v236 offset:33792
    v_mfma_f32_16x16x32_bf16 v[140:143], a[108:111], a[72:75], v[140:143]
    v_mfma_f32_16x16x32_bf16 v[144:147], a[108:111], a[76:79], v[144:147]
    ds_read_b64_tr_b16 a[54:55], v236 offset:37888
    v_mfma_f32_16x16x32_bf16 v[148:151], a[108:111], a[80:83], v[148:151]
    v_mfma_f32_16x16x32_bf16 v[152:155], a[108:111], a[84:87], v[152:155]
    ds_read_b64_tr_b16 a[56:57], v237 offset:35840
    v_mfma_f32_16x16x32_bf16 v[156:159], a[108:111], a[88:91], v[156:159]
    v_mfma_f32_16x16x32_bf16 v[188:191], a[112:115], a[88:91], v[188:191]
    ds_read_b64_tr_b16 a[58:59], v237 offset:39936
    ds_write_b32 v238, v240
    v_mfma_f32_16x16x32_bf16 v[184:187], a[112:115], a[84:87], v[184:187]
    v_mfma_f32_16x16x32_bf16 v[180:183], a[112:115], a[80:83], v[180:183]
    ds_write_b32 v238, v248 offset:1024
    v_mfma_f32_16x16x32_bf16 v[176:179], a[112:115], a[76:79], v[176:179]
    v_mfma_f32_16x16x32_bf16 v[172:175], a[112:115], a[72:75], v[172:175]
    ds_write_b32 v238, v249 offset:2048
    v_mfma_f32_16x16x32_bf16 v[168:171], a[112:115], a[68:71], v[168:171]
    v_mfma_f32_16x16x32_bf16 v[164:167], a[112:115], a[64:67], v[164:167]
    v_mfma_f32_16x16x32_bf16 v[160:163], a[112:115], a[60:63], v[160:163]
    v_mfma_f32_16x16x32_bf16 v[192:195], a[116:119], a[60:63], v[192:195]
    v_mfma_f32_16x16x32_bf16 v[196:199], a[116:119], a[64:67], v[196:199]
    v_mfma_f32_16x16x32_bf16 v[200:203], a[116:119], a[68:71], v[200:203]
    v_mfma_f32_16x16x32_bf16 v[204:207], a[116:119], a[72:75], v[204:207]
    v_mfma_f32_16x16x32_bf16 v[208:211], a[116:119], a[76:79], v[208:211]
    v_mfma_f32_16x16x32_bf16 v[212:215], a[116:119], a[80:83], v[212:215]
    v_mfma_f32_16x16x32_bf16 v[216:219], a[116:119], a[84:87], v[216:219]
    v_mfma_f32_16x16x32_bf16 v[220:223], a[116:119], a[88:91], v[220:223]
    s_waitcnt vmcnt(4) lgkmcnt(0)
    s_barrier
    v_mfma_f32_16x16x32_bf16 v[0:3], a[32:35], a[0:3], v[0:3]
    ds_read_b64_tr_b16 a[92:93], v235 offset:49152
    v_mfma_f32_16x16x32_bf16 v[4:7], a[32:35], a[4:7], v[4:7]
    ds_read_b64_tr_b16 a[94:95], v235 offset:53248
    v_mfma_f32_16x16x32_bf16 v[8:11], a[32:35], a[8:11], v[8:11]
    s_lshl_b32 s52, s50, 14
    v_mfma_f32_16x16x32_bf16 v[12:15], a[32:35], a[12:15], v[12:15]
    ds_read_b128 a[60:63], v233 offset:0
    s_lshl_b32 s53, s48, 13
    v_mfma_f32_16x16x32_bf16 v[16:19], a[32:35], a[16:19], v[16:19]
    s_add_u32 s52, s52, s53
    v_mfma_f32_16x16x32_bf16 v[20:23], a[32:35], a[20:23], v[20:23]
    ds_read_b128 a[64:67], v233 offset:2048
    v_add_u32 v240, s52, v251
    v_mfma_f32_16x16x32_bf16 v[24:27], a[32:35], a[24:27], v[24:27]
    v_add_u32 v241, 4096, v240
    v_mfma_f32_16x16x32_bf16 v[28:31], a[32:35], a[28:31], v[28:31]
    ds_read_b128 a[68:71], v233 offset:4096
    s_lshl_b32 s53, s49, 9
    v_mfma_f32_16x16x32_bf16 v[60:63], a[36:39], a[28:31], v[60:63]
    s_add_u32 s52, s52, s53
    v_mfma_f32_16x16x32_bf16 v[56:59], a[36:39], a[24:27], v[56:59]
    ds_read_b128 a[72:75], v233 offset:6144
    v_lshrrev_b32 v242, 5, v250
    v_mfma_f32_16x16x32_bf16 v[52:55], a[36:39], a[20:23], v[52:55]
    v_lshl_add_u32 v242, v242, 8, s52
    v_mfma_f32_16x16x32_bf16 v[48:51], a[36:39], a[16:19], v[48:51]
    ds_read_b128 a[76:79], v233 offset:8192
    v_and_b32 v243, 15, v250
    v_mfma_f32_16x16x32_bf16 v[44:47], a[36:39], a[12:15], v[44:47]
    v_mfma_f32_16x16x32_bf16 v[40:43], a[36:39], a[8:11], v[40:43]
    ds_read_b128 a[80:83], v233 offset:10240
    v_lshl_add_u32 v242, v243, 4, v242
    v_mfma_f32_16x16x32_bf16 v[36:39], a[36:39], a[4:7], v[36:39]
    v_bfe_u32 v243, v250, 4, 1
    v_mfma_f32_16x16x32_bf16 v[32:35], a[36:39], a[0:3], v[32:35]
    ds_read_b128 a[84:87], v233 offset:12288
    v_lshl_add_u32 v242, v243, 3, v242
    v_mfma_f32_16x16x32_bf16 v[64:67], a[40:43], a[0:3], v[64:67]
    v_add_u32 v243, 4096, v242
    v_mfma_f32_16x16x32_bf16 v[68:71], a[40:43], a[4:7], v[68:71]
    ds_read_b128 a[88:91], v233 offset:14336
    s_mul_i32 s52, s41, 14
    v_mfma_f32_16x16x32_bf16 v[72:75], a[40:43], a[8:11], v[72:75]
    s_mul_i32 s53, s51, 6
    v_mfma_f32_16x16x32_bf16 v[76:79], a[40:43], a[12:15], v[76:79]
    ds_read_b64_tr_b16 a[96:97], v236 offset:49152
    s_mul_i32 s54, s49, 3
    v_mfma_f32_16x16x32_bf16 v[80:83], a[40:43], a[16:19], v[80:83]
    s_add_u32 s53, s53, s54
    v_mfma_f32_16x16x32_bf16 v[84:87], a[40:43], a[20:23], v[84:87]
    ds_read_b64_tr_b16 a[98:99], v236 offset:53248
    s_add_u32 s53, s53, s52
    v_mfma_f32_16x16x32_bf16 v[88:91], a[40:43], a[24:27], v[88:91]
    ds_read_b64_tr_b16 a[100:101], v235 offset:49664
    s_add_u32 s53, s53, 160
    v_mfma_f32_16x16x32_bf16 v[92:95], a[40:43], a[28:31], v[92:95]
    v_mfma_f32_16x16x32_bf16 v[124:127], a[44:47], a[28:31], v[124:127]
    ds_read_b64_tr_b16 a[102:103], v235 offset:53760
    s_lshl_b32 s53, s53, 17
    v_mfma_f32_16x16x32_bf16 v[120:123], a[44:47], a[24:27], v[120:123]
    s_add_u32 s54, s52, s51
    v_mfma_f32_16x16x32_bf16 v[116:119], a[44:47], a[20:23], v[116:119]
    ds_read_b64_tr_b16 a[104:105], v236 offset:49664
    s_add_u32 s54, s54, 172
    v_mfma_f32_16x16x32_bf16 v[112:115], a[44:47], a[16:19], v[112:115]
    s_lshl_b32 s54, s54, 17
    v_mfma_f32_16x16x32_bf16 v[108:111], a[44:47], a[12:15], v[108:111]
    ds_read_b64_tr_b16 a[106:107], v236 offset:53760
    s_add_u32 s55, s53, 131072
    v_mfma_f32_16x16x32_bf16 v[104:107], a[44:47], a[8:11], v[104:107]
    s_add_u32 s56, s53, 262144
    v_mfma_f32_16x16x32_bf16 v[100:103], a[44:47], a[4:7], v[100:103]
    ds_read_b64_tr_b16 a[108:109], v235 offset:50176
    s_lshl_b32 s57, s100, 18
    v_mfma_f32_16x16x32_bf16 v[96:99], a[44:47], a[0:3], v[96:99]
    s_add_u32 s57, s57, 8388608
    v_mfma_f32_16x16x32_bf16 v[128:131], a[48:51], a[0:3], v[128:131]
    ds_read_b64_tr_b16 a[110:111], v235 offset:54272
    v_mfma_f32_16x16x32_bf16 v[132:135], a[48:51], a[4:7], v[132:135]
    s_add_u32 s16, s4, s57
    s_addc_u32 s17, s5, 0
    s_mov_b32 s18, 262144
    v_mfma_f32_16x16x32_bf16 v[136:139], a[48:51], a[8:11], v[136:139]
    ds_read_b64_tr_b16 a[112:113], v236 offset:50176
    v_mfma_f32_16x16x32_bf16 v[140:143], a[48:51], a[12:15], v[140:143]
    s_lshl_b32 s90, 0x01010101, s50
    v_mfma_f32_16x16x32_bf16 v[144:147], a[48:51], a[16:19], v[144:147]
    ds_read_b64_tr_b16 a[114:115], v236 offset:54272
    s_mov_b32 s91, 0
    v_mfma_f32_16x16x32_bf16 v[148:151], a[48:51], a[20:23], v[148:151]
    s_mul_i32 s57, s49, 448
    v_mfma_f32_16x16x32_bf16 v[152:155], a[48:51], a[24:27], v[152:155]
    ds_read_b64_tr_b16 a[116:117], v237 offset:52224
    s_add_u32 s57, s57, 90112
    v_mfma_f32_16x16x32_bf16 v[156:159], a[48:51], a[28:31], v[156:159]
    v_and_b32 v248, 48, v250
    v_mfma_f32_16x16x32_bf16 v[188:191], a[52:55], a[28:31], v[188:191]
    ds_read_b64_tr_b16 a[118:119], v237 offset:56320
    v_add_u32 v248, s57, v248
    v_mfma_f32_16x16x32_bf16 v[184:187], a[52:55], a[24:27], v[184:187]
    s_lshl_b32 s52, s48, 9
    v_mfma_f32_16x16x32_bf16 v[180:183], a[52:55], a[20:23], v[180:183]
    s_add_u32 s52, s52, 91136
    v_mfma_f32_16x16x32_bf16 v[176:179], a[52:55], a[16:19], v[176:179]
    v_and_b32 v249, 15, v250
    v_mfma_f32_16x16x32_bf16 v[172:175], a[52:55], a[12:15], v[172:175]
    s_add_u32 s96, s97, s45
    v_lshl_add_u32 v249, v249, 2, s52
    v_mfma_f32_16x16x32_bf16 v[168:171], a[52:55], a[8:11], v[168:171]
    v_mfma_f32_16x16x32_bf16 v[164:167], a[52:55], a[4:7], v[164:167]
    s_add_u32 s97, s97, 32768
    v_mfma_f32_16x16x32_bf16 v[160:163], a[52:55], a[0:3], v[160:163]
    v_mfma_f32_16x16x32_bf16 v[192:195], a[56:59], a[0:3], v[192:195]
    s_cmp_eq_u32 s97, 98304
    s_cselect_b32 s97, 0, s97
    v_mfma_f32_16x16x32_bf16 v[196:199], a[56:59], a[4:7], v[196:199]
    v_mfma_f32_16x16x32_bf16 v[200:203], a[56:59], a[8:11], v[200:203]
    v_add_u32 v232, s97, v234
    v_mfma_f32_16x16x32_bf16 v[204:207], a[56:59], a[12:15], v[204:207]
    v_mfma_f32_16x16x32_bf16 v[208:211], a[56:59], a[16:19], v[208:211]
    v_xor_b32 v233, 64, v232
    v_mfma_f32_16x16x32_bf16 v[212:215], a[56:59], a[20:23], v[212:215]
    v_mfma_f32_16x16x32_bf16 v[216:219], a[56:59], a[24:27], v[216:219]
    v_mfma_f32_16x16x32_bf16 v[220:223], a[56:59], a[28:31], v[220:223]
    s_waitcnt vmcnt(0) lgkmcnt(0)
    s_barrier
    v_mfma_f32_16x16x32_bf16 v[0:3], a[92:95], a[60:63], v[0:3]
    v_mfma_f32_16x16x32_bf16 v[4:7], a[92:95], a[64:67], v[4:7]
    v_mfma_f32_16x16x32_bf16 v[8:11], a[92:95], a[68:71], v[8:11]
    ds_read_b32 v224, v249 offset:0
    v_mfma_f32_16x16x32_bf16 v[12:15], a[92:95], a[72:75], v[12:15]
    v_mfma_f32_16x16x32_bf16 v[16:19], a[92:95], a[76:79], v[16:19]
    ds_read_b32 v226, v249 offset:64
    v_mfma_f32_16x16x32_bf16 v[20:23], a[92:95], a[80:83], v[20:23]
    v_mfma_f32_16x16x32_bf16 v[24:27], a[92:95], a[84:87], v[24:27]
    ds_read_b32 v228, v249 offset:128
    v_mfma_f32_16x16x32_bf16 v[28:31], a[92:95], a[88:91], v[28:31]
    v_mfma_f32_16x16x32_bf16 v[60:63], a[96:99], a[88:91], v[60:63]
    ds_read_b32 v230, v249 offset:192
    v_mfma_f32_16x16x32_bf16 v[56:59], a[96:99], a[84:87], v[56:59]
    v_mfma_f32_16x16x32_bf16 v[52:55], a[96:99], a[80:83], v[52:55]
    ds_read_b32 v232, v249 offset:256
    v_mfma_f32_16x16x32_bf16 v[48:51], a[96:99], a[76:79], v[48:51]
    v_mfma_f32_16x16x32_bf16 v[44:47], a[96:99], a[72:75], v[44:47]
    ds_read_b32 v234, v249 offset:320
    v_mfma_f32_16x16x32_bf16 v[40:43], a[96:99], a[68:71], v[40:43]
    v_mfma_f32_16x16x32_bf16 v[36:39], a[96:99], a[64:67], v[36:39]
    ds_read_b32 v236, v249 offset:384
    v_mfma_f32_16x16x32_bf16 v[32:35], a[96:99], a[60:63], v[32:35]
    v_mfma_f32_16x16x32_bf16 v[64:67], a[100:103], a[60:63], v[64:67]
    ds_read_b32 v238, v249 offset:448
    v_mfma_f32_16x16x32_bf16 v[68:71], a[100:103], a[64:67], v[68:71]
    v_mfma_f32_16x16x32_bf16 v[72:75], a[100:103], a[68:71], v[72:75]
    ds_read_b128 v[244:247], v248 offset:384
    v_mfma_f32_16x16x32_bf16 v[76:79], a[100:103], a[72:75], v[76:79]
    v_mfma_f32_16x16x32_bf16 v[80:83], a[100:103], a[76:79], v[80:83]
    v_mfma_f32_16x16x32_bf16 v[84:87], a[100:103], a[80:83], v[84:87]
    v_mfma_f32_16x16x32_bf16 v[88:91], a[100:103], a[84:87], v[88:91]
    v_mfma_f32_16x16x32_bf16 v[92:95], a[100:103], a[88:91], v[92:95]
    v_mfma_f32_16x16x32_bf16 v[124:127], a[104:107], a[88:91], v[124:127]
    v_mfma_f32_16x16x32_bf16 v[120:123], a[104:107], a[84:87], v[120:123]
    v_mfma_f32_16x16x32_bf16 v[116:119], a[104:107], a[80:83], v[116:119]
    v_mfma_f32_16x16x32_bf16 v[112:115], a[104:107], a[76:79], v[112:115]
    v_mfma_f32_16x16x32_bf16 v[108:111], a[104:107], a[72:75], v[108:111]
    v_mfma_f32_16x16x32_bf16 v[104:107], a[104:107], a[68:71], v[104:107]
    v_mfma_f32_16x16x32_bf16 v[100:103], a[104:107], a[64:67], v[100:103]
    v_mfma_f32_16x16x32_bf16 v[96:99], a[104:107], a[60:63], v[96:99]
    v_mfma_f32_16x16x32_bf16 v[128:131], a[108:111], a[60:63], v[128:131]
    v_mfma_f32_16x16x32_bf16 v[132:135], a[108:111], a[64:67], v[132:135]
    v_mfma_f32_16x16x32_bf16 v[136:139], a[108:111], a[68:71], v[136:139]
    v_mfma_f32_16x16x32_bf16 v[140:143], a[108:111], a[72:75], v[140:143]
    v_mfma_f32_16x16x32_bf16 v[144:147], a[108:111], a[76:79], v[144:147]
    v_mfma_f32_16x16x32_bf16 v[148:151], a[108:111], a[80:83], v[148:151]
    v_mfma_f32_16x16x32_bf16 v[152:155], a[108:111], a[84:87], v[152:155]
    v_mfma_f32_16x16x32_bf16 v[156:159], a[108:111], a[88:91], v[156:159]
    v_mfma_f32_16x16x32_bf16 v[188:191], a[112:115], a[88:91], v[188:191]
    v_mfma_f32_16x16x32_bf16 v[184:187], a[112:115], a[84:87], v[184:187]
    v_mfma_f32_16x16x32_bf16 v[180:183], a[112:115], a[80:83], v[180:183]
    v_mfma_f32_16x16x32_bf16 v[176:179], a[112:115], a[76:79], v[176:179]
    v_mfma_f32_16x16x32_bf16 v[172:175], a[112:115], a[72:75], v[172:175]
    v_mfma_f32_16x16x32_bf16 v[168:171], a[112:115], a[68:71], v[168:171]
    v_mfma_f32_16x16x32_bf16 v[164:167], a[112:115], a[64:67], v[164:167]
    v_mfma_f32_16x16x32_bf16 v[160:163], a[112:115], a[60:63], v[160:163]
    v_mfma_f32_16x16x32_bf16 v[192:195], a[116:119], a[60:63], v[192:195]
    v_mfma_f32_16x16x32_bf16 v[196:199], a[116:119], a[64:67], v[196:199]
    v_mfma_f32_16x16x32_bf16 v[200:203], a[116:119], a[68:71], v[200:203]
    v_mfma_f32_16x16x32_bf16 v[204:207], a[116:119], a[72:75], v[204:207]
    v_mfma_f32_16x16x32_bf16 v[208:211], a[116:119], a[76:79], v[208:211]
    v_mfma_f32_16x16x32_bf16 v[212:215], a[116:119], a[80:83], v[212:215]
    v_mfma_f32_16x16x32_bf16 v[216:219], a[116:119], a[84:87], v[216:219]
    v_mfma_f32_16x16x32_bf16 v[220:223], a[116:119], a[88:91], v[220:223]
    s_nop 0
    s_mov_b32 s49, s53
    s_mov_b32 s50, s54
    s_mov_b32 s101, s92
    s_add_u32 s24, s4, 0
    s_addc_u32 s25, s5, 0
    s_mov_b32 s26, 36700160
    s_mov_b32 s27, 0x00020000
    s_waitcnt lgkmcnt(0)
    v_pk_fma_f32 v[192:193], v[244:245], v[224:225], v[192:193] op_sel_hi:[1,0,1]
    v_pk_fma_f32 v[194:195], v[246:247], v[224:225], v[194:195] op_sel_hi:[1,0,1]
    v_cvt_pk_bf16_f32 v192, v192, v193
    v_cvt_pk_bf16_f32 v193, v194, v195
    v_pk_max_i16 v192, v192, 0
    v_pk_max_i16 v193, v193, 0
    v_accvgpr_write_b32 a0, v192
    v_accvgpr_write_b32 a1, v193
    v_pk_fma_f32 v[196:197], v[244:245], v[226:227], v[196:197] op_sel_hi:[1,0,1]
    v_pk_fma_f32 v[198:199], v[246:247], v[226:227], v[198:199] op_sel_hi:[1,0,1]
    v_cvt_pk_bf16_f32 v196, v196, v197
    v_cvt_pk_bf16_f32 v197, v198, v199
    v_pk_max_i16 v196, v196, 0
    v_pk_max_i16 v197, v197, 0
    v_accvgpr_write_b32 a4, v196
    v_accvgpr_write_b32 a5, v197
    ds_read_b64 v[194:195], v248 offset:64
    ds_read_b64 v[198:199], v248 offset:72
    v_pk_fma_f32 v[200:201], v[244:245], v[228:229], v[200:201] op_sel_hi:[1,0,1]
    v_pk_fma_f32 v[202:203], v[246:247], v[228:229], v[202:203] op_sel_hi:[1,0,1]
    v_cvt_pk_bf16_f32 v200, v200, v201
    v_cvt_pk_bf16_f32 v201, v202, v203
    v_pk_max_i16 v200, v200, 0
    v_pk_max_i16 v201, v201, 0
    v_accvgpr_write_b32 a8, v200
    v_accvgpr_write_b32 a9, v201
    v_pk_fma_f32 v[204:205], v[244:245], v[230:231], v[204:205] op_sel_hi:[1,0,1]
    v_pk_fma_f32 v[206:207], v[246:247], v[230:231], v[206:207] op_sel_hi:[1,0,1]
    v_cvt_pk_bf16_f32 v204, v204, v205
    v_cvt_pk_bf16_f32 v205, v206, v207
    v_pk_max_i16 v204, v204, 0
    v_pk_max_i16 v205, v205, 0
    v_accvgpr_write_b32 a12, v204
    v_accvgpr_write_b32 a13, v205
    ds_read_b64 v[202:203], v248 offset:0
    ds_read_b64 v[206:207], v248 offset:8
    v_pk_fma_f32 v[208:209], v[244:245], v[232:233], v[208:209] op_sel_hi:[1,0,1]
    v_pk_fma_f32 v[210:211], v[246:247], v[232:233], v[210:211] op_sel_hi:[1,0,1]
    v_cvt_pk_bf16_f32 v208, v208, v209
    v_cvt_pk_bf16_f32 v209, v210, v211
    v_pk_max_i16 v208, v208, 0
    v_pk_max_i16 v209, v209, 0
    v_accvgpr_write_b32 a16, v208
    v_accvgpr_write_b32 a17, v209
    v_pk_fma_f32 v[212:213], v[244:245], v[234:235], v[212:213] op_sel_hi:[1,0,1]
    v_pk_fma_f32 v[214:215], v[246:247], v[234:235], v[214:215] op_sel_hi:[1,0,1]
    v_cvt_pk_bf16_f32 v212, v212, v213
    v_cvt_pk_bf16_f32 v213, v214, v215
    v_pk_max_i16 v212, v212, 0
    v_pk_max_i16 v213, v213, 0
    v_accvgpr_write_b32 a20, v212
    v_accvgpr_write_b32 a21, v213
    v_pk_fma_f32 v[216:217], v[244:245], v[236:237], v[216:217] op_sel_hi:[1,0,1]
    v_pk_fma_f32 v[218:219], v[246:247], v[236:237], v[218:219] op_sel_hi:[1,0,1]
    v_cvt_pk_bf16_f32 v216, v216, v217
    v_cvt_pk_bf16_f32 v217, v218, v219
    v_pk_max_i16 v216, v216, 0
    v_pk_max_i16 v217, v217, 0
    v_accvgpr_write_b32 a24, v216
    v_accvgpr_write_b32 a25, v217
    v_pk_fma_f32 v[220:221], v[244:245], v[238:239], v[220:221] op_sel_hi:[1,0,1]
    v_pk_fma_f32 v[222:223], v[246:247], v[238:239], v[222:223] op_sel_hi:[1,0,1]
    v_cvt_pk_bf16_f32 v220, v220, v221
    v_cvt_pk_bf16_f32 v221, v222, v223
    v_pk_max_i16 v220, v220, 0
    v_pk_max_i16 v221, v221, 0
    v_accvgpr_write_b32 a28, v220
    v_accvgpr_write_b32 a29, v221
    ds_read_b64 v[210:211], v248 offset:128
    ds_read_b64 v[214:215], v248 offset:136
    ds_read_b64 v[218:219], v248 offset:192
    ds_read_b64 v[222:223], v248 offset:200
    ds_read_b128 v[244:247], v248 offset:256
    s_waitcnt lgkmcnt(5)
    v_pk_fma_f32 v[0:1], v[202:203], v[224:225], v[0:1] op_sel_hi:[1,0,1]
    v_pk_fma_f32 v[2:3], v[206:207], v[224:225], v[2:3] op_sel_hi:[1,0,1]
    v_pk_fma_f32 v[32:33], v[194:195], v[224:225], v[32:33] op_sel_hi:[1,0,1]
    v_pk_fma_f32 v[34:35], v[198:199], v[224:225], v[34:35] op_sel_hi:[1,0,1]
    v_cvt_pk_bf16_f32 v0, v0, v1
    v_cvt_pk_bf16_f32 v1, v2, v3
    v_cvt_pk_bf16_f32 v2, v32, v33
    v_cvt_pk_bf16_f32 v3, v34, v35
    v_pk_max_i16 v32, v0, 0
    v_pk_max_i16 v33, v1, 0
    v_pk_max_i16 v34, v2, 0
    v_pk_max_i16 v35, v3, 0
    v_pk_fma_f32 v[4:5], v[202:203], v[226:227], v[4:5] op_sel_hi:[1,0,1]
    v_pk_fma_f32 v[6:7], v[206:207], v[226:227], v[6:7] op_sel_hi:[1,0,1]
    v_pk_fma_f32 v[36:37], v[194:195], v[226:227], v[36:37] op_sel_hi:[1,0,1]
    v_pk_fma_f32 v[38:39], v[198:199], v[226:227], v[38:39] op_sel_hi:[1,0,1]
    v_cvt_pk_bf16_f32 v4, v4, v5
    v_cvt_pk_bf16_f32 v5, v6, v7
    v_cvt_pk_bf16_f32 v6, v36, v37
    v_cvt_pk_bf16_f32 v7, v38, v39
    v_pk_max_i16 v36, v4, 0
    v_pk_max_i16 v37, v5, 0
    v_pk_max_i16 v38, v6, 0
    v_pk_max_i16 v39, v7, 0
    v_pk_fma_f32 v[8:9], v[202:203], v[228:229], v[8:9] op_sel_hi:[1,0,1]
    v_pk_fma_f32 v[10:11], v[206:207], v[228:229], v[10:11] op_sel_hi:[1,0,1]
    v_pk_fma_f32 v[40:41], v[194:195], v[228:229], v[40:41] op_sel_hi:[1,0,1]
    v_pk_fma_f32 v[42:43], v[198:199], v[228:229], v[42:43] op_sel_hi:[1,0,1]
    v_cvt_pk_bf16_f32 v8, v8, v9
    v_cvt_pk_bf16_f32 v9, v10, v11
    v_cvt_pk_bf16_f32 v10, v40, v41
    v_cvt_pk_bf16_f32 v11, v42, v43
    v_pk_max_i16 v40, v8, 0
    v_pk_max_i16 v41, v9, 0
    v_pk_max_i16 v42, v10, 0
    v_pk_max_i16 v43, v11, 0
    v_accvgpr_write_b32 a32, v40
    v_accvgpr_write_b32 a33, v41
    v_accvgpr_write_b32 a34, v42
    v_accvgpr_write_b32 a35, v43
    v_pk_fma_f32 v[12:13], v[202:203], v[230:231], v[12:13] op_sel_hi:[1,0,1]
    v_pk_fma_f32 v[14:15], v[206:207], v[230:231], v[14:15] op_sel_hi:[1,0,1]
    v_pk_fma_f32 v[44:45], v[194:195], v[230:231], v[44:45] op_sel_hi:[1,0,1]
    v_pk_fma_f32 v[46:47], v[198:199], v[230:231], v[46:47] op_sel_hi:[1,0,1]
    v_cvt_pk_bf16_f32 v12, v12, v13
    v_cvt_pk_bf16_f32 v13, v14, v15
    v_cvt_pk_bf16_f32 v14, v44, v45
    v_cvt_pk_bf16_f32 v15, v46, v47
    v_pk_max_i16 v44, v12, 0
    v_pk_max_i16 v45, v13, 0
    v_pk_max_i16 v46, v14, 0
    v_pk_max_i16 v47, v15, 0
    v_accvgpr_write_b32 a36, v44
    v_accvgpr_write_b32 a37, v45
    v_accvgpr_write_b32 a38, v46
    v_accvgpr_write_b32 a39, v47
    v_pk_fma_f32 v[16:17], v[202:203], v[232:233], v[16:17] op_sel_hi:[1,0,1]
    v_pk_fma_f32 v[18:19], v[206:207], v[232:233], v[18:19] op_sel_hi:[1,0,1]
    v_pk_fma_f32 v[48:49], v[194:195], v[232:233], v[48:49] op_sel_hi:[1,0,1]
    v_pk_fma_f32 v[50:51], v[198:199], v[232:233], v[50:51] op_sel_hi:[1,0,1]
    v_cvt_pk_bf16_f32 v16, v16, v17
    v_cvt_pk_bf16_f32 v17, v18, v19
    v_cvt_pk_bf16_f32 v18, v48, v49
    v_cvt_pk_bf16_f32 v19, v50, v51
    v_pk_max_i16 v48, v16, 0
    v_pk_max_i16 v49, v17, 0
    v_pk_max_i16 v50, v18, 0
    v_pk_max_i16 v51, v19, 0
    v_accvgpr_write_b32 a40, v48
    v_accvgpr_write_b32 a41, v49
    v_accvgpr_write_b32 a42, v50
    v_accvgpr_write_b32 a43, v51
    v_pk_fma_f32 v[20:21], v[202:203], v[234:235], v[20:21] op_sel_hi:[1,0,1]
    v_pk_fma_f32 v[22:23], v[206:207], v[234:235], v[22:23] op_sel_hi:[1,0,1]
    v_pk_fma_f32 v[52:53], v[194:195], v[234:235], v[52:53] op_sel_hi:[1,0,1]
    v_pk_fma_f32 v[54:55], v[198:199], v[234:235], v[54:55] op_sel_hi:[1,0,1]
    v_cvt_pk_bf16_f32 v20, v20, v21
    v_cvt_pk_bf16_f32 v21, v22, v23
    v_cvt_pk_bf16_f32 v22, v52, v53
    v_cvt_pk_bf16_f32 v23, v54, v55
    v_pk_max_i16 v52, v20, 0
    v_pk_max_i16 v53, v21, 0
    v_pk_max_i16 v54, v22, 0
    v_pk_max_i16 v55, v23, 0
    v_accvgpr_write_b32 a44, v52
    v_accvgpr_write_b32 a45, v53
    v_accvgpr_write_b32 a46, v54
    v_accvgpr_write_b32 a47, v55
    v_pk_fma_f32 v[24:25], v[202:203], v[236:237], v[24:25] op_sel_hi:[1,0,1]
    v_pk_fma_f32 v[26:27], v[206:207], v[236:237], v[26:27] op_sel_hi:[1,0,1]
    v_pk_fma_f32 v[56:57], v[194:195], v[236:237], v[56:57] op_sel_hi:[1,0,1]
    v_pk_fma_f32 v[58:59], v[198:199], v[236:237], v[58:59] op_sel_hi:[1,0,1]
    v_cvt_pk_bf16_f32 v24, v24, v25
    v_cvt_pk_bf16_f32 v25, v26, v27
    v_cvt_pk_bf16_f32 v26, v56, v57
    v_cvt_pk_bf16_f32 v27, v58, v59
    v_pk_max_i16 v56, v24, 0
    v_pk_max_i16 v57, v25, 0
    v_pk_max_i16 v58, v26, 0
    v_pk_max_i16 v59, v27, 0
    v_accvgpr_write_b32 a48, v56
    v_accvgpr_write_b32 a49, v57
    v_accvgpr_write_b32 a50, v58
    v_accvgpr_write_b32 a51, v59
    v_pk_fma_f32 v[28:29], v[202:203], v[238:239], v[28:29] op_sel_hi:[1,0,1]
    v_pk_fma_f32 v[30:31], v[206:207], v[238:239], v[30:31] op_sel_hi:[1,0,1]
    v_pk_fma_f32 v[60:61], v[194:195], v[238:239], v[60:61] op_sel_hi:[1,0,1]
    v_pk_fma_f32 v[62:63], v[198:199], v[238:239], v[62:63] op_sel_hi:[1,0,1]
    v_cvt_pk_bf16_f32 v28, v28, v29
    v_cvt_pk_bf16_f32 v29, v30, v31
    v_cvt_pk_bf16_f32 v30, v60, v61
    v_cvt_pk_bf16_f32 v31, v62, v63
    v_pk_max_i16 v60, v28, 0
    v_pk_max_i16 v61, v29, 0
    v_pk_max_i16 v62, v30, 0
    v_pk_max_i16 v63, v31, 0
    v_accvgpr_write_b32 a52, v60
    v_accvgpr_write_b32 a53, v61
    v_accvgpr_write_b32 a54, v62
    v_accvgpr_write_b32 a55, v63
    s_waitcnt lgkmcnt(0)
    ds_read_b64 v[194:195], v248 offset:320
    ds_read_b64 v[198:199], v248 offset:328
    v_pk_fma_f32 v[64:65], v[210:211], v[224:225], v[64:65] op_sel_hi:[1,0,1]
    v_pk_fma_f32 v[66:67], v[214:215], v[224:225], v[66:67] op_sel_hi:[1,0,1]
    v_pk_fma_f32 v[96:97], v[218:219], v[224:225], v[96:97] op_sel_hi:[1,0,1]
    v_pk_fma_f32 v[98:99], v[222:223], v[224:225], v[98:99] op_sel_hi:[1,0,1]
    v_cvt_pk_bf16_f32 v64, v64, v65
    v_cvt_pk_bf16_f32 v65, v66, v67
    v_cvt_pk_bf16_f32 v66, v96, v97
    v_cvt_pk_bf16_f32 v67, v98, v99
    v_pk_max_i16 v96, v64, 0
    v_pk_max_i16 v97, v65, 0
    v_pk_max_i16 v98, v66, 0
    v_pk_max_i16 v99, v67, 0
    v_accvgpr_write_b32 a56, v96
    v_accvgpr_write_b32 a57, v97
    v_accvgpr_write_b32 a58, v98
    v_accvgpr_write_b32 a59, v99
    v_pk_fma_f32 v[68:69], v[210:211], v[226:227], v[68:69] op_sel_hi:[1,0,1]
    v_pk_fma_f32 v[70:71], v[214:215], v[226:227], v[70:71] op_sel_hi:[1,0,1]
    v_pk_fma_f32 v[100:101], v[218:219], v[226:227], v[100:101] op_sel_hi:[1,0,1]
    v_pk_fma_f32 v[102:103], v[222:223], v[226:227], v[102:103] op_sel_hi:[1,0,1]
    v_cvt_pk_bf16_f32 v68, v68, v69
    v_cvt_pk_bf16_f32 v69, v70, v71
    v_cvt_pk_bf16_f32 v70, v100, v101
    v_cvt_pk_bf16_f32 v71, v102, v103
    v_pk_max_i16 v100, v68, 0
    v_pk_max_i16 v101, v69, 0
    v_pk_max_i16 v102, v70, 0
    v_pk_max_i16 v103, v71, 0
    v_accvgpr_write_b32 a60, v100
    v_accvgpr_write_b32 a61, v101
    v_accvgpr_write_b32 a62, v102
    v_accvgpr_write_b32 a63, v103
    v_pk_fma_f32 v[72:73], v[210:211], v[228:229], v[72:73] op_sel_hi:[1,0,1]
    v_pk_fma_f32 v[74:75], v[214:215], v[228:229], v[74:75] op_sel_hi:[1,0,1]
    v_pk_fma_f32 v[104:105], v[218:219], v[228:229], v[104:105] op_sel_hi:[1,0,1]
    v_pk_fma_f32 v[106:107], v[222:223], v[228:229], v[106:107] op_sel_hi:[1,0,1]
    v_cvt_pk_bf16_f32 v72, v72, v73
    v_cvt_pk_bf16_f32 v73, v74, v75
    v_cvt_pk_bf16_f32 v74, v104, v105
    v_cvt_pk_bf16_f32 v75, v106, v107
    v_pk_max_i16 v104, v72, 0
    v_pk_max_i16 v105, v73, 0
    v_pk_max_i16 v106, v74, 0
    v_pk_max_i16 v107, v75, 0
    v_accvgpr_write_b32 a64, v104
    v_accvgpr_write_b32 a65, v105
    v_accvgpr_write_b32 a66, v106
    v_accvgpr_write_b32 a67, v107
    v_pk_fma_f32 v[76:77], v[210:211], v[230:231], v[76:77] op_sel_hi:[1,0,1]
    v_pk_fma_f32 v[78:79], v[214:215], v[230:231], v[78:79] op_sel_hi:[1,0,1]
    v_pk_fma_f32 v[108:109], v[218:219], v[230:231], v[108:109] op_sel_hi:[1,0,1]
    v_pk_fma_f32 v[110:111], v[222:223], v[230:231], v[110:111] op_sel_hi:[1,0,1]
    v_cvt_pk_bf16_f32 v76, v76, v77
    v_cvt_pk_bf16_f32 v77, v78, v79
    v_cvt_pk_bf16_f32 v78, v108, v109
    v_cvt_pk_bf16_f32 v79, v110, v111
    v_pk_max_i16 v108, v76, 0
    v_pk_max_i16 v109, v77, 0
    v_pk_max_i16 v110, v78, 0
    v_pk_max_i16 v111, v79, 0
    v_accvgpr_write_b32 a68, v108
    v_accvgpr_write_b32 a69, v109
    v_accvgpr_write_b32 a70, v110
    v_accvgpr_write_b32 a71, v111
    v_pk_fma_f32 v[80:81], v[210:211], v[232:233], v[80:81] op_sel_hi:[1,0,1]
    v_pk_fma_f32 v[82:83], v[214:215], v[232:233], v[82:83] op_sel_hi:[1,0,1]
    v_pk_fma_f32 v[112:113], v[218:219], v[232:233], v[112:113] op_sel_hi:[1,0,1]
    v_pk_fma_f32 v[114:115], v[222:223], v[232:233], v[114:115] op_sel_hi:[1,0,1]
    v_cvt_pk_bf16_f32 v80, v80, v81
    v_cvt_pk_bf16_f32 v81, v82, v83
    v_cvt_pk_bf16_f32 v82, v112, v113
    v_cvt_pk_bf16_f32 v83, v114, v115
    v_pk_max_i16 v112, v80, 0
    v_pk_max_i16 v113, v81, 0
    v_pk_max_i16 v114, v82, 0
    v_pk_max_i16 v115, v83, 0
    v_accvgpr_write_b32 a72, v112
    v_accvgpr_write_b32 a73, v113
    v_accvgpr_write_b32 a74, v114
    v_accvgpr_write_b32 a75, v115
    buffer_load_dwordx2 v[254:255], v253, s[8:11], 0 offen sc1
    v_pk_fma_f32 v[84:85], v[210:211], v[234:235], v[84:85] op_sel_hi:[1,0,1]
    v_pk_fma_f32 v[86:87], v[214:215], v[234:235], v[86:87] op_sel_hi:[1,0,1]
    v_pk_fma_f32 v[116:117], v[218:219], v[234:235], v[116:117] op_sel_hi:[1,0,1]
    v_pk_fma_f32 v[118:119], v[222:223], v[234:235], v[118:119] op_sel_hi:[1,0,1]
    v_cvt_pk_bf16_f32 v84, v84, v85
    v_cvt_pk_bf16_f32 v85, v86, v87
    v_cvt_pk_bf16_f32 v86, v116, v117
    v_cvt_pk_bf16_f32 v87, v118, v119
    v_pk_max_i16 v116, v84, 0
    v_pk_max_i16 v117, v85, 0
    v_pk_max_i16 v118, v86, 0
    v_pk_max_i16 v119, v87, 0
    v_accvgpr_write_b32 a76, v116
    v_accvgpr_write_b32 a77, v117
    v_accvgpr_write_b32 a78, v118
    v_accvgpr_write_b32 a79, v119
    v_pk_fma_f32 v[88:89], v[210:211], v[236:237], v[88:89] op_sel_hi:[1,0,1]
    v_pk_fma_f32 v[90:91], v[214:215], v[236:237], v[90:91] op_sel_hi:[1,0,1]
    v_pk_fma_f32 v[120:121], v[218:219], v[236:237], v[120:121] op_sel_hi:[1,0,1]
    v_pk_fma_f32 v[122:123], v[222:223], v[236:237], v[122:123] op_sel_hi:[1,0,1]
    v_cvt_pk_bf16_f32 v88, v88, v89
    v_cvt_pk_bf16_f32 v89, v90, v91
    v_cvt_pk_bf16_f32 v90, v120, v121
    v_cvt_pk_bf16_f32 v91, v122, v123
    v_pk_max_i16 v120, v88, 0
    v_pk_max_i16 v121, v89, 0
    v_pk_max_i16 v122, v90, 0
    v_pk_max_i16 v123, v91, 0
    v_accvgpr_write_b32 a80, v120
    v_accvgpr_write_b32 a81, v121
    v_accvgpr_write_b32 a82, v122
    v_accvgpr_write_b32 a83, v123
    v_pk_fma_f32 v[92:93], v[210:211], v[238:239], v[92:93] op_sel_hi:[1,0,1]
    v_pk_fma_f32 v[94:95], v[214:215], v[238:239], v[94:95] op_sel_hi:[1,0,1]
    v_pk_fma_f32 v[124:125], v[218:219], v[238:239], v[124:125] op_sel_hi:[1,0,1]
    v_pk_fma_f32 v[126:127], v[222:223], v[238:239], v[126:127] op_sel_hi:[1,0,1]
    v_cvt_pk_bf16_f32 v92, v92, v93
    v_cvt_pk_bf16_f32 v93, v94, v95
    v_cvt_pk_bf16_f32 v94, v124, v125
    v_cvt_pk_bf16_f32 v95, v126, v127
    v_pk_max_i16 v124, v92, 0
    v_pk_max_i16 v125, v93, 0
    v_pk_max_i16 v126, v94, 0
    v_pk_max_i16 v127, v95, 0
    v_accvgpr_write_b32 a84, v124
    v_accvgpr_write_b32 a85, v125
    v_accvgpr_write_b32 a86, v126
    v_accvgpr_write_b32 a87, v127
    s_waitcnt lgkmcnt(0)
    v_pk_fma_f32 v[128:129], v[244:245], v[224:225], v[128:129] op_sel_hi:[1,0,1]
    v_pk_fma_f32 v[130:131], v[246:247], v[224:225], v[130:131] op_sel_hi:[1,0,1]
    v_pk_fma_f32 v[160:161], v[194:195], v[224:225], v[160:161] op_sel_hi:[1,0,1]
    v_pk_fma_f32 v[162:163], v[198:199], v[224:225], v[162:163] op_sel_hi:[1,0,1]
    v_cvt_pk_bf16_f32 v128, v128, v129
    v_cvt_pk_bf16_f32 v129, v130, v131
    v_cvt_pk_bf16_f32 v130, v160, v161
    v_cvt_pk_bf16_f32 v131, v162, v163
    v_pk_max_i16 v160, v128, 0
    v_pk_max_i16 v161, v129, 0
    v_pk_max_i16 v162, v130, 0
    v_pk_max_i16 v163, v131, 0
    v_accvgpr_write_b32 a88, v160
    v_accvgpr_write_b32 a89, v161
    v_accvgpr_write_b32 a90, v162
    v_accvgpr_write_b32 a91, v163
    v_pk_fma_f32 v[132:133], v[244:245], v[226:227], v[132:133] op_sel_hi:[1,0,1]
    v_pk_fma_f32 v[134:135], v[246:247], v[226:227], v[134:135] op_sel_hi:[1,0,1]
    v_pk_fma_f32 v[164:165], v[194:195], v[226:227], v[164:165] op_sel_hi:[1,0,1]
    v_pk_fma_f32 v[166:167], v[198:199], v[226:227], v[166:167] op_sel_hi:[1,0,1]
    v_cvt_pk_bf16_f32 v132, v132, v133
    v_cvt_pk_bf16_f32 v133, v134, v135
    v_cvt_pk_bf16_f32 v134, v164, v165
    v_cvt_pk_bf16_f32 v135, v166, v167
    v_pk_max_i16 v164, v132, 0
    v_pk_max_i16 v165, v133, 0
    v_pk_max_i16 v166, v134, 0
    v_pk_max_i16 v167, v135, 0
    v_accvgpr_write_b32 a92, v164
    v_accvgpr_write_b32 a93, v165
    v_accvgpr_write_b32 a94, v166
    v_accvgpr_write_b32 a95, v167
    v_pk_fma_f32 v[136:137], v[244:245], v[228:229], v[136:137] op_sel_hi:[1,0,1]
    v_pk_fma_f32 v[138:139], v[246:247], v[228:229], v[138:139] op_sel_hi:[1,0,1]
    v_pk_fma_f32 v[168:169], v[194:195], v[228:229], v[168:169] op_sel_hi:[1,0,1]
    v_pk_fma_f32 v[170:171], v[198:199], v[228:229], v[170:171] op_sel_hi:[1,0,1]
    v_cvt_pk_bf16_f32 v136, v136, v137
    v_cvt_pk_bf16_f32 v137, v138, v139
    v_cvt_pk_bf16_f32 v138, v168, v169
    v_cvt_pk_bf16_f32 v139, v170, v171
    v_pk_max_i16 v168, v136, 0
    v_pk_max_i16 v169, v137, 0
    v_pk_max_i16 v170, v138, 0
    v_pk_max_i16 v171, v139, 0
    v_accvgpr_write_b32 a96, v168
    v_accvgpr_write_b32 a97, v169
    v_accvgpr_write_b32 a98, v170
    v_accvgpr_write_b32 a99, v171
    v_pk_fma_f32 v[140:141], v[244:245], v[230:231], v[140:141] op_sel_hi:[1,0,1]
    v_pk_fma_f32 v[142:143], v[246:247], v[230:231], v[142:143] op_sel_hi:[1,0,1]
    v_pk_fma_f32 v[172:173], v[194:195], v[230:231], v[172:173] op_sel_hi:[1,0,1]
    v_pk_fma_f32 v[174:175], v[198:199], v[230:231], v[174:175] op_sel_hi:[1,0,1]
    v_cvt_pk_bf16_f32 v140, v140, v141
    v_cvt_pk_bf16_f32 v141, v142, v143
    v_cvt_pk_bf16_f32 v142, v172, v173
    v_cvt_pk_bf16_f32 v143, v174, v175
    v_pk_max_i16 v172, v140, 0
    v_pk_max_i16 v173, v141, 0
    v_pk_max_i16 v174, v142, 0
    v_pk_max_i16 v175, v143, 0
    v_accvgpr_write_b32 a100, v172
    v_accvgpr_write_b32 a101, v173
    v_accvgpr_write_b32 a102, v174
    v_accvgpr_write_b32 a103, v175
    v_pk_fma_f32 v[144:145], v[244:245], v[232:233], v[144:145] op_sel_hi:[1,0,1]
    v_pk_fma_f32 v[146:147], v[246:247], v[232:233], v[146:147] op_sel_hi:[1,0,1]
    v_pk_fma_f32 v[176:177], v[194:195], v[232:233], v[176:177] op_sel_hi:[1,0,1]
    v_pk_fma_f32 v[178:179], v[198:199], v[232:233], v[178:179] op_sel_hi:[1,0,1]
    v_cvt_pk_bf16_f32 v144, v144, v145
    v_cvt_pk_bf16_f32 v145, v146, v147
    v_cvt_pk_bf16_f32 v146, v176, v177
    v_cvt_pk_bf16_f32 v147, v178, v179
    v_pk_max_i16 v176, v144, 0
    v_pk_max_i16 v177, v145, 0
    v_pk_max_i16 v178, v146, 0
    v_pk_max_i16 v179, v147, 0
    v_accvgpr_write_b32 a104, v176
    v_accvgpr_write_b32 a105, v177
    v_accvgpr_write_b32 a106, v178
    v_accvgpr_write_b32 a107, v179
    v_pk_fma_f32 v[148:149], v[244:245], v[234:235], v[148:149] op_sel_hi:[1,0,1]
    v_pk_fma_f32 v[150:151], v[246:247], v[234:235], v[150:151] op_sel_hi:[1,0,1]
    v_pk_fma_f32 v[180:181], v[194:195], v[234:235], v[180:181] op_sel_hi:[1,0,1]
    v_pk_fma_f32 v[182:183], v[198:199], v[234:235], v[182:183] op_sel_hi:[1,0,1]
    v_cvt_pk_bf16_f32 v148, v148, v149
    v_cvt_pk_bf16_f32 v149, v150, v151
    v_cvt_pk_bf16_f32 v150, v180, v181
    v_cvt_pk_bf16_f32 v151, v182, v183
    v_pk_max_i16 v180, v148, 0
    v_pk_max_i16 v181, v149, 0
    v_pk_max_i16 v182, v150, 0
    v_pk_max_i16 v183, v151, 0
    v_accvgpr_write_b32 a108, v180
    v_accvgpr_write_b32 a109, v181
    v_accvgpr_write_b32 a110, v182
    v_accvgpr_write_b32 a111, v183
    v_pk_fma_f32 v[152:153], v[244:245], v[236:237], v[152:153] op_sel_hi:[1,0,1]
    v_pk_fma_f32 v[154:155], v[246:247], v[236:237], v[154:155] op_sel_hi:[1,0,1]
    v_pk_fma_f32 v[184:185], v[194:195], v[236:237], v[184:185] op_sel_hi:[1,0,1]
    v_pk_fma_f32 v[186:187], v[198:199], v[236:237], v[186:187] op_sel_hi:[1,0,1]
    v_cvt_pk_bf16_f32 v152, v152, v153
    v_cvt_pk_bf16_f32 v153, v154, v155
    v_cvt_pk_bf16_f32 v154, v184, v185
    v_cvt_pk_bf16_f32 v155, v186, v187
    v_pk_max_i16 v184, v152, 0
    v_pk_max_i16 v185, v153, 0
    v_pk_max_i16 v186, v154, 0
    v_pk_max_i16 v187, v155, 0
    v_accvgpr_write_b32 a112, v184
    v_accvgpr_write_b32 a113, v185
    v_accvgpr_write_b32 a114, v186
    v_accvgpr_write_b32 a115, v187
    v_pk_fma_f32 v[156:157], v[244:245], v[238:239], v[156:157] op_sel_hi:[1,0,1]
    v_pk_fma_f32 v[158:159], v[246:247], v[238:239], v[158:159] op_sel_hi:[1,0,1]
    v_pk_fma_f32 v[188:189], v[194:195], v[238:239], v[188:189] op_sel_hi:[1,0,1]
    v_pk_fma_f32 v[190:191], v[198:199], v[238:239], v[190:191] op_sel_hi:[1,0,1]
    v_cvt_pk_bf16_f32 v156, v156, v157
    v_cvt_pk_bf16_f32 v157, v158, v159
    v_cvt_pk_bf16_f32 v158, v188, v189
    v_cvt_pk_bf16_f32 v159, v190, v191
    v_pk_max_i16 v188, v156, 0
    v_pk_max_i16 v189, v157, 0
    v_pk_max_i16 v190, v158, 0
    v_pk_max_i16 v191, v159, 0
    v_accvgpr_write_b32 a116, v188
    v_accvgpr_write_b32 a117, v189
    v_accvgpr_write_b32 a118, v190
    v_accvgpr_write_b32 a119, v191
    s_waitcnt vmcnt(0)
    s_mov_b32 s57, 0
    s_branch L_pc5
L_pl5:
    buffer_load_dwordx2 v[254:255], v253, s[8:11], 0 offen sc1
    s_waitcnt vmcnt(0)
L_pc5:
    v_cmp_ne_u64 vcc, s[6:7], v[254:255]
    s_add_u32 s57, s57, 1
    s_and_b64 vcc, vcc, s[90:91]
    s_cbranch_scc0 L_pd5
    s_sleep 6
    s_cmp_lt_u32 s57, 0x40000
    s_cbranch_scc1 L_pl5
L_pd5:
    s_add_u32 m0, s95, 0
    s_nop 0
    buffer_load_dwordx4 v252, s[16:19], s94 offen offset:0 sc1 lds
    buffer_load_dwordx4 v252, s[16:19], s94 offen offset:1024 sc1 lds
    buffer_load_dwordx4 v252, s[16:19], s94 offen offset:2048 sc1 lds
    buffer_load_dwordx4 v252, s[16:19], s94 offen offset:3072 sc1 lds
    s_add_u32 s94, s94, 16384
    buffer_load_dwordx4 v[0:3], v251, s[8:11], s99 offen offset:0 sc1
    buffer_load_dwordx4 v[4:7], v251, s[8:11], s99 offen offset:1024 sc1
    buffer_load_dwordx4 v[8:11], v251, s[8:11], s99 offen offset:2048 sc1
    buffer_load_dwordx4 v[12:15], v251, s[8:11], s99 offen offset:3072 sc1
    s_add_u32 m0, s95, 16384
    s_nop 0
    buffer_load_dwordx4 v252, s[16:19], s94 offen offset:0 sc1 lds
    buffer_load_dwordx4 v252, s[16:19], s94 offen offset:1024 sc1 lds
    buffer_load_dwordx4 v252, s[16:19], s94 offen offset:2048 sc1 lds
    buffer_load_dwordx4 v252, s[16:19], s94 offen offset:3072 sc1 lds
    s_add_u32 s94, s94, 16384
    s_and_b32 s94, s94, 262143
    buffer_store_dwordx4 v[32:35], v240, s[24:27], s49 offen offset:0 sc1
    buffer_store_dwordx4 v[36:39], v240, s[24:27], s49 offen offset:1024 sc1
    s_nop 1
    v_mov_b32 v220, v251
    v_mfma_f32_32x32x16_bf16 v[80:95], a[128:131], a[128:131], 0
    v_mfma_f32_32x32x16_bf16 v[96:111], a[128:131], a[128:131], 0
    v_and_b32 v232, 7, v250
    v_cmp_eq_u32 vcc, 0, v232
    v_cmp_eq_u32 s[88:89], 4, v232
    v_mov_b32 v234, 0x3f803f80
    v_mov_b32 v221, 0xdddddddd
    v_cndmask_b32 v184, 0, v234, vcc
    v_cndmask_b32 v186, 0, v234, s[88:89]
    v_mov_b32 v185, v184
    v_mov_b32 v187, v186
    s_add_u32 s98, s95, 65536
    s_mov_b32 s97, 0
    v_mov_b64 v[112:113], 0
    v_mov_b64 v[114:115], 0
    v_mov_b64 v[116:117], 0
    v_mov_b64 v[118:119], 0
    v_mov_b64 v[144:145], 0
    v_mov_b64 v[146:147], 0
    v_mov_b64 v[148:149], 0
    v_mov_b64 v[150:151], 0
    v_mov_b64 v[180:181], 0
    v_mov_b64 v[182:183], 0
    s_lshr_b32 s52, s41, 1
    s_lshl_b32 s52, s52, 2
    s_and_b32 s53, s42, 3
    s_add_u32 s46, s52, s53
    s_lshr_b32 s52, s46, 1
    s_lshl_b32 s52, s52, 7
    s_add_u32 s52, s52, 2048
    v_and_b32 v232, 15, v250
    v_lshl_add_u32 v230, v232, 3, s52
    s_add_u32 s12, s30, 0
    s_addc_u32 s13, s31, 0
    s_mov_b32 s14, 7340032
    s_mov_b32 s15, 0x00020000
    s_and_b32 s52, s41, 1
    s_lshl_b32 s52, s52, 3
    s_lshr_b32 s53, s42, 2
    s_add_u32 s48, s52, s53
    s_xor_b32 s48, s48, 4
    s_lshl_b32 s52, s46, 13
    s_add_u32 s53, s40, 1
    s_and_b32 s53, s53, 3
    s_lshl_b32 s53, s53, 11
    s_add_u32 s53, s53, s52
    v_add_u32 v222, s53, v251
    s_add_u32 s53, s40, 2
    s_and_b32 s53, s53, 3
    s_lshl_b32 s53, s53, 11
    s_add_u32 s53, s53, s52
    v_add_u32 v223, s53, v251
    s_add_u32 s53, s40, 3
    s_and_b32 s53, s53, 3
    s_lshl_b32 s53, s53, 11
    s_add_u32 s53, s53, s52
    v_add_u32 v246, s53, v251
    s_add_u32 s53, s40, 4
    s_and_b32 s53, s53, 3
    s_lshl_b32 s53, s53, 11
    s_add_u32 s53, s53, s52
    v_add_u32 v247, s53, v251
    v_lshrrev_b32 v232, 5, v250
    v_bfe_u32 v233, v250, 4, 1
    v_bfe_u32 v234, v250, 2, 2
    v_and_b32 v235, 3, v250
    v_lshl_add_u32 v224, v233, 2, v234
    v_lshlrev_b32 v224, 11, v224
    v_lshlrev_b32 v225, 1, v233
    v_xor_b32 v225, v225, v235
    v_lshl_add_u32 v224, v225, 4, v224
    v_lshl_add_u32 v224, v232, 6, v224
    s_lshl_b32 s52, s48, 7
    v_add_u32 v224, s52, v224
    v_add_u32 v225, 15360, v224
    v_add_u32 v226, 30720, v224
    v_add_u32 v227, 46080, v224
    s_lshl_b32 s45, s40, 14
    s_add_u32 s45, s45, 98304
    v_lshl_add_u32 v228, v232, 10, s45
    v_lshl_add_u32 v228, v233, 8, v228
    v_lshl_add_u32 v228, v234, 6, v228
    v_lshl_add_u32 v228, v233, 5, v228
    v_lshl_add_u32 v228, v235, 3, v228
    v_xor_b32 v229, 32, v228
    s_and_b32 s52, s42, 7
    s_lshl_b32 s52, s52, 2
    s_add_u32 s52, s52, s40
    s_lshl_b32 s52, s52, 8
    s_add_u32 s52, s52, 32768
    v_and_b32 v233, 31, v250
    v_lshlrev_b32 v233, 2, v233
    buffer_load_dword v244, v233, s[8:11], s52 offen offset:0 sc1
    buffer_load_dword v245, v233, s[8:11], s52 offen offset:128 sc1
    s_getpc_b64 s[52:53]
L_pc_6:
    s_sub_u32 s52, s52, L_pc_6-parallel_sum__softmax_full_mha__dense_activation_relu__prompt_kernel
    s_subb_u32 s53, s53, 0
    s_lshl_b32 s54, s42, 2
    s_add_u32 s54, s54, s40
    s_and_b32 s54, s54, 63
    s_lshl_b32 s54, s54, 10
    v_add_u32 v248, s54, v251
    v_min_u32 v248, L_code_end-parallel_sum__softmax_full_mha__dense_activation_relu__prompt_kernel-16, v248
    v_mov_b32 v249, s53
    v_add_co_u32 v248, vcc, s52, v248
    s_nop 1
    v_addc_co_u32 v249, vcc, 0, v249, vcc
    s_mul_i32 s43, s40, 3670016
    s_add_u32 s43, s43, 20971520
    s_mul_i32 s44, s40, 1835008
    s_waitcnt vmcnt(8)
    s_branch L_at_entry
L_g1_qkv:
    s_lshl_b32 s53, s41, 1
    s_add_u32 s53, s53, s51
    s_sub_u32 s53, s53, 2
    s_lshl_b32 s53, s53, 7
    s_mul_i32 s44, s47, 786432
    v_mul_u32_u24 v244, 6144, v244
    v_add3_u32 v245, v245, v244, s53
    v_add_u32 v228, 4096, v245
    v_add_u32 v229, 5120, v245
    v_add_u32 v230, 6144, v245
    v_mov_b32 v12, 0
    v_mov_b32 v13, 0
    v_mov_b32 v14, 0
    v_mov_b32 v15, 0
    s_mov_b32 s23, 0x00020000
    s_mov_b32 s19, 0x00020000
    s_mov_b32 s15, 0x00020000
    s_mov_b32 s22, 4194304
    s_mov_b32 s18, 4128768
    s_mov_b32 s14, 6295552
    s_waitcnt lgkmcnt(0)
    s_mov_b32 s20, s34
    s_mov_b32 s21, s35
    s_add_u32 m0, s45, 0
    s_nop 0
    buffer_load_dwordx4 v224, s[20:23], s43 offen offset:0  lds
    v_mfma_f32_32x32x16_bf16 a[128:143], v[12:15], v[12:15], 0
    buffer_load_dwordx4 v225, s[20:23], s43 offen offset:1024  lds
    v_mfma_f32_32x32x16_bf16 a[144:159], v[12:15], v[12:15], 0
    buffer_load_dwordx4 v226, s[20:23], s43 offen offset:2048  lds
    v_mfma_f32_32x32x16_bf16 a[176:191], v[12:15], v[12:15], 0
    buffer_load_dwordx4 v227, s[20:23], s43 offen offset:3072  lds
    v_mfma_f32_32x32x16_bf16 a[192:207], v[12:15], v[12:15], 0
    s_sub_u32 s12, s6, 4096
    s_subb_u32 s13, s7, 0
    s_add_u32 m0, s46, 0
    s_nop 0
    buffer_load_dwordx4 v228, s[12:15], s44 offen offset:0  lds
    v_mfma_f32_32x32x16_bf16 a[208:223], v[12:15], v[12:15], 0
    buffer_load_dwordx4 v229, s[12:15], s44 offen offset:1024  lds
    v_mfma_f32_32x32x16_bf16 a[224:239], v[12:15], v[12:15], 0
    buffer_load_dwordx4 v230, s[12:15], s44 offen offset:2048  lds
    v_mfma_f32_32x32x16_bf16 a[240:255], v[12:15], v[12:15], 0
    s_add_u32 s44, s44, 196608
    s_add_u32 s16, s34, 65536
    s_addc_u32 s17, s35, 0
    s_add_u32 m0, s45, 4096
    s_nop 0
    buffer_load_dwordx4 v224, s[16:19], s43 offen offset:0  lds
    v_mfma_f32_32x32x16_bf16 v[16:31], v[12:15], v[12:15], 0
    buffer_load_dwordx4 v225, s[16:19], s43 offen offset:1024  lds
    v_mfma_f32_32x32x16_bf16 v[32:47], v[12:15], v[12:15], 0
    buffer_load_dwordx4 v226, s[16:19], s43 offen offset:2048  lds
    v_mfma_f32_32x32x16_bf16 v[48:63], v[12:15], v[12:15], 0
    buffer_load_dwordx4 v227, s[16:19], s43 offen offset:3072  lds
    v_mfma_f32_32x32x16_bf16 v[64:79], v[12:15], v[12:15], 0
    s_add_u32 s43, s43, 128
    s_add_u32 s88, s38, 248
    s_addc_u32 s89, s39, 0
    s_mov_b32 s90, 8
    s_mov_b32 s91, 0x00020000
    s_or_b32 s52, s2, s40
    s_cbranch_scc1 L_nonon_qkv
    s_or_b32 s92, s92, 1
    v_mov_b32 v8, s92
    v_mov_b32 v9, s93
    buffer_store_dwordx2 v[8:9], off, s[88:91], 0 sc1
L_nonon_qkv:
    s_add_u32 s8, s4, 0
    s_addc_u32 s9, s5, 0
    s_add_u32 m0, s46, 16384
    s_mov_b32 s10, 36700160
    s_mov_b32 s11, 0x00020000
    v_and_b32 v247, 15, v250
    v_mfma_f32_32x32x16_bf16 v[80:95], v[12:15], v[12:15], 0
    v_lshrrev_b32 v248, 1, v247
    v_xor_b32 v248, v248, v239
    v_lshlrev_b32 v248, 4, v248
    v_lshl_add_u32 v248, v247, 7, v248
    s_lshl_b32 s52, s48, 14
    v_mfma_f32_32x32x16_bf16 v[96:111], v[12:15], v[12:15], 0
    v_add_u32 v234, s52, v248
    v_mov_b32 v232, v234
    buffer_load_dwordx4 v228, s[12:15], s44 offen offset:0  lds
    v_xor_b32 v233, 64, v234
    s_mov_b32 s97, 0
    v_lshlrev_b32 v248, 13, v241
    v_mfma_f32_32x32x16_bf16 v[112:127], v[12:15], v[12:15], 0
    v_lshl_add_u32 v248, v242, 8, v248
    v_lshl_add_u32 v248, v243, 6, v248
    v_add_u32 v248, 98304, v248
    v_lshl_add_u32 v249, v242, 5, v248
    v_lshl_add_u32 v249, v4, 3, v249
    v_mfma_f32_32x32x16_bf16 v[128:143], v[12:15], v[12:15], 0
    s_mul_i32 s52, s49, 512
    v_add_u32 v235, s52, v249
    v_xor_b32 v236, 32, v235
    v_mov_b32 v248, 0x3f803f80
    buffer_load_dwordx4 v229, s[12:15], s44 offen offset:1024  lds
    v_accvgpr_write_b32 a124, v248
    v_mfma_f32_32x32x16_bf16 v[144:159], v[12:15], v[12:15], 0
    v_accvgpr_write_b32 a125, v248
    v_accvgpr_write_b32 a126, v248
    v_accvgpr_write_b32 a127, v248
    s_lshl_b32 s101, s41, 2
    s_add_u32 s101, s101, s51
    v_mfma_f32_32x32x16_bf16 v[160:175], v[12:15], v[12:15], 0
    s_and_b32 s52, s51, 1
    s_lshl_b32 s52, s52, 1
    s_lshl_b32 s100, s41, 2
    s_add_u32 s100, s100, s52
    s_lshl_b32 s52, s50, 2
    v_mfma_f32_32x32x16_bf16 v[176:191], v[12:15], v[12:15], 0
    s_add_u32 s52, s52, s40
    buffer_load_dwordx4 v230, s[12:15], s44 offen offset:2048  lds
    s_lshl_b32 s52, s52, 12
    s_lshl_b32 s53, s100, 17
    s_add_u32 s99, s52, s53
    s_add_u32 s99, s99, 4194304
    s_lshl_b32 s94, s50, 15
    s_lshl_b32 s95, s40, 12
    v_add_u32 v252, s95, v251
    s_lshr_b32 s52, s100, 1
    s_lshl_b32 s52, s52, 7
    v_and_b32 v253, 7, v250
    v_lshl_add_u32 v253, v253, 3, s52
    s_add_u32 s24, s30, 0
    s_addc_u32 s25, s31, 0
    s_add_u32 s44, s44, 196608
    s_mov_b32 s26, 7340032
    s_mov_b32 s27, 0x00020000
    s_lshl_b32 s58, s2, 2
    s_add_u32 s58, s58, s40
    s_lshl_b32 s58, s58, 10
    v_and_b32 v246, 0x3b, v250
    v_min_u32 v246, 1, v246
    v_lshlrev_b32 v246, 30, v246
    v_lshl_add_u32 v246, v3, 2, v246
    v_mov_b32 v241, 0
    v_mov_b32 v242, 0
    v_mov_b32 v247, v6
    s_lshl_b32 s52, s41, 1
    s_add_u32 s52, s52, s51
    s_sub_u32 s51, s52, 2
    s_lshl_b32 s52, s51, 7
    s_lshl_b32 s53, s50, 3
    s_add_u32 s92, s52, s53
    s_lshl_b32 s52, s50, 8
    s_lshl_b32 s93, s100, 3
    s_add_u32 s93, s93, s52
    s_add_u32 s93, s93, 4096
    s_getpc_b64 s[52:53]
L_pc_7:
    s_sub_u32 s52, s52, L_pc_7-parallel_sum__softmax_full_mha__dense_activation_relu__prompt_kernel
    s_subb_u32 s53, s53, 0
    s_lshl_b32 s54, s42, 2
    s_add_u32 s54, s54, s40
    s_and_b32 s54, s54, 63
    s_lshl_b32 s54, s54, 10
    v_add_u32 v254, s54, v251
    v_min_u32 v254, L_code_end-parallel_sum__softmax_full_mha__dense_activation_relu__prompt_kernel-16, v254
    v_mov_b32 v255, s53
    v_add_co_u32 v254, vcc, s52, v254
    s_nop 1
    v_addc_co_u32 v255, vcc, 0, v255, vcc
    s_nop 1
    v_mfma_f32_32x32x16_bf16 v[0:15], a[128:131], a[128:131], 0
    s_waitcnt vmcnt(3)
    s_barrier
    ds_read_b64_tr_b16 a[32:33], v235 offset:0
    ds_read_b64_tr_b16 a[34:35], v235 offset:4096
    ds_read_b128 a[0:3], v232 offset:0
    ds_read_b128 a[4:7], v232 offset:2048
    ds_read_b128 a[8:11], v232 offset:4096
    ds_read_b128 a[12:15], v232 offset:6144
    ds_read_b128 a[16:19], v232 offset:8192
    ds_read_b128 a[20:23], v232 offset:10240
    ds_read_b128 a[24:27], v232 offset:12288
    ds_read_b128 a[28:31], v232 offset:14336
    ds_read_b64_tr_b16 a[36:37], v236 offset:0
    ds_read_b64_tr_b16 a[38:39], v236 offset:4096
    ds_read_b64_tr_b16 a[40:41], v235 offset:1024
    ds_read_b64_tr_b16 a[42:43], v235 offset:5120
    ds_read_b64_tr_b16 a[44:45], v236 offset:1024
    ds_read_b64_tr_b16 a[46:47], v236 offset:5120
    ds_read_b64_tr_b16 a[48:49], v235 offset:2048
    ds_read_b64_tr_b16 a[50:51], v235 offset:6144
    ds_read_b64_tr_b16 a[52:53], v236 offset:2048
    ds_read_b64_tr_b16 a[54:55], v236 offset:6144
    s_waitcnt lgkmcnt(0)
    v_mfma_f32_16x16x32_bf16 a[128:131], a[32:35], a[124:127], a[128:131]
    s_add_u32 m0, s46, 32768
    v_mfma_f32_16x16x32_bf16 a[132:135], a[36:39], a[124:127], a[132:135]
    buffer_load_dwordx4 v228, s[12:15], s44 offen offset:0  lds
    v_mfma_f32_16x16x32_bf16 a[136:139], a[40:43], a[124:127], a[136:139]
    buffer_load_dwordx4 v229, s[12:15], s44 offen offset:1024  lds
    ds_read_b128 a[56:59], v233 offset:0
    v_mfma_f32_16x16x32_bf16 a[140:143], a[44:47], a[124:127], a[140:143]
    v_mfma_f32_16x16x32_bf16 a[144:147], a[48:51], a[124:127], a[144:147]
    buffer_load_dwordx4 v230, s[12:15], s44 offen offset:2048  lds
    v_mfma_f32_16x16x32_bf16 a[148:151], a[52:55], a[124:127], a[148:151]
    s_add_u32 s44, s44, 196608
    ds_read_b128 a[60:63], v233 offset:2048
    v_mfma_f32_16x16x32_bf16 v[0:3], a[32:35], a[0:3], v[0:3]
    v_mfma_f32_16x16x32_bf16 v[4:7], a[32:35], a[4:7], v[4:7]
    s_add_u32 m0, s45, 32768
    v_mfma_f32_16x16x32_bf16 v[8:11], a[32:35], a[8:11], v[8:11]
    buffer_load_dwordx4 v224, s[20:23], s43 offen offset:0  lds
    ds_read_b128 a[64:67], v233 offset:4096
    v_mfma_f32_16x16x32_bf16 v[12:15], a[32:35], a[12:15], v[12:15]
    v_mfma_f32_16x16x32_bf16 v[16:19], a[32:35], a[16:19], v[16:19]
    buffer_load_dwordx4 v225, s[20:23], s43 offen offset:1024  lds
    v_mfma_f32_16x16x32_bf16 v[20:23], a[32:35], a[20:23], v[20:23]
    buffer_load_dwordx4 v226, s[20:23], s43 offen offset:2048  lds
    ds_read_b128 a[68:71], v233 offset:6144
    v_mfma_f32_16x16x32_bf16 v[24:27], a[32:35], a[24:27], v[24:27]
    v_mfma_f32_16x16x32_bf16 v[28:31], a[32:35], a[28:31], v[28:31]
    buffer_load_dwordx4 v227, s[20:23], s43 offen offset:3072  lds
    v_mfma_f32_16x16x32_bf16 v[60:63], a[36:39], a[28:31], v[60:63]
    s_add_u32 m0, s45, 36864
    ds_read_b128 a[72:75], v233 offset:8192
    v_mfma_f32_16x16x32_bf16 v[56:59], a[36:39], a[24:27], v[56:59]
    v_mfma_f32_16x16x32_bf16 v[52:55], a[36:39], a[20:23], v[52:55]
    buffer_load_dwordx4 v224, s[16:19], s43 offen offset:0  lds
    v_mfma_f32_16x16x32_bf16 v[48:51], a[36:39], a[16:19], v[48:51]
    buffer_load_dwordx4 v225, s[16:19], s43 offen offset:1024  lds
    ds_read_b128 a[76:79], v233 offset:10240
    v_mfma_f32_16x16x32_bf16 v[44:47], a[36:39], a[12:15], v[44:47]
    v_mfma_f32_16x16x32_bf16 v[40:43], a[36:39], a[8:11], v[40:43]
    buffer_load_dwordx4 v226, s[16:19], s43 offen offset:2048  lds
    v_mfma_f32_16x16x32_bf16 v[36:39], a[36:39], a[4:7], v[36:39]
    buffer_load_dwordx4 v227, s[16:19], s43 offen offset:3072  lds
    ds_read_b128 a[80:83], v233 offset:12288
    v_mfma_f32_16x16x32_bf16 v[32:35], a[36:39], a[0:3], v[32:35]
    v_mfma_f32_16x16x32_bf16 v[64:67], a[40:43], a[0:3], v[64:67]
    s_add_u32 s43, s43, 128
    v_mfma_f32_16x16x32_bf16 v[68:71], a[40:43], a[4:7], v[68:71]
    s_and_b32 s43, s43, 2047
    ds_read_b128 a[84:87], v233 offset:14336
    v_mfma_f32_16x16x32_bf16 v[72:75], a[40:43], a[8:11], v[72:75]
    v_mfma_f32_16x16x32_bf16 v[76:79], a[40:43], a[12:15], v[76:79]
    v_mfma_f32_16x16x32_bf16 v[80:83], a[40:43], a[16:19], v[80:83]
    s_waitcnt vmcnt(11)
    s_barrier
    v_mfma_f32_16x16x32_bf16 v[84:87], a[40:43], a[20:23], v[84:87]
    global_load_dwordx4 a[120:123], v[254:255], off
    ds_read_b64_tr_b16 a[88:89], v235 offset:16384
    v_mfma_f32_16x16x32_bf16 v[88:91], a[40:43], a[24:27], v[88:91]
    buffer_load_dwordx4 a[160:163], v247, s[20:23], 0 offen offset:0
    ds_read_b64_tr_b16 a[90:91], v235 offset:20480
    v_mfma_f32_16x16x32_bf16 v[92:95], a[40:43], a[28:31], v[92:95]
    v_mfma_f32_16x16x32_bf16 v[124:127], a[44:47], a[28:31], v[124:127]
    buffer_load_dwordx4 a[164:167], v247, s[20:23], 0 offen offset:512
    ds_read_b64_tr_b16 a[92:93], v236 offset:16384
    v_mfma_f32_16x16x32_bf16 v[120:123], a[44:47], a[24:27], v[120:123]
    buffer_load_dwordx4 a[168:171], v247, s[20:23], 0 offen offset:1024
    ds_read_b64_tr_b16 a[94:95], v236 offset:20480
    v_mfma_f32_16x16x32_bf16 v[116:119], a[44:47], a[20:23], v[116:119]
    v_mfma_f32_16x16x32_bf16 v[112:115], a[44:47], a[16:19], v[112:115]
    buffer_load_dwordx4 a[172:175], v247, s[20:23], 0 offen offset:1536
    ds_read_b64_tr_b16 a[96:97], v235 offset:17408
    v_mfma_f32_16x16x32_bf16 v[108:111], a[44:47], a[12:15], v[108:111]
    s_add_u32 m0, s46, 49152
    ds_read_b64_tr_b16 a[98:99], v235 offset:21504
    v_mfma_f32_16x16x32_bf16 v[104:107], a[44:47], a[8:11], v[104:107]
    v_mfma_f32_16x16x32_bf16 v[100:103], a[44:47], a[4:7], v[100:103]
    buffer_load_dwordx4 v228, s[12:15], s44 offen offset:0  lds
    ds_read_b64_tr_b16 a[100:101], v236 offset:17408
    v_mfma_f32_16x16x32_bf16 v[96:99], a[44:47], a[0:3], v[96:99]
    buffer_load_dwordx4 v229, s[12:15], s44 offen offset:1024  lds
    ds_read_b64_tr_b16 a[102:103], v236 offset:21504
    v_mfma_f32_16x16x32_bf16 v[128:131], a[0:3], a[48:51], v[128:131]
    v_mfma_f32_16x16x32_bf16 v[132:135], a[4:7], a[48:51], v[132:135]
    buffer_load_dwordx4 v230, s[12:15], s44 offen offset:2048  lds
    ds_read_b64_tr_b16 a[104:105], v235 offset:18432
    v_mfma_f32_16x16x32_bf16 v[136:139], a[8:11], a[48:51], v[136:139]
    ds_read_b64_tr_b16 a[106:107], v235 offset:22528
    v_mfma_f32_16x16x32_bf16 v[140:143], a[12:15], a[48:51], v[140:143]
    s_add_u32 s44, s44, 196608
    v_mfma_f32_16x16x32_bf16 v[144:147], a[16:19], a[48:51], v[144:147]
    s_cmp_eq_u32 s44, 6291456
    s_cselect_b32 s44, 0, s44
    ds_read_b64_tr_b16 a[108:109], v236 offset:18432
    v_mfma_f32_16x16x32_bf16 v[148:151], a[20:23], a[48:51], v[148:151]
    ds_read_b64_tr_b16 a[110:111], v236 offset:22528
    v_mfma_f32_16x16x32_bf16 v[152:155], a[24:27], a[48:51], v[152:155]
    s_add_u32 s96, s97, s45
    v_mfma_f32_16x16x32_bf16 v[156:159], a[28:31], a[48:51], v[156:159]
    s_add_u32 s97, s97, 32768
    v_mfma_f32_16x16x32_bf16 v[188:191], a[28:31], a[52:55], v[188:191]
    v_mfma_f32_16x16x32_bf16 v[184:187], a[24:27], a[52:55], v[184:187]
    s_cmp_eq_u32 s97, 98304
    s_cselect_b32 s97, 0, s97
    v_mfma_f32_16x16x32_bf16 v[180:183], a[20:23], a[52:55], v[180:183]
    v_add_u32 v232, s97, v234
    v_mfma_f32_16x16x32_bf16 v[176:179], a[16:19], a[52:55], v[176:179]
    v_mfma_f32_16x16x32_bf16 v[172:175], a[12:15], a[52:55], v[172:175]
    v_xor_b32 v233, 64, v232
    v_mfma_f32_16x16x32_bf16 v[168:171], a[8:11], a[52:55], v[168:171]
    v_mfma_f32_16x16x32_bf16 v[164:167], a[4:7], a[52:55], v[164:167]
    v_mfma_f32_16x16x32_bf16 v[160:163], a[0:3], a[52:55], v[160:163]
    s_waitcnt vmcnt(8) lgkmcnt(0)
    s_barrier
    v_mfma_f32_16x16x32_bf16 a[128:131], a[88:91], a[124:127], a[128:131]
    s_add_u32 m0, s45, 65536
    ds_read_b64_tr_b16 a[32:33], v235 offset:32768
    v_mfma_f32_16x16x32_bf16 a[132:135], a[92:95], a[124:127], a[132:135]
    v_mfma_f32_16x16x32_bf16 a[136:139], a[96:99], a[124:127], a[136:139]
    buffer_load_dwordx4 v224, s[20:23], s43 offen offset:0  lds
    ds_read_b64_tr_b16 a[34:35], v235 offset:36864
    v_mfma_f32_16x16x32_bf16 a[140:143], a[100:103], a[124:127], a[140:143]
    v_mfma_f32_16x16x32_bf16 a[144:147], a[104:107], a[124:127], a[144:147]
    buffer_load_dwordx4 v225, s[20:23], s43 offen offset:1024  lds
    ds_read_b128 a[0:3], v232 offset:0
    v_mfma_f32_16x16x32_bf16 a[148:151], a[108:111], a[124:127], a[148:151]
    v_mfma_f32_16x16x32_bf16 v[0:3], a[88:91], a[56:59], v[0:3]
    buffer_load_dwordx4 v226, s[20:23], s43 offen offset:2048  lds
    ds_read_b128 a[4:7], v232 offset:2048
    v_mfma_f32_16x16x32_bf16 v[4:7], a[88:91], a[60:63], v[4:7]
    v_mfma_f32_16x16x32_bf16 v[8:11], a[88:91], a[64:67], v[8:11]
    buffer_load_dwordx4 v227, s[20:23], s43 offen offset:3072  lds
    ds_read_b128 a[8:11], v232 offset:4096
    v_mfma_f32_16x16x32_bf16 v[12:15], a[88:91], a[68:71], v[12:15]
    v_mfma_f32_16x16x32_bf16 v[16:19], a[88:91], a[72:75], v[16:19]
    s_add_u32 m0, s45, 69632
    ds_read_b128 a[12:15], v232 offset:6144
    v_mfma_f32_16x16x32_bf16 v[20:23], a[88:91], a[76:79], v[20:23]
    v_mfma_f32_16x16x32_bf16 v[24:27], a[88:91], a[80:83], v[24:27]
    buffer_load_dwordx4 v224, s[16:19], s43 offen offset:0  lds
    ds_read_b128 a[16:19], v232 offset:8192
    v_mfma_f32_16x16x32_bf16 v[28:31], a[88:91], a[84:87], v[28:31]
    v_mfma_f32_16x16x32_bf16 v[60:63], a[92:95], a[84:87], v[60:63]
    ds_read_b128 a[20:23], v232 offset:10240
    v_mfma_f32_16x16x32_bf16 v[56:59], a[92:95], a[80:83], v[56:59]
    buffer_load_dwordx4 v225, s[16:19], s43 offen offset:1024  lds
    v_mfma_f32_16x16x32_bf16 v[52:55], a[92:95], a[76:79], v[52:55]
    ds_read_b128 a[24:27], v232 offset:12288
    v_mfma_f32_16x16x32_bf16 v[48:51], a[92:95], a[72:75], v[48:51]
    buffer_load_dwordx4 v226, s[16:19], s43 offen offset:2048  lds
    v_mfma_f32_16x16x32_bf16 v[44:47], a[92:95], a[68:71], v[44:47]
    ds_read_b128 a[28:31], v232 offset:14336
    v_mfma_f32_16x16x32_bf16 v[40:43], a[92:95], a[64:67], v[40:43]
    buffer_load_dwordx4 v227, s[16:19], s43 offen offset:3072  lds
    v_mfma_f32_16x16x32_bf16 v[36:39], a[92:95], a[60:63], v[36:39]
    ds_read_b64_tr_b16 a[36:37], v236 offset:32768
    v_mfma_f32_16x16x32_bf16 v[32:35], a[92:95], a[56:59], v[32:35]
    s_add_u32 s43, s43, 128
    v_mfma_f32_16x16x32_bf16 v[64:67], a[96:99], a[56:59], v[64:67]
    ds_read_b64_tr_b16 a[38:39], v236 offset:36864
    v_mfma_f32_16x16x32_bf16 v[68:71], a[96:99], a[60:63], v[68:71]
    s_add_u32 m0, s46, 0
    v_mfma_f32_16x16x32_bf16 v[72:75], a[96:99], a[64:67], v[72:75]
    ds_read_b64_tr_b16 a[40:41], v235 offset:33792
    v_mfma_f32_16x16x32_bf16 v[76:79], a[96:99], a[68:71], v[76:79]
    buffer_load_dwordx4 v228, s[12:15], s44 offen offset:0  lds
    v_mfma_f32_16x16x32_bf16 v[80:83], a[96:99], a[72:75], v[80:83]
    ds_read_b64_tr_b16 a[42:43], v235 offset:37888
    v_mfma_f32_16x16x32_bf16 v[84:87], a[96:99], a[76:79], v[84:87]
    buffer_load_dwordx4 v229, s[12:15], s44 offen offset:1024  lds
    v_mfma_f32_16x16x32_bf16 v[88:91], a[96:99], a[80:83], v[88:91]
    ds_read_b64_tr_b16 a[44:45], v236 offset:33792
    v_mfma_f32_16x16x32_bf16 v[92:95], a[96:99], a[84:87], v[92:95]
    v_mfma_f32_16x16x32_bf16 v[124:127], a[100:103], a[84:87], v[124:127]
    buffer_load_dwordx4 v230, s[12:15], s44 offen offset:2048  lds
    ds_read_b64_tr_b16 a[46:47], v236 offset:37888
    v_mfma_f32_16x16x32_bf16 v[120:123], a[100:103], a[80:83], v[120:123]
    v_mfma_f32_16x16x32_bf16 v[116:119], a[100:103], a[76:79], v[116:119]
    s_add_u32 s44, s44, 196608
    ds_read_b64_tr_b16 a[48:49], v235 offset:34816
    v_mfma_f32_16x16x32_bf16 v[112:115], a[100:103], a[72:75], v[112:115]
    v_mfma_f32_16x16x32_bf16 v[108:111], a[100:103], a[68:71], v[108:111]
    s_add_u32 m0, s46, 16384
    ds_read_b64_tr_b16 a[50:51], v235 offset:38912
    v_mfma_f32_16x16x32_bf16 v[104:107], a[100:103], a[64:67], v[104:107]
    v_mfma_f32_16x16x32_bf16 v[100:103], a[100:103], a[60:63], v[100:103]
    buffer_load_dwordx4 v228, s[12:15], s44 offen offset:0  lds
    ds_read_b64_tr_b16 a[52:53], v236 offset:34816
    v_mfma_f32_16x16x32_bf16 v[96:99], a[100:103], a[56:59], v[96:99]
    v_mfma_f32_16x16x32_bf16 v[128:131], a[56:59], a[104:107], v[128:131]
    buffer_load_dwordx4 v229, s[12:15], s44 offen offset:1024  lds
    ds_read_b64_tr_b16 a[54:55], v236 offset:38912
    v_mfma_f32_16x16x32_bf16 v[132:135], a[60:63], a[104:107], v[132:135]
    v_mfma_f32_16x16x32_bf16 v[136:139], a[64:67], a[104:107], v[136:139]
    buffer_load_dwordx4 v230, s[12:15], s44 offen offset:2048  lds
    v_mfma_f32_16x16x32_bf16 v[140:143], a[68:71], a[104:107], v[140:143]
    v_mfma_f32_16x16x32_bf16 v[144:147], a[72:75], a[104:107], v[144:147]
    s_add_u32 s44, s44, 196608
    v_mfma_f32_16x16x32_bf16 v[148:151], a[76:79], a[104:107], v[148:151]
    v_mfma_f32_16x16x32_bf16 v[152:155], a[80:83], a[104:107], v[152:155]
    v_mfma_f32_16x16x32_bf16 v[156:159], a[84:87], a[104:107], v[156:159]
    v_mfma_f32_16x16x32_bf16 v[188:191], a[84:87], a[108:111], v[188:191]
    v_mfma_f32_16x16x32_bf16 v[184:187], a[80:83], a[108:111], v[184:187]
    v_mfma_f32_16x16x32_bf16 v[180:183], a[76:79], a[108:111], v[180:183]
    v_mfma_f32_16x16x32_bf16 v[176:179], a[72:75], a[108:111], v[176:179]
    v_mfma_f32_16x16x32_bf16 v[172:175], a[68:71], a[108:111], v[172:175]
    v_mfma_f32_16x16x32_bf16 v[168:171], a[64:67], a[108:111], v[168:171]
    v_mfma_f32_16x16x32_bf16 v[164:167], a[60:63], a[108:111], v[164:167]
    v_mfma_f32_16x16x32_bf16 v[160:163], a[56:59], a[108:111], v[160:163]
    s_waitcnt vmcnt(17)
    v_accvgpr_read_b32 v244, a160
    v_dot2c_f32_bf16 v241, v244, v248
    v_dot2c_f32_bf16 v242, v244, v244
    v_accvgpr_read_b32 v245, a161
    v_dot2c_f32_bf16 v241, v245, v248
    v_dot2c_f32_bf16 v242, v245, v245
    v_accvgpr_read_b32 v244, a162
    v_dot2c_f32_bf16 v241, v244, v248
    v_dot2c_f32_bf16 v242, v244, v244
    v_accvgpr_read_b32 v245, a163
    v_dot2c_f32_bf16 v241, v245, v248
    v_dot2c_f32_bf16 v242, v245, v245
    v_accvgpr_read_b32 v244, a164
    v_dot2c_f32_bf16 v241, v244, v248
    v_dot2c_f32_bf16 v242, v244, v244
    v_accvgpr_read_b32 v245, a165
    v_dot2c_f32_bf16 v241, v245, v248
    v_dot2c_f32_bf16 v242, v245, v245
    v_accvgpr_read_b32 v244, a166
    v_dot2c_f32_bf16 v241, v244, v248
    v_dot2c_f32_bf16 v242, v244, v244
    v_accvgpr_read_b32 v245, a167
    v_dot2c_f32_bf16 v241, v245, v248
    v_dot2c_f32_bf16 v242, v245, v245
    v_accvgpr_read_b32 v244, a168
    v_dot2c_f32_bf16 v241, v244, v248
    v_dot2c_f32_bf16 v242, v244, v244
    v_accvgpr_read_b32 v245, a169
    v_dot2c_f32_bf16 v241, v245, v248
    v_dot2c_f32_bf16 v242, v245, v245
    v_accvgpr_read_b32 v244, a170
    v_dot2c_f32_bf16 v241, v244, v248
    v_dot2c_f32_bf16 v242, v244, v244
    v_accvgpr_read_b32 v245, a171
    v_dot2c_f32_bf16 v241, v245, v248
    v_dot2c_f32_bf16 v242, v245, v245
    v_accvgpr_read_b32 v244, a172
    v_dot2c_f32_bf16 v241, v244, v248
    v_dot2c_f32_bf16 v242, v244, v244
    v_accvgpr_read_b32 v245, a173
    v_dot2c_f32_bf16 v241, v245, v248
    v_dot2c_f32_bf16 v242, v245, v245
    v_accvgpr_read_b32 v244, a174
    v_dot2c_f32_bf16 v241, v244, v248
    v_dot2c_f32_bf16 v242, v244, v244
    v_accvgpr_read_b32 v245, a175
    v_dot2c_f32_bf16 v241, v245, v248
    v_dot2c_f32_bf16 v242, v245, v245
    s_nop 1
    s_nop 1
    v_add_f32_dpp v243, v241, v241 quad_perm:[1,0,3,2] row_mask:0xf bank_mask:0xf
    s_nop 1
    v_add_f32_dpp v241, v243, v243 quad_perm:[2,3,0,1] row_mask:0xf bank_mask:0xf
    s_nop 1
    v_add_f32_dpp v243, v241, v241 row_ror:8 row_mask:0xf bank_mask:0xf
    v_mov_b32 v241, v243
    s_nop 1
    v_permlane16_swap_b32 v243, v241
    v_add_f32 v241, v243, v241
    v_mov_b32 v243, v241
    s_nop 1
    v_permlane32_swap_b32 v243, v241
    v_add_f32 v241, v243, v241
    s_nop 1
    v_add_f32_dpp v243, v242, v242 quad_perm:[1,0,3,2] row_mask:0xf bank_mask:0xf
    s_nop 1
    v_add_f32_dpp v242, v243, v243 quad_perm:[2,3,0,1] row_mask:0xf bank_mask:0xf
    s_nop 1
    v_add_f32_dpp v243, v242, v242 row_ror:8 row_mask:0xf bank_mask:0xf
    v_mov_b32 v242, v243
    s_nop 1
    v_permlane16_swap_b32 v243, v242
    v_add_f32 v242, v243, v242
    v_mov_b32 v243, v242
    s_nop 1
    v_permlane32_swap_b32 v243, v242
    v_add_f32 v242, v243, v242
    v_mul_f32 v241, 0xba800000, v241
    v_mul_f32 v242, 0x3a800000, v242
    v_fma_f32 v242, -v241, v241, v242
    v_max_f32 v242, 0, v242
    v_cvt_pk_bf16_f32 v241, v241, v241
    v_and_b32 v241, 0xffff0000, v241
    v_cvt_pk_bf16_f32 v242, v242, v242
    v_and_b32 v242, 0xffff0000, v242
    v_add_f32 v242, 0x3727c5ac, v242
    v_cvt_pk_bf16_f32 v242, v242, v242
    v_and_b32 v242, 0xffff0000, v242
    v_sqrt_f32 v242, v242
    s_mov_b32 s54, 16384
    v_cvt_pk_bf16_f32 v242, v242, v242
    v_and_b32 v242, 0xffff0000, v242
    v_rcp_f32 v243, v242
    s_mov_b32 s55, 24576
    s_mov_b32 s56, 32768
    buffer_store_dword v241, v246, s[8:11], s54 offen sc1
    buffer_store_dword v243, v246, s[8:11], s55 offen sc1
    buffer_store_dword v242, v246, s[8:11], s56 offen sc1
    s_waitcnt vmcnt(17) lgkmcnt(0)
    s_barrier
    v_mfma_f32_16x16x32_bf16 a[128:131], a[32:35], a[124:127], a[128:131]
    s_add_u32 m0, s46, 32768
    ds_read_b64_tr_b16 a[88:89], v235 offset:49152
    v_mfma_f32_16x16x32_bf16 a[132:135], a[36:39], a[124:127], a[132:135]
    v_mfma_f32_16x16x32_bf16 a[136:139], a[40:43], a[124:127], a[136:139]
    buffer_load_dwordx4 v228, s[12:15], s44 offen offset:0  lds
    ds_read_b64_tr_b16 a[90:91], v235 offset:53248
    v_mfma_f32_16x16x32_bf16 a[140:143], a[44:47], a[124:127], a[140:143]
    v_mfma_f32_16x16x32_bf16 a[144:147], a[48:51], a[124:127], a[144:147]
    buffer_load_dwordx4 v229, s[12:15], s44 offen offset:1024  lds
    ds_read_b128 a[56:59], v233 offset:0
    v_mfma_f32_16x16x32_bf16 a[148:151], a[52:55], a[124:127], a[148:151]
    v_mfma_f32_16x16x32_bf16 v[0:3], a[32:35], a[0:3], v[0:3]
    ds_read_b128 a[60:63], v233 offset:2048
    v_mfma_f32_16x16x32_bf16 v[4:7], a[32:35], a[4:7], v[4:7]
    buffer_load_dwordx4 v230, s[12:15], s44 offen offset:2048  lds
    v_mfma_f32_16x16x32_bf16 v[8:11], a[32:35], a[8:11], v[8:11]
    ds_read_b128 a[64:67], v233 offset:4096
    v_mfma_f32_16x16x32_bf16 v[12:15], a[32:35], a[12:15], v[12:15]
    s_add_u32 s44, s44, 196608
    v_mfma_f32_16x16x32_bf16 v[16:19], a[32:35], a[16:19], v[16:19]
    ds_read_b128 a[68:71], v233 offset:6144
    v_mfma_f32_16x16x32_bf16 v[20:23], a[32:35], a[20:23], v[20:23]
    s_add_u32 m0, s96, 0
    v_mfma_f32_16x16x32_bf16 v[24:27], a[32:35], a[24:27], v[24:27]
    ds_read_b128 a[72:75], v233 offset:8192
    v_mfma_f32_16x16x32_bf16 v[28:31], a[32:35], a[28:31], v[28:31]
    v_mfma_f32_16x16x32_bf16 v[60:63], a[36:39], a[28:31], v[60:63]
    buffer_load_dwordx4 v224, s[20:23], s43 offen offset:0  lds
    ds_read_b128 a[76:79], v233 offset:10240
    v_mfma_f32_16x16x32_bf16 v[56:59], a[36:39], a[24:27], v[56:59]
    v_mfma_f32_16x16x32_bf16 v[52:55], a[36:39], a[20:23], v[52:55]
    buffer_load_dwordx4 v225, s[20:23], s43 offen offset:1024  lds
    ds_read_b128 a[80:83], v233 offset:12288
    v_mfma_f32_16x16x32_bf16 v[48:51], a[36:39], a[16:19], v[48:51]
    v_mfma_f32_16x16x32_bf16 v[44:47], a[36:39], a[12:15], v[44:47]
    buffer_load_dwordx4 v226, s[20:23], s43 offen offset:2048  lds
    ds_read_b128 a[84:87], v233 offset:14336
    v_mfma_f32_16x16x32_bf16 v[40:43], a[36:39], a[8:11], v[40:43]
    v_mfma_f32_16x16x32_bf16 v[36:39], a[36:39], a[4:7], v[36:39]
    ds_read_b64_tr_b16 a[92:93], v236 offset:49152
    v_mfma_f32_16x16x32_bf16 v[32:35], a[36:39], a[0:3], v[32:35]
    buffer_load_dwordx4 v227, s[20:23], s43 offen offset:3072  lds
    v_mfma_f32_16x16x32_bf16 v[64:67], a[40:43], a[0:3], v[64:67]
    ds_read_b64_tr_b16 a[94:95], v236 offset:53248
    v_mfma_f32_16x16x32_bf16 v[68:71], a[40:43], a[4:7], v[68:71]
    s_add_u32 m0, s96, 4096
    v_mfma_f32_16x16x32_bf16 v[72:75], a[40:43], a[8:11], v[72:75]
    ds_read_b64_tr_b16 a[96:97], v235 offset:50176
    v_mfma_f32_16x16x32_bf16 v[76:79], a[40:43], a[12:15], v[76:79]
    buffer_load_dwordx4 v224, s[16:19], s43 offen offset:0  lds
    v_mfma_f32_16x16x32_bf16 v[80:83], a[40:43], a[16:19], v[80:83]
    ds_read_b64_tr_b16 a[98:99], v235 offset:54272
    v_mfma_f32_16x16x32_bf16 v[84:87], a[40:43], a[20:23], v[84:87]
    v_mfma_f32_16x16x32_bf16 v[88:91], a[40:43], a[24:27], v[88:91]
    buffer_load_dwordx4 v225, s[16:19], s43 offen offset:1024  lds
    ds_read_b64_tr_b16 a[100:101], v236 offset:50176
    v_mfma_f32_16x16x32_bf16 v[92:95], a[40:43], a[28:31], v[92:95]
    v_mfma_f32_16x16x32_bf16 v[124:127], a[44:47], a[28:31], v[124:127]
    buffer_load_dwordx4 v226, s[16:19], s43 offen offset:2048  lds
    ds_read_b64_tr_b16 a[102:103], v236 offset:54272
    v_mfma_f32_16x16x32_bf16 v[120:123], a[44:47], a[24:27], v[120:123]
    v_mfma_f32_16x16x32_bf16 v[116:119], a[44:47], a[20:23], v[116:119]
    buffer_load_dwordx4 v227, s[16:19], s43 offen offset:3072  lds
    ds_read_b64_tr_b16 a[104:105], v235 offset:51200
    v_mfma_f32_16x16x32_bf16 v[112:115], a[44:47], a[16:19], v[112:115]
    v_mfma_f32_16x16x32_bf16 v[108:111], a[44:47], a[12:15], v[108:111]
    ds_read_b64_tr_b16 a[106:107], v235 offset:55296
    v_mfma_f32_16x16x32_bf16 v[104:107], a[44:47], a[8:11], v[104:107]
    s_add_u32 s43, s43, 128
    v_mfma_f32_16x16x32_bf16 v[100:103], a[44:47], a[4:7], v[100:103]
    ds_read_b64_tr_b16 a[108:109], v236 offset:51200
    v_mfma_f32_16x16x32_bf16 v[96:99], a[44:47], a[0:3], v[96:99]
    s_and_b32 s43, s43, 2047
    v_mfma_f32_16x16x32_bf16 v[128:131], a[0:3], a[48:51], v[128:131]
    ds_read_b64_tr_b16 a[110:111], v236 offset:55296
    v_mfma_f32_16x16x32_bf16 v[132:135], a[4:7], a[48:51], v[132:135]
    v_mfma_f32_16x16x32_bf16 v[136:139], a[8:11], a[48:51], v[136:139]
    v_mfma_f32_16x16x32_bf16 v[140:143], a[12:15], a[48:51], v[140:143]
    v_mfma_f32_16x16x32_bf16 v[144:147], a[16:19], a[48:51], v[144:147]
    s_add_u32 s96, s97, s45
    v_mfma_f32_16x16x32_bf16 v[148:151], a[20:23], a[48:51], v[148:151]
    v_mfma_f32_16x16x32_bf16 v[152:155], a[24:27], a[48:51], v[152:155]
    s_add_u32 s97, s97, 32768
    v_mfma_f32_16x16x32_bf16 v[156:159], a[28:31], a[48:51], v[156:159]
    v_mfma_f32_16x16x32_bf16 v[188:191], a[28:31], a[52:55], v[188:191]
    s_cmp_eq_u32 s97, 98304
    s_cselect_b32 s97, 0, s97
    v_mfma_f32_16x16x32_bf16 v[184:187], a[24:27], a[52:55], v[184:187]
    v_mfma_f32_16x16x32_bf16 v[180:183], a[20:23], a[52:55], v[180:183]
    v_add_u32 v232, s97, v234
    v_mfma_f32_16x16x32_bf16 v[176:179], a[16:19], a[52:55], v[176:179]
    v_mfma_f32_16x16x32_bf16 v[172:175], a[12:15], a[52:55], v[172:175]
    v_xor_b32 v233, 64, v232
    v_mfma_f32_16x16x32_bf16 v[168:171], a[8:11], a[52:55], v[168:171]
    v_mfma_f32_16x16x32_bf16 v[164:167], a[4:7], a[52:55], v[164:167]
    v_mfma_f32_16x16x32_bf16 v[160:163], a[0:3], a[52:55], v[160:163]
    s_waitcnt vmcnt(17) lgkmcnt(0)
    s_barrier
    v_mfma_f32_16x16x32_bf16 a[128:131], a[88:91], a[124:127], a[128:131]
    s_add_u32 m0, s46, 49152
    ds_read_b64_tr_b16 a[32:33], v235 offset:0
    v_mfma_f32_16x16x32_bf16 a[132:135], a[92:95], a[124:127], a[132:135]
    v_mfma_f32_16x16x32_bf16 a[136:139], a[96:99], a[124:127], a[136:139]
    buffer_load_dwordx4 v228, s[12:15], s44 offen offset:0  lds
    ds_read_b64_tr_b16 a[34:35], v235 offset:4096
    v_mfma_f32_16x16x32_bf16 a[140:143], a[100:103], a[124:127], a[140:143]
    v_mfma_f32_16x16x32_bf16 a[144:147], a[104:107], a[124:127], a[144:147]
    ds_read_b128 a[0:3], v232 offset:0
    v_mfma_f32_16x16x32_bf16 a[148:151], a[108:111], a[124:127], a[148:151]
    buffer_load_dwordx4 v229, s[12:15], s44 offen offset:1024  lds
    v_mfma_f32_16x16x32_bf16 v[0:3], a[88:91], a[56:59], v[0:3]
    ds_read_b128 a[4:7], v232 offset:2048
    v_mfma_f32_16x16x32_bf16 v[4:7], a[88:91], a[60:63], v[4:7]
    v_mfma_f32_16x16x32_bf16 v[8:11], a[88:91], a[64:67], v[8:11]
    buffer_load_dwordx4 v230, s[12:15], s44 offen offset:2048  lds
    ds_read_b128 a[8:11], v232 offset:4096
    v_mfma_f32_16x16x32_bf16 v[12:15], a[88:91], a[68:71], v[12:15]
    v_mfma_f32_16x16x32_bf16 v[16:19], a[88:91], a[72:75], v[16:19]
    ds_read_b128 a[12:15], v232 offset:6144
    v_mfma_f32_16x16x32_bf16 v[20:23], a[88:91], a[76:79], v[20:23]
    s_add_u32 s44, s44, 196608
    v_mfma_f32_16x16x32_bf16 v[24:27], a[88:91], a[80:83], v[24:27]
    ds_read_b128 a[16:19], v232 offset:8192
    s_lshl_b32 s52, s101, 13
    v_mfma_f32_16x16x32_bf16 v[28:31], a[88:91], a[84:87], v[28:31]
    v_mfma_f32_16x16x32_bf16 v[60:63], a[92:95], a[84:87], v[60:63]
    s_cmp_eq_u32 s44, 6291456
    s_cselect_b32 s44, 0, s44
    ds_read_b128 a[20:23], v232 offset:10240
    v_mfma_f32_16x16x32_bf16 v[56:59], a[92:95], a[80:83], v[56:59]
    s_lshl_b32 s53, s50, 10
    v_mfma_f32_16x16x32_bf16 v[52:55], a[92:95], a[76:79], v[52:55]
    ds_read_b128 a[24:27], v232 offset:12288
    s_add_u32 s52, s52, s53
    v_mfma_f32_16x16x32_bf16 v[48:51], a[92:95], a[72:75], v[48:51]
    s_add_u32 m0, s96, 0
    v_mfma_f32_16x16x32_bf16 v[44:47], a[92:95], a[68:71], v[44:47]
    ds_read_b128 a[28:31], v232 offset:14336
    s_mul_i32 s53, s49, 384
    v_mfma_f32_16x16x32_bf16 v[40:43], a[92:95], a[64:67], v[40:43]
    v_mfma_f32_16x16x32_bf16 v[36:39], a[92:95], a[60:63], v[36:39]
    buffer_load_dwordx4 v224, s[20:23], s43 offen offset:0  lds
    ds_read_b64_tr_b16 a[36:37], v236 offset:0
    v_mfma_f32_16x16x32_bf16 v[32:35], a[92:95], a[56:59], v[32:35]
    s_add_u32 s52, s52, s53
    v_mfma_f32_16x16x32_bf16 v[64:67], a[96:99], a[56:59], v[64:67]
    ds_read_b64_tr_b16 a[38:39], v236 offset:4096
    s_add_u32 s52, s52, 65536
    v_mfma_f32_16x16x32_bf16 v[68:71], a[96:99], a[60:63], v[68:71]
    buffer_load_dwordx4 v225, s[20:23], s43 offen offset:1024  lds
    v_mfma_f32_16x16x32_bf16 v[72:75], a[96:99], a[64:67], v[72:75]
    ds_read_b64_tr_b16 a[40:41], v235 offset:1024
    v_and_b32 v238, 15, v250
    v_mfma_f32_16x16x32_bf16 v[76:79], a[96:99], a[68:71], v[76:79]
    v_mfma_f32_16x16x32_bf16 v[80:83], a[96:99], a[72:75], v[80:83]
    buffer_load_dwordx4 v226, s[20:23], s43 offen offset:2048  lds
    ds_read_b64_tr_b16 a[42:43], v235 offset:5120
    v_mfma_f32_16x16x32_bf16 v[84:87], a[96:99], a[76:79], v[84:87]
    v_or_b32 v238, s48, v238
    v_mfma_f32_16x16x32_bf16 v[88:91], a[96:99], a[80:83], v[88:91]
    ds_read_b64_tr_b16 a[44:45], v236 offset:1024
    v_lshlrev_b32 v238, 27, v238
    v_mfma_f32_16x16x32_bf16 v[92:95], a[96:99], a[84:87], v[92:95]
    buffer_load_dwordx4 v227, s[20:23], s43 offen offset:3072  lds
    v_mfma_f32_16x16x32_bf16 v[124:127], a[100:103], a[84:87], v[124:127]
    ds_read_b64_tr_b16 a[46:47], v236 offset:5120
    v_and_b32 v239, 48, v250
    v_mfma_f32_16x16x32_bf16 v[120:123], a[100:103], a[80:83], v[120:123]
    v_mfma_f32_16x16x32_bf16 v[116:119], a[100:103], a[76:79], v[116:119]
    ds_read_b64_tr_b16 a[48:49], v235 offset:2048
    v_or_b32 v238, v238, v239
    v_mfma_f32_16x16x32_bf16 v[112:115], a[100:103], a[72:75], v[112:115]
    v_mfma_f32_16x16x32_bf16 v[108:111], a[100:103], a[68:71], v[108:111]
    ds_read_b64_tr_b16 a[50:51], v235 offset:6144
    s_mov_b32 s47, 6
    v_mfma_f32_16x16x32_bf16 v[104:107], a[100:103], a[64:67], v[104:107]
    v_mfma_f32_16x16x32_bf16 v[100:103], a[100:103], a[60:63], v[100:103]
    ds_read_b64_tr_b16 a[52:53], v236 offset:2048
    buffer_load_dwordx2 v[254:255], off, s[88:91], 0  sc1
    v_mfma_f32_16x16x32_bf16 v[96:99], a[100:103], a[56:59], v[96:99]
    v_mfma_f32_16x16x32_bf16 v[128:131], a[56:59], a[104:107], v[128:131]
    ds_read_b64_tr_b16 a[54:55], v236 offset:6144
    buffer_store_dwordx4 a[128:131], v238, s[8:11], s52 offen offset:0 sc1
    v_mfma_f32_16x16x32_bf16 v[132:135], a[60:63], a[104:107], v[132:135]
    v_mfma_f32_16x16x32_bf16 v[136:139], a[64:67], a[104:107], v[136:139]
    buffer_store_dwordx4 a[132:135], v238, s[8:11], s52 offen offset:64 sc1
    v_mfma_f32_16x16x32_bf16 v[140:143], a[68:71], a[104:107], v[140:143]
    v_mfma_f32_16x16x32_bf16 v[144:147], a[72:75], a[104:107], v[144:147]
    buffer_store_dwordx4 a[136:139], v238, s[8:11], s52 offen offset:128 sc1
    v_mfma_f32_16x16x32_bf16 v[148:151], a[76:79], a[104:107], v[148:151]
    v_mfma_f32_16x16x32_bf16 v[152:155], a[80:83], a[104:107], v[152:155]
    buffer_store_dwordx4 a[140:143], v238, s[8:11], s52 offen offset:192 sc1
    v_mfma_f32_16x16x32_bf16 v[156:159], a[84:87], a[104:107], v[156:159]
    v_mfma_f32_16x16x32_bf16 v[188:191], a[84:87], a[108:111], v[188:191]
    buffer_store_dwordx4 a[144:147], v238, s[8:11], s52 offen offset:256 sc1
    v_mfma_f32_16x16x32_bf16 v[184:187], a[80:83], a[108:111], v[184:187]
    v_mfma_f32_16x16x32_bf16 v[180:183], a[76:79], a[108:111], v[180:183]
    buffer_store_dwordx4 a[148:151], v238, s[8:11], s52 offen offset:320 sc1
    v_mfma_f32_16x16x32_bf16 v[176:179], a[72:75], a[108:111], v[176:179]
    v_mfma_f32_16x16x32_bf16 v[172:175], a[68:71], a[108:111], v[172:175]
    v_mfma_f32_16x16x32_bf16 v[168:171], a[64:67], a[108:111], v[168:171]
    v_mfma_f32_16x16x32_bf16 v[164:167], a[60:63], a[108:111], v[164:167]
    v_mfma_f32_16x16x32_bf16 v[160:163], a[56:59], a[108:111], v[160:163]
    s_waitcnt vmcnt(21) lgkmcnt(0)
    s_barrier
.p2align 6
L_g1_qkv_loop:
    v_mfma_f32_16x16x32_bf16 v[0:3], a[32:35], a[0:3], v[0:3]
    s_add_u32 m0, s46, 0
    ds_read_b64_tr_b16 a[88:89], v235 offset:16384
    v_mfma_f32_16x16x32_bf16 v[4:7], a[32:35], a[4:7], v[4:7]
    ds_read_b64_tr_b16 a[90:91], v235 offset:20480
    v_mfma_f32_16x16x32_bf16 v[8:11], a[32:35], a[8:11], v[8:11]
    buffer_load_dwordx4 v228, s[12:15], s44 offen offset:0  lds
    v_mfma_f32_16x16x32_bf16 v[12:15], a[32:35], a[12:15], v[12:15]
    ds_read_b128 a[56:59], v233 offset:0
    v_mfma_f32_16x16x32_bf16 v[16:19], a[32:35], a[16:19], v[16:19]
    buffer_load_dwordx4 v229, s[12:15], s44 offen offset:1024  lds
    v_mfma_f32_16x16x32_bf16 v[20:23], a[32:35], a[20:23], v[20:23]
    ds_read_b128 a[60:63], v233 offset:2048
    v_mfma_f32_16x16x32_bf16 v[24:27], a[32:35], a[24:27], v[24:27]
    buffer_load_dwordx4 v230, s[12:15], s44 offen offset:2048  lds
    v_mfma_f32_16x16x32_bf16 v[28:31], a[32:35], a[28:31], v[28:31]
    ds_read_b128 a[64:67], v233 offset:4096
    v_mfma_f32_16x16x32_bf16 v[60:63], a[36:39], a[28:31], v[60:63]
    s_add_u32 s44, s44, 196608
    v_mfma_f32_16x16x32_bf16 v[56:59], a[36:39], a[24:27], v[56:59]
    ds_read_b128 a[68:71], v233 offset:6144
    v_mfma_f32_16x16x32_bf16 v[52:55], a[36:39], a[20:23], v[52:55]
    s_add_u32 m0, s96, 4096
    ds_read_b128 a[72:75], v233 offset:8192
    v_mfma_f32_16x16x32_bf16 v[48:51], a[36:39], a[16:19], v[48:51]
    v_mfma_f32_16x16x32_bf16 v[44:47], a[36:39], a[12:15], v[44:47]
    buffer_load_dwordx4 v224, s[16:19], s43 offen offset:0  lds
    v_mfma_f32_16x16x32_bf16 v[40:43], a[36:39], a[8:11], v[40:43]
    ds_read_b128 a[76:79], v233 offset:10240
    v_mfma_f32_16x16x32_bf16 v[36:39], a[36:39], a[4:7], v[36:39]
    ds_read_b128 a[80:83], v233 offset:12288
    v_mfma_f32_16x16x32_bf16 v[32:35], a[36:39], a[0:3], v[32:35]
    buffer_load_dwordx4 v225, s[16:19], s43 offen offset:1024  lds
    v_mfma_f32_16x16x32_bf16 v[64:67], a[40:43], a[0:3], v[64:67]
    ds_read_b128 a[84:87], v233 offset:14336
    v_mfma_f32_16x16x32_bf16 v[68:71], a[40:43], a[4:7], v[68:71]
    buffer_load_dwordx4 v226, s[16:19], s43 offen offset:2048  lds
    v_mfma_f32_16x16x32_bf16 v[72:75], a[40:43], a[8:11], v[72:75]
    ds_read_b64_tr_b16 a[92:93], v236 offset:16384
    v_mfma_f32_16x16x32_bf16 v[76:79], a[40:43], a[12:15], v[76:79]
    buffer_load_dwordx4 v227, s[16:19], s43 offen offset:3072  lds
    v_mfma_f32_16x16x32_bf16 v[80:83], a[40:43], a[16:19], v[80:83]
    ds_read_b64_tr_b16 a[94:95], v236 offset:20480
    v_mfma_f32_16x16x32_bf16 v[84:87], a[40:43], a[20:23], v[84:87]
    s_add_u32 s43, s43, 128
    ds_read_b64_tr_b16 a[96:97], v235 offset:17408
    v_mfma_f32_16x16x32_bf16 v[88:91], a[40:43], a[24:27], v[88:91]
    v_mfma_f32_16x16x32_bf16 v[92:95], a[40:43], a[28:31], v[92:95]
    buffer_load_dwordx4 a[120:123], v251, s[24:27], s58 offen
    v_mfma_f32_16x16x32_bf16 v[124:127], a[44:47], a[28:31], v[124:127]
    ds_read_b64_tr_b16 a[98:99], v235 offset:21504
    v_mfma_f32_16x16x32_bf16 v[120:123], a[44:47], a[24:27], v[120:123]
    s_add_u32 s58, s58, 1048576
    ds_read_b64_tr_b16 a[100:101], v236 offset:17408
    v_mfma_f32_16x16x32_bf16 v[116:119], a[44:47], a[20:23], v[116:119]
    v_mfma_f32_16x16x32_bf16 v[112:115], a[44:47], a[16:19], v[112:115]
    ds_read_b64_tr_b16 a[102:103], v236 offset:21504
    v_mfma_f32_16x16x32_bf16 v[108:111], a[44:47], a[12:15], v[108:111]
    ds_read_b64_tr_b16 a[104:105], v235 offset:18432
    v_mfma_f32_16x16x32_bf16 v[104:107], a[44:47], a[8:11], v[104:107]
    v_mfma_f32_16x16x32_bf16 v[100:103], a[44:47], a[4:7], v[100:103]
    ds_read_b64_tr_b16 a[106:107], v235 offset:22528
    v_mfma_f32_16x16x32_bf16 v[96:99], a[44:47], a[0:3], v[96:99]
    v_mfma_f32_16x16x32_bf16 v[128:131], a[0:3], a[48:51], v[128:131]
    ds_read_b64_tr_b16 a[108:109], v236 offset:18432
    v_mfma_f32_16x16x32_bf16 v[132:135], a[4:7], a[48:51], v[132:135]
    v_mfma_f32_16x16x32_bf16 v[136:139], a[8:11], a[48:51], v[136:139]
    ds_read_b64_tr_b16 a[110:111], v236 offset:22528
    v_mfma_f32_16x16x32_bf16 v[140:143], a[12:15], a[48:51], v[140:143]
    v_mfma_f32_16x16x32_bf16 v[144:147], a[16:19], a[48:51], v[144:147]
    s_add_u32 s96, s97, s45
    v_mfma_f32_16x16x32_bf16 v[148:151], a[20:23], a[48:51], v[148:151]
    v_mfma_f32_16x16x32_bf16 v[152:155], a[24:27], a[48:51], v[152:155]
    s_add_u32 s97, s97, 32768
    v_mfma_f32_16x16x32_bf16 v[156:159], a[28:31], a[48:51], v[156:159]
    v_mfma_f32_16x16x32_bf16 v[188:191], a[28:31], a[52:55], v[188:191]
    s_cmp_eq_u32 s97, 98304
    s_cselect_b32 s97, 0, s97
    v_mfma_f32_16x16x32_bf16 v[184:187], a[24:27], a[52:55], v[184:187]
    v_mfma_f32_16x16x32_bf16 v[180:183], a[20:23], a[52:55], v[180:183]
    v_add_u32 v232, s97, v234
    v_mfma_f32_16x16x32_bf16 v[176:179], a[16:19], a[52:55], v[176:179]
    v_mfma_f32_16x16x32_bf16 v[172:175], a[12:15], a[52:55], v[172:175]
    v_xor_b32 v233, 64, v232
    v_mfma_f32_16x16x32_bf16 v[168:171], a[8:11], a[52:55], v[168:171]
    v_mfma_f32_16x16x32_bf16 v[164:167], a[4:7], a[52:55], v[164:167]
    v_mfma_f32_16x16x32_bf16 v[160:163], a[0:3], a[52:55], v[160:163]
    s_waitcnt vmcnt(15) lgkmcnt(0)
    s_barrier
    v_mfma_f32_16x16x32_bf16 v[0:3], a[88:91], a[56:59], v[0:3]
    s_add_u32 m0, s46, 16384
    ds_read_b64_tr_b16 a[32:33], v235 offset:32768
    v_mfma_f32_16x16x32_bf16 v[4:7], a[88:91], a[60:63], v[4:7]
    ds_read_b64_tr_b16 a[34:35], v235 offset:36864
    v_mfma_f32_16x16x32_bf16 v[8:11], a[88:91], a[64:67], v[8:11]
    buffer_load_dwordx4 v228, s[12:15], s44 offen offset:0  lds
    v_mfma_f32_16x16x32_bf16 v[12:15], a[88:91], a[68:71], v[12:15]
    ds_read_b128 a[0:3], v232 offset:0
    v_mfma_f32_16x16x32_bf16 v[16:19], a[88:91], a[72:75], v[16:19]
    v_mfma_f32_16x16x32_bf16 v[20:23], a[88:91], a[76:79], v[20:23]
    buffer_load_dwordx4 v229, s[12:15], s44 offen offset:1024  lds
    v_mfma_f32_16x16x32_bf16 v[24:27], a[88:91], a[80:83], v[24:27]
    ds_read_b128 a[4:7], v232 offset:2048
    v_mfma_f32_16x16x32_bf16 v[28:31], a[88:91], a[84:87], v[28:31]
    ds_read_b128 a[8:11], v232 offset:4096
    v_mfma_f32_16x16x32_bf16 v[60:63], a[92:95], a[84:87], v[60:63]
    buffer_load_dwordx4 v230, s[12:15], s44 offen offset:2048  lds
    v_mfma_f32_16x16x32_bf16 v[56:59], a[92:95], a[80:83], v[56:59]
    ds_read_b128 a[12:15], v232 offset:6144
    v_mfma_f32_16x16x32_bf16 v[52:55], a[92:95], a[76:79], v[52:55]
    ds_read_b128 a[16:19], v232 offset:8192
    v_mfma_f32_16x16x32_bf16 v[48:51], a[92:95], a[72:75], v[48:51]
    s_add_u32 s44, s44, 196608
    v_mfma_f32_16x16x32_bf16 v[44:47], a[92:95], a[68:71], v[44:47]
    ds_read_b128 a[20:23], v232 offset:10240
    v_mfma_f32_16x16x32_bf16 v[40:43], a[92:95], a[64:67], v[40:43]
    v_mfma_f32_16x16x32_bf16 v[36:39], a[92:95], a[60:63], v[36:39]
    s_add_u32 m0, s96, 0
    ds_read_b128 a[24:27], v232 offset:12288
    v_mfma_f32_16x16x32_bf16 v[32:35], a[92:95], a[56:59], v[32:35]
    v_mfma_f32_16x16x32_bf16 v[64:67], a[96:99], a[56:59], v[64:67]
    buffer_load_dwordx4 v224, s[20:23], s43 offen offset:0  lds
    v_mfma_f32_16x16x32_bf16 v[68:71], a[96:99], a[60:63], v[68:71]
    ds_read_b128 a[28:31], v232 offset:14336
    v_mfma_f32_16x16x32_bf16 v[72:75], a[96:99], a[64:67], v[72:75]
    ds_read_b64_tr_b16 a[36:37], v236 offset:32768
    v_mfma_f32_16x16x32_bf16 v[76:79], a[96:99], a[68:71], v[76:79]
    buffer_load_dwordx4 v225, s[20:23], s43 offen offset:1024  lds
    v_mfma_f32_16x16x32_bf16 v[80:83], a[96:99], a[72:75], v[80:83]
    ds_read_b64_tr_b16 a[38:39], v236 offset:36864
    v_mfma_f32_16x16x32_bf16 v[84:87], a[96:99], a[76:79], v[84:87]
    ds_read_b64_tr_b16 a[40:41], v235 offset:33792
    v_mfma_f32_16x16x32_bf16 v[88:91], a[96:99], a[80:83], v[88:91]
    buffer_load_dwordx4 v226, s[20:23], s43 offen offset:2048  lds
    v_mfma_f32_16x16x32_bf16 v[92:95], a[96:99], a[84:87], v[92:95]
    ds_read_b64_tr_b16 a[42:43], v235 offset:37888
    v_mfma_f32_16x16x32_bf16 v[124:127], a[100:103], a[84:87], v[124:127]
    v_mfma_f32_16x16x32_bf16 v[120:123], a[100:103], a[80:83], v[120:123]
    buffer_load_dwordx4 v227, s[20:23], s43 offen offset:3072  lds
    v_mfma_f32_16x16x32_bf16 v[116:119], a[100:103], a[76:79], v[116:119]
    ds_read_b64_tr_b16 a[44:45], v236 offset:33792
    v_mfma_f32_16x16x32_bf16 v[112:115], a[100:103], a[72:75], v[112:115]
    ds_read_b64_tr_b16 a[46:47], v236 offset:37888
    v_mfma_f32_16x16x32_bf16 v[108:111], a[100:103], a[68:71], v[108:111]
    ds_read_b64_tr_b16 a[48:49], v235 offset:34816
    v_mfma_f32_16x16x32_bf16 v[104:107], a[100:103], a[64:67], v[104:107]
    v_mfma_f32_16x16x32_bf16 v[100:103], a[100:103], a[60:63], v[100:103]
    ds_read_b64_tr_b16 a[50:51], v235 offset:38912
    v_mfma_f32_16x16x32_bf16 v[96:99], a[100:103], a[56:59], v[96:99]
    v_mfma_f32_16x16x32_bf16 v[128:131], a[56:59], a[104:107], v[128:131]
    ds_read_b64_tr_b16 a[52:53], v236 offset:34816
    v_mfma_f32_16x16x32_bf16 v[132:135], a[60:63], a[104:107], v[132:135]
    v_mfma_f32_16x16x32_bf16 v[136:139], a[64:67], a[104:107], v[136:139]
    ds_read_b64_tr_b16 a[54:55], v236 offset:38912
    v_mfma_f32_16x16x32_bf16 v[140:143], a[68:71], a[104:107], v[140:143]
    v_mfma_f32_16x16x32_bf16 v[144:147], a[72:75], a[104:107], v[144:147]
    v_mfma_f32_16x16x32_bf16 v[148:151], a[76:79], a[104:107], v[148:151]
    v_mfma_f32_16x16x32_bf16 v[152:155], a[80:83], a[104:107], v[152:155]
    v_mfma_f32_16x16x32_bf16 v[156:159], a[84:87], a[104:107], v[156:159]
    v_mfma_f32_16x16x32_bf16 v[188:191], a[84:87], a[108:111], v[188:191]
    v_mfma_f32_16x16x32_bf16 v[184:187], a[80:83], a[108:111], v[184:187]
    v_mfma_f32_16x16x32_bf16 v[180:183], a[76:79], a[108:111], v[180:183]
    v_mfma_f32_16x16x32_bf16 v[176:179], a[72:75], a[108:111], v[176:179]
    v_mfma_f32_16x16x32_bf16 v[172:175], a[68:71], a[108:111], v[172:175]
    v_mfma_f32_16x16x32_bf16 v[168:171], a[64:67], a[108:111], v[168:171]
    v_mfma_f32_16x16x32_bf16 v[164:167], a[60:63], a[108:111], v[164:167]
    v_mfma_f32_16x16x32_bf16 v[160:163], a[56:59], a[108:111], v[160:163]
    s_waitcnt vmcnt(19) lgkmcnt(0)
    s_barrier
    v_mfma_f32_16x16x32_bf16 v[0:3], a[32:35], a[0:3], v[0:3]
    s_add_u32 m0, s46, 32768
    ds_read_b64_tr_b16 a[88:89], v235 offset:49152
    v_mfma_f32_16x16x32_bf16 v[4:7], a[32:35], a[4:7], v[4:7]
    ds_read_b64_tr_b16 a[90:91], v235 offset:53248
    v_mfma_f32_16x16x32_bf16 v[8:11], a[32:35], a[8:11], v[8:11]
    buffer_load_dwordx4 v228, s[12:15], s44 offen offset:0  lds
    v_mfma_f32_16x16x32_bf16 v[12:15], a[32:35], a[12:15], v[12:15]
    ds_read_b128 a[56:59], v233 offset:0
    v_mfma_f32_16x16x32_bf16 v[16:19], a[32:35], a[16:19], v[16:19]
    buffer_load_dwordx4 v229, s[12:15], s44 offen offset:1024  lds
    v_mfma_f32_16x16x32_bf16 v[20:23], a[32:35], a[20:23], v[20:23]
    ds_read_b128 a[60:63], v233 offset:2048
    v_mfma_f32_16x16x32_bf16 v[24:27], a[32:35], a[24:27], v[24:27]
    buffer_load_dwordx4 v230, s[12:15], s44 offen offset:2048  lds
    v_mfma_f32_16x16x32_bf16 v[28:31], a[32:35], a[28:31], v[28:31]
    ds_read_b128 a[64:67], v233 offset:4096
    v_mfma_f32_16x16x32_bf16 v[60:63], a[36:39], a[28:31], v[60:63]
    s_add_u32 s44, s44, 196608
    v_mfma_f32_16x16x32_bf16 v[56:59], a[36:39], a[24:27], v[56:59]
    ds_read_b128 a[68:71], v233 offset:6144
    v_mfma_f32_16x16x32_bf16 v[52:55], a[36:39], a[20:23], v[52:55]
    s_add_u32 m0, s96, 4096
    ds_read_b128 a[72:75], v233 offset:8192
    v_mfma_f32_16x16x32_bf16 v[48:51], a[36:39], a[16:19], v[48:51]
    v_mfma_f32_16x16x32_bf16 v[44:47], a[36:39], a[12:15], v[44:47]
    buffer_load_dwordx4 v224, s[16:19], s43 offen offset:0  lds
    v_mfma_f32_16x16x32_bf16 v[40:43], a[36:39], a[8:11], v[40:43]
    ds_read_b128 a[76:79], v233 offset:10240
    v_mfma_f32_16x16x32_bf16 v[36:39], a[36:39], a[4:7], v[36:39]
    buffer_load_dwordx4 v225, s[16:19], s43 offen offset:1024  lds
    v_mfma_f32_16x16x32_bf16 v[32:35], a[36:39], a[0:3], v[32:35]
    ds_read_b128 a[80:83], v233 offset:12288
    v_mfma_f32_16x16x32_bf16 v[64:67], a[40:43], a[0:3], v[64:67]
    buffer_load_dwordx4 v226, s[16:19], s43 offen offset:2048  lds
    v_mfma_f32_16x16x32_bf16 v[68:71], a[40:43], a[4:7], v[68:71]
    ds_read_b128 a[84:87], v233 offset:14336
    v_mfma_f32_16x16x32_bf16 v[72:75], a[40:43], a[8:11], v[72:75]
    buffer_load_dwordx4 v227, s[16:19], s43 offen offset:3072  lds
    v_mfma_f32_16x16x32_bf16 v[76:79], a[40:43], a[12:15], v[76:79]
    ds_read_b64_tr_b16 a[92:93], v236 offset:49152
    v_mfma_f32_16x16x32_bf16 v[80:83], a[40:43], a[16:19], v[80:83]
    ds_read_b64_tr_b16 a[94:95], v236 offset:53248
    v_mfma_f32_16x16x32_bf16 v[84:87], a[40:43], a[20:23], v[84:87]
    s_add_u32 s43, s43, 128
    ds_read_b64_tr_b16 a[96:97], v235 offset:50176
    v_mfma_f32_16x16x32_bf16 v[88:91], a[40:43], a[24:27], v[88:91]
    s_and_b32 s43, s43, 2047
    v_mfma_f32_16x16x32_bf16 v[92:95], a[40:43], a[28:31], v[92:95]
    ds_read_b64_tr_b16 a[98:99], v235 offset:54272
    v_mfma_f32_16x16x32_bf16 v[124:127], a[44:47], a[28:31], v[124:127]
    buffer_load_dwordx4 a[120:123], v251, s[24:27], s58 offen
    v_mfma_f32_16x16x32_bf16 v[120:123], a[44:47], a[24:27], v[120:123]
    ds_read_b64_tr_b16 a[100:101], v236 offset:50176
    v_mfma_f32_16x16x32_bf16 v[116:119], a[44:47], a[20:23], v[116:119]
    s_add_u32 s58, s58, 1048576
    v_mfma_f32_16x16x32_bf16 v[112:115], a[44:47], a[16:19], v[112:115]
    ds_read_b64_tr_b16 a[102:103], v236 offset:54272
    v_mfma_f32_16x16x32_bf16 v[108:111], a[44:47], a[12:15], v[108:111]
    ds_read_b64_tr_b16 a[104:105], v235 offset:51200
    v_mfma_f32_16x16x32_bf16 v[104:107], a[44:47], a[8:11], v[104:107]
    v_mfma_f32_16x16x32_bf16 v[100:103], a[44:47], a[4:7], v[100:103]
    ds_read_b64_tr_b16 a[106:107], v235 offset:55296
    v_mfma_f32_16x16x32_bf16 v[96:99], a[44:47], a[0:3], v[96:99]
    v_mfma_f32_16x16x32_bf16 v[128:131], a[0:3], a[48:51], v[128:131]
    ds_read_b64_tr_b16 a[108:109], v236 offset:51200
    v_mfma_f32_16x16x32_bf16 v[132:135], a[4:7], a[48:51], v[132:135]
    v_mfma_f32_16x16x32_bf16 v[136:139], a[8:11], a[48:51], v[136:139]
    ds_read_b64_tr_b16 a[110:111], v236 offset:55296
    v_mfma_f32_16x16x32_bf16 v[140:143], a[12:15], a[48:51], v[140:143]
    v_mfma_f32_16x16x32_bf16 v[144:147], a[16:19], a[48:51], v[144:147]
    s_add_u32 s96, s97, s45
    v_mfma_f32_16x16x32_bf16 v[148:151], a[20:23], a[48:51], v[148:151]
    v_mfma_f32_16x16x32_bf16 v[152:155], a[24:27], a[48:51], v[152:155]
    s_add_u32 s97, s97, 32768
    v_mfma_f32_16x16x32_bf16 v[156:159], a[28:31], a[48:51], v[156:159]
    v_mfma_f32_16x16x32_bf16 v[188:191], a[28:31], a[52:55], v[188:191]
    s_cmp_eq_u32 s97, 98304
    s_cselect_b32 s97, 0, s97
    v_mfma_f32_16x16x32_bf16 v[184:187], a[24:27], a[52:55], v[184:187]
    v_mfma_f32_16x16x32_bf16 v[180:183], a[20:23], a[52:55], v[180:183]
    v_add_u32 v232, s97, v234
    v_mfma_f32_16x16x32_bf16 v[176:179], a[16:19], a[52:55], v[176:179]
    v_mfma_f32_16x16x32_bf16 v[172:175], a[12:15], a[52:55], v[172:175]
    v_xor_b32 v233, 64, v232
    v_mfma_f32_16x16x32_bf16 v[168:171], a[8:11], a[52:55], v[168:171]
    v_mfma_f32_16x16x32_bf16 v[164:167], a[4:7], a[52:55], v[164:167]
    v_mfma_f32_16x16x32_bf16 v[160:163], a[0:3], a[52:55], v[160:163]
    s_waitcnt vmcnt(16) lgkmcnt(0)
    s_barrier
    v_mfma_f32_16x16x32_bf16 v[0:3], a[88:91], a[56:59], v[0:3]
    s_cmp_eq_u32 s47, 1
    s_cselect_b32 s22, 0, s22
    v_mfma_f32_16x16x32_bf16 v[4:7], a[88:91], a[60:63], v[4:7]
    ds_read_b64_tr_b16 a[32:33], v235 offset:0
    v_mfma_f32_16x16x32_bf16 v[8:11], a[88:91], a[64:67], v[8:11]
    ds_read_b64_tr_b16 a[34:35], v235 offset:4096
    v_mfma_f32_16x16x32_bf16 v[12:15], a[88:91], a[68:71], v[12:15]
    s_add_u32 m0, s46, 49152
    ds_read_b128 a[0:3], v232 offset:0
    v_mfma_f32_16x16x32_bf16 v[16:19], a[88:91], a[72:75], v[16:19]
    buffer_load_dwordx4 v228, s[12:15], s44 offen offset:0  lds
    v_mfma_f32_16x16x32_bf16 v[20:23], a[88:91], a[76:79], v[20:23]
    ds_read_b128 a[4:7], v232 offset:2048
    v_mfma_f32_16x16x32_bf16 v[24:27], a[88:91], a[80:83], v[24:27]
    buffer_load_dwordx4 v229, s[12:15], s44 offen offset:1024  lds
    v_mfma_f32_16x16x32_bf16 v[28:31], a[88:91], a[84:87], v[28:31]
    ds_read_b128 a[8:11], v232 offset:4096
    v_mfma_f32_16x16x32_bf16 v[60:63], a[92:95], a[84:87], v[60:63]
    buffer_load_dwordx4 v230, s[12:15], s44 offen offset:2048  lds
    v_mfma_f32_16x16x32_bf16 v[56:59], a[92:95], a[80:83], v[56:59]
    ds_read_b128 a[12:15], v232 offset:6144
    v_mfma_f32_16x16x32_bf16 v[52:55], a[92:95], a[76:79], v[52:55]
    s_add_u32 s44, s44, 196608
    ds_read_b128 a[16:19], v232 offset:8192
    v_mfma_f32_16x16x32_bf16 v[48:51], a[92:95], a[72:75], v[48:51]
    v_mfma_f32_16x16x32_bf16 v[44:47], a[92:95], a[68:71], v[44:47]
    s_cmp_eq_u32 s44, 6291456
    s_cselect_b32 s44, 0, s44
    v_mfma_f32_16x16x32_bf16 v[40:43], a[92:95], a[64:67], v[40:43]
    ds_read_b128 a[20:23], v232 offset:10240
    v_mfma_f32_16x16x32_bf16 v[36:39], a[92:95], a[60:63], v[36:39]
    s_add_u32 m0, s96, 0
    ds_read_b128 a[24:27], v232 offset:12288
    v_mfma_f32_16x16x32_bf16 v[32:35], a[92:95], a[56:59], v[32:35]
    v_mfma_f32_16x16x32_bf16 v[64:67], a[96:99], a[56:59], v[64:67]
    buffer_load_dwordx4 v224, s[20:23], s43 offen offset:0  lds
    v_mfma_f32_16x16x32_bf16 v[68:71], a[96:99], a[60:63], v[68:71]
    ds_read_b128 a[28:31], v232 offset:14336
    v_mfma_f32_16x16x32_bf16 v[72:75], a[96:99], a[64:67], v[72:75]
    buffer_load_dwordx4 v225, s[20:23], s43 offen offset:1024  lds
    v_mfma_f32_16x16x32_bf16 v[76:79], a[96:99], a[68:71], v[76:79]
    ds_read_b64_tr_b16 a[36:37], v236 offset:0
    v_mfma_f32_16x16x32_bf16 v[80:83], a[96:99], a[72:75], v[80:83]
    ds_read_b64_tr_b16 a[38:39], v236 offset:4096
    v_mfma_f32_16x16x32_bf16 v[84:87], a[96:99], a[76:79], v[84:87]
    buffer_load_dwordx4 v226, s[20:23], s43 offen offset:2048  lds
    v_mfma_f32_16x16x32_bf16 v[88:91], a[96:99], a[80:83], v[88:91]
    ds_read_b64_tr_b16 a[40:41], v235 offset:1024
    v_mfma_f32_16x16x32_bf16 v[92:95], a[96:99], a[84:87], v[92:95]
    buffer_load_dwordx4 v227, s[20:23], s43 offen offset:3072  lds
    v_mfma_f32_16x16x32_bf16 v[124:127], a[100:103], a[84:87], v[124:127]
    ds_read_b64_tr_b16 a[42:43], v235 offset:5120
    v_mfma_f32_16x16x32_bf16 v[120:123], a[100:103], a[80:83], v[120:123]
    s_sub_u32 s47, s47, 1
    ds_read_b64_tr_b16 a[44:45], v236 offset:1024
    v_mfma_f32_16x16x32_bf16 v[116:119], a[100:103], a[76:79], v[116:119]
    s_bitcmp1_b32 0x3d, s47
    v_mfma_f32_16x16x32_bf16 v[112:115], a[100:103], a[72:75], v[112:115]
    ds_read_b64_tr_b16 a[46:47], v236 offset:5120
    v_mfma_f32_16x16x32_bf16 v[108:111], a[100:103], a[68:71], v[108:111]
    ds_read_b64_tr_b16 a[48:49], v235 offset:2048
    v_mfma_f32_16x16x32_bf16 v[104:107], a[100:103], a[64:67], v[104:107]
    v_mfma_f32_16x16x32_bf16 v[100:103], a[100:103], a[60:63], v[100:103]
    ds_read_b64_tr_b16 a[50:51], v235 offset:6144
    v_mfma_f32_16x16x32_bf16 v[96:99], a[100:103], a[56:59], v[96:99]
    v_mfma_f32_16x16x32_bf16 v[128:131], a[56:59], a[104:107], v[128:131]
    ds_read_b64_tr_b16 a[52:53], v236 offset:2048
    v_mfma_f32_16x16x32_bf16 v[132:135], a[60:63], a[104:107], v[132:135]
    v_mfma_f32_16x16x32_bf16 v[136:139], a[64:67], a[104:107], v[136:139]
    ds_read_b64_tr_b16 a[54:55], v236 offset:6144
    v_mfma_f32_16x16x32_bf16 v[140:143], a[68:71], a[104:107], v[140:143]
    v_mfma_f32_16x16x32_bf16 v[144:147], a[72:75], a[104:107], v[144:147]
    v_mfma_f32_16x16x32_bf16 v[148:151], a[76:79], a[104:107], v[148:151]
    v_mfma_f32_16x16x32_bf16 v[152:155], a[80:83], a[104:107], v[152:155]
    v_mfma_f32_16x16x32_bf16 v[156:159], a[84:87], a[104:107], v[156:159]
    v_mfma_f32_16x16x32_bf16 v[188:191], a[84:87], a[108:111], v[188:191]
    v_mfma_f32_16x16x32_bf16 v[184:187], a[80:83], a[108:111], v[184:187]
    v_mfma_f32_16x16x32_bf16 v[180:183], a[76:79], a[108:111], v[180:183]
    v_mfma_f32_16x16x32_bf16 v[176:179], a[72:75], a[108:111], v[176:179]
    v_mfma_f32_16x16x32_bf16 v[172:175], a[68:71], a[108:111], v[172:175]
    v_mfma_f32_16x16x32_bf16 v[168:171], a[64:67], a[108:111], v[168:171]
    v_mfma_f32_16x16x32_bf16 v[164:167], a[60:63], a[108:111], v[164:167]
    v_mfma_f32_16x16x32_bf16 v[160:163], a[56:59], a[108:111], v[160:163]
    s_waitcnt vmcnt(19) lgkmcnt(0)
    s_barrier
    s_cbranch_scc0 L_g1_qkv_loop
    s_cmp_lg_u32 s47, 0
    s_cbranch_scc1 L_hk5_qkv
    v_mfma_f32_16x16x32_bf16 v[0:3], a[32:35], a[0:3], v[0:3]
    ds_read_b64_tr_b16 a[88:89], v235 offset:16384
    v_mfma_f32_16x16x32_bf16 v[4:7], a[32:35], a[4:7], v[4:7]
    ds_read_b64_tr_b16 a[90:91], v235 offset:20480
    v_mfma_f32_16x16x32_bf16 v[8:11], a[32:35], a[8:11], v[8:11]
    v_add_f32 v240, v240, v241
    v_mfma_f32_16x16x32_bf16 v[12:15], a[32:35], a[12:15], v[12:15]
    ds_read_b128 a[56:59], v233 offset:0
    v_mfma_f32_16x16x32_bf16 v[16:19], a[32:35], a[16:19], v[16:19]
    v_mfma_f32_16x16x32_bf16 v[20:23], a[32:35], a[20:23], v[20:23]
    ds_read_b128 a[60:63], v233 offset:2048
    v_add_f32 v242, v242, v243
    v_mfma_f32_16x16x32_bf16 v[24:27], a[32:35], a[24:27], v[24:27]
    v_mfma_f32_16x16x32_bf16 v[28:31], a[32:35], a[28:31], v[28:31]
    ds_read_b128 a[64:67], v233 offset:4096
    v_mfma_f32_16x16x32_bf16 v[60:63], a[36:39], a[28:31], v[60:63]
    v_add_f32 v244, v244, v245
    v_mfma_f32_16x16x32_bf16 v[56:59], a[36:39], a[24:27], v[56:59]
    ds_read_b128 a[68:71], v233 offset:6144
    v_mfma_f32_16x16x32_bf16 v[52:55], a[36:39], a[20:23], v[52:55]
    ds_read_b128 a[72:75], v233 offset:8192
    v_mfma_f32_16x16x32_bf16 v[48:51], a[36:39], a[16:19], v[48:51]
    v_add_f32 v246, v246, v247
    v_mfma_f32_16x16x32_bf16 v[44:47], a[36:39], a[12:15], v[44:47]
    ds_read_b128 a[76:79], v233 offset:10240
    v_mfma_f32_16x16x32_bf16 v[40:43], a[36:39], a[8:11], v[40:43]
    v_mfma_f32_16x16x32_bf16 v[36:39], a[36:39], a[4:7], v[36:39]
    ds_read_b128 a[80:83], v233 offset:12288
    v_add_f32 v240, v240, v242
    v_mfma_f32_16x16x32_bf16 v[32:35], a[36:39], a[0:3], v[32:35]
    v_mfma_f32_16x16x32_bf16 v[64:67], a[40:43], a[0:3], v[64:67]
    ds_read_b128 a[84:87], v233 offset:14336
    v_mfma_f32_16x16x32_bf16 v[68:71], a[40:43], a[4:7], v[68:71]
    v_add_f32 v244, v244, v246
    v_mfma_f32_16x16x32_bf16 v[72:75], a[40:43], a[8:11], v[72:75]
    ds_read_b64_tr_b16 a[92:93], v236 offset:16384
    v_mfma_f32_16x16x32_bf16 v[76:79], a[40:43], a[12:15], v[76:79]
    ds_read_b64_tr_b16 a[94:95], v236 offset:20480
    v_mfma_f32_16x16x32_bf16 v[80:83], a[40:43], a[16:19], v[80:83]
    v_add_f32 v240, v240, v244
    v_mfma_f32_16x16x32_bf16 v[84:87], a[40:43], a[20:23], v[84:87]
    ds_read_b64_tr_b16 a[96:97], v235 offset:17408
    v_mfma_f32_16x16x32_bf16 v[88:91], a[40:43], a[24:27], v[88:91]
    v_mfma_f32_16x16x32_bf16 v[92:95], a[40:43], a[28:31], v[92:95]
    ds_read_b64_tr_b16 a[98:99], v235 offset:21504
    v_add_u32 v238, 90112, v238
    v_mfma_f32_16x16x32_bf16 v[124:127], a[44:47], a[28:31], v[124:127]
    v_mfma_f32_16x16x32_bf16 v[120:123], a[44:47], a[24:27], v[120:123]
    ds_read_b64_tr_b16 a[100:101], v236 offset:17408
    v_mfma_f32_16x16x32_bf16 v[116:119], a[44:47], a[20:23], v[116:119]
    v_mfma_f32_16x16x32_bf16 v[112:115], a[44:47], a[16:19], v[112:115]
    ds_read_b64_tr_b16 a[102:103], v236 offset:21504
    v_mfma_f32_16x16x32_bf16 v[108:111], a[44:47], a[12:15], v[108:111]
    ds_read_b64_tr_b16 a[104:105], v235 offset:18432
    v_mfma_f32_16x16x32_bf16 v[104:107], a[44:47], a[8:11], v[104:107]
    v_mfma_f32_16x16x32_bf16 v[100:103], a[44:47], a[4:7], v[100:103]
    ds_read_b64_tr_b16 a[106:107], v235 offset:22528
    v_mfma_f32_16x16x32_bf16 v[96:99], a[44:47], a[0:3], v[96:99]
    v_mfma_f32_16x16x32_bf16 v[128:131], a[0:3], a[48:51], v[128:131]
    ds_read_b64_tr_b16 a[108:109], v236 offset:18432
    v_mfma_f32_16x16x32_bf16 v[132:135], a[4:7], a[48:51], v[132:135]
    v_mfma_f32_16x16x32_bf16 v[136:139], a[8:11], a[48:51], v[136:139]
    ds_read_b64_tr_b16 a[110:111], v236 offset:22528
    v_mfma_f32_16x16x32_bf16 v[140:143], a[12:15], a[48:51], v[140:143]
    v_mfma_f32_16x16x32_bf16 v[144:147], a[16:19], a[48:51], v[144:147]
    s_add_u32 s96, s97, s45
    v_mfma_f32_16x16x32_bf16 v[148:151], a[20:23], a[48:51], v[148:151]
    v_mfma_f32_16x16x32_bf16 v[152:155], a[24:27], a[48:51], v[152:155]
    s_add_u32 s97, s97, 32768
    v_mfma_f32_16x16x32_bf16 v[156:159], a[28:31], a[48:51], v[156:159]
    v_mfma_f32_16x16x32_bf16 v[188:191], a[28:31], a[52:55], v[188:191]
    s_cmp_eq_u32 s97, 98304
    s_cselect_b32 s97, 0, s97
    v_mfma_f32_16x16x32_bf16 v[184:187], a[24:27], a[52:55], v[184:187]
    v_mfma_f32_16x16x32_bf16 v[180:183], a[20:23], a[52:55], v[180:183]
    v_add_u32 v232, s97, v234
    v_mfma_f32_16x16x32_bf16 v[176:179], a[16:19], a[52:55], v[176:179]
    v_mfma_f32_16x16x32_bf16 v[172:175], a[12:15], a[52:55], v[172:175]
    v_xor_b32 v233, 64, v232
    v_mfma_f32_16x16x32_bf16 v[168:171], a[8:11], a[52:55], v[168:171]
    v_mfma_f32_16x16x32_bf16 v[164:167], a[4:7], a[52:55], v[164:167]
    v_mfma_f32_16x16x32_bf16 v[160:163], a[0:3], a[52:55], v[160:163]
    s_waitcnt vmcnt(7) lgkmcnt(0)
    s_barrier
    v_mfma_f32_16x16x32_bf16 v[0:3], a[88:91], a[56:59], v[0:3]
    ds_read_b64_tr_b16 a[32:33], v235 offset:32768
    v_mfma_f32_16x16x32_bf16 v[4:7], a[88:91], a[60:63], v[4:7]
    ds_read_b64_tr_b16 a[34:35], v235 offset:36864
    v_mfma_f32_16x16x32_bf16 v[8:11], a[88:91], a[64:67], v[8:11]
    v_mfma_f32_16x16x32_bf16 v[12:15], a[88:91], a[68:71], v[12:15]
    ds_read_b128 a[0:3], v232 offset:0
    v_mfma_f32_16x16x32_bf16 v[16:19], a[88:91], a[72:75], v[16:19]
    v_mfma_f32_16x16x32_bf16 v[20:23], a[88:91], a[76:79], v[20:23]
    ds_read_b128 a[4:7], v232 offset:2048
    v_mfma_f32_16x16x32_bf16 v[24:27], a[88:91], a[80:83], v[24:27]
    v_mfma_f32_16x16x32_bf16 v[28:31], a[88:91], a[84:87], v[28:31]
    ds_read_b128 a[8:11], v232 offset:4096
    v_mfma_f32_16x16x32_bf16 v[60:63], a[92:95], a[84:87], v[60:63]
    v_mfma_f32_16x16x32_bf16 v[56:59], a[92:95], a[80:83], v[56:59]
    ds_read_b128 a[12:15], v232 offset:6144
    v_mfma_f32_16x16x32_bf16 v[52:55], a[92:95], a[76:79], v[52:55]
    ds_read_b128 a[16:19], v232 offset:8192
    v_mfma_f32_16x16x32_bf16 v[48:51], a[92:95], a[72:75], v[48:51]
    v_mfma_f32_16x16x32_bf16 v[44:47], a[92:95], a[68:71], v[44:47]
    ds_read_b128 a[20:23], v232 offset:10240
    v_mfma_f32_16x16x32_bf16 v[40:43], a[92:95], a[64:67], v[40:43]
    v_mfma_f32_16x16x32_bf16 v[36:39], a[92:95], a[60:63], v[36:39]
    ds_read_b128 a[24:27], v232 offset:12288
    v_mfma_f32_16x16x32_bf16 v[32:35], a[92:95], a[56:59], v[32:35]
    v_mfma_f32_16x16x32_bf16 v[64:67], a[96:99], a[56:59], v[64:67]
    ds_read_b128 a[28:31], v232 offset:14336
    v_mfma_f32_16x16x32_bf16 v[68:71], a[96:99], a[60:63], v[68:71]
    v_mfma_f32_16x16x32_bf16 v[72:75], a[96:99], a[64:67], v[72:75]
    ds_read_b64_tr_b16 a[36:37], v236 offset:32768
    v_mfma_f32_16x16x32_bf16 v[76:79], a[96:99], a[68:71], v[76:79]
    ds_read_b64_tr_b16 a[38:39], v236 offset:36864
    v_mfma_f32_16x16x32_bf16 v[80:83], a[96:99], a[72:75], v[80:83]
    v_mfma_f32_16x16x32_bf16 v[84:87], a[96:99], a[76:79], v[84:87]
    ds_read_b64_tr_b16 a[40:41], v235 offset:33792
    v_mfma_f32_16x16x32_bf16 v[88:91], a[96:99], a[80:83], v[88:91]
    v_mfma_f32_16x16x32_bf16 v[92:95], a[96:99], a[84:87], v[92:95]
    ds_read_b64_tr_b16 a[42:43], v235 offset:37888
    v_mfma_f32_16x16x32_bf16 v[124:127], a[100:103], a[84:87], v[124:127]
    v_mfma_f32_16x16x32_bf16 v[120:123], a[100:103], a[80:83], v[120:123]
    ds_read_b64_tr_b16 a[44:45], v236 offset:33792
    v_mfma_f32_16x16x32_bf16 v[116:119], a[100:103], a[76:79], v[116:119]
    v_mfma_f32_16x16x32_bf16 v[112:115], a[100:103], a[72:75], v[112:115]
    ds_read_b64_tr_b16 a[46:47], v236 offset:37888
    v_mfma_f32_16x16x32_bf16 v[108:111], a[100:103], a[68:71], v[108:111]
    ds_read_b64_tr_b16 a[48:49], v235 offset:34816
    v_mfma_f32_16x16x32_bf16 v[104:107], a[100:103], a[64:67], v[104:107]
    v_mfma_f32_16x16x32_bf16 v[100:103], a[100:103], a[60:63], v[100:103]
    ds_read_b64_tr_b16 a[50:51], v235 offset:38912
    v_mfma_f32_16x16x32_bf16 v[96:99], a[100:103], a[56:59], v[96:99]
    v_mfma_f32_16x16x32_bf16 v[128:131], a[56:59], a[104:107], v[128:131]
    ds_read_b64_tr_b16 a[52:53], v236 offset:34816
    v_mfma_f32_16x16x32_bf16 v[132:135], a[60:63], a[104:107], v[132:135]
    v_mfma_f32_16x16x32_bf16 v[136:139], a[64:67], a[104:107], v[136:139]
    ds_read_b64_tr_b16 a[54:55], v236 offset:38912
    v_mfma_f32_16x16x32_bf16 v[140:143], a[68:71], a[104:107], v[140:143]
    v_mfma_f32_16x16x32_bf16 v[144:147], a[72:75], a[104:107], v[144:147]
    v_mfma_f32_16x16x32_bf16 v[148:151], a[76:79], a[104:107], v[148:151]
    v_mfma_f32_16x16x32_bf16 v[152:155], a[80:83], a[104:107], v[152:155]
    v_mfma_f32_16x16x32_bf16 v[156:159], a[84:87], a[104:107], v[156:159]
    v_mfma_f32_16x16x32_bf16 v[188:191], a[84:87], a[108:111], v[188:191]
    ds_write_b32 v238, v240
    v_mfma_f32_16x16x32_bf16 v[184:187], a[80:83], a[108:111], v[184:187]
    v_mfma_f32_16x16x32_bf16 v[180:183], a[76:79], a[108:111], v[180:183]
    ds_write_b32 v238, v248 offset:1024
    v_mfma_f32_16x16x32_bf16 v[176:179], a[72:75], a[108:111], v[176:179]
    v_mfma_f32_16x16x32_bf16 v[172:175], a[68:71], a[108:111], v[172:175]
    ds_write_b32 v238, v249 offset:2048
    v_mfma_f32_16x16x32_bf16 v[168:171], a[64:67], a[108:111], v[168:171]
    v_mfma_f32_16x16x32_bf16 v[164:167], a[60:63], a[108:111], v[164:167]
    v_mfma_f32_16x16x32_bf16 v[160:163], a[56:59], a[108:111], v[160:163]
    s_waitcnt vmcnt(4) lgkmcnt(0)
    s_barrier
    v_mfma_f32_16x16x32_bf16 v[0:3], a[32:35], a[0:3], v[0:3]
    ds_read_b64_tr_b16 a[88:89], v235 offset:49152
    v_mfma_f32_16x16x32_bf16 v[4:7], a[32:35], a[4:7], v[4:7]
    ds_read_b64_tr_b16 a[90:91], v235 offset:53248
    v_mfma_f32_16x16x32_bf16 v[8:11], a[32:35], a[8:11], v[8:11]
    s_lshl_b32 s52, s50, 3
    v_mfma_f32_16x16x32_bf16 v[12:15], a[32:35], a[12:15], v[12:15]
    ds_read_b128 a[56:59], v233 offset:0
    s_lshl_b32 s53, s48, 2
    v_mfma_f32_16x16x32_bf16 v[16:19], a[32:35], a[16:19], v[16:19]
    s_add_u32 s52, s52, s53
    v_mfma_f32_16x16x32_bf16 v[20:23], a[32:35], a[20:23], v[20:23]
    ds_read_b128 a[60:63], v233 offset:2048
    s_lshl_b32 s52, s52, 11
    v_mfma_f32_16x16x32_bf16 v[24:27], a[32:35], a[24:27], v[24:27]
    s_lshl_b32 s55, s51, 1
    v_mfma_f32_16x16x32_bf16 v[28:31], a[32:35], a[28:31], v[28:31]
    ds_read_b128 a[64:67], v233 offset:4096
    s_add_u32 s55, s55, s49
    v_mfma_f32_16x16x32_bf16 v[60:63], a[36:39], a[28:31], v[60:63]
    s_lshl_b32 s55, s55, 17
    v_mfma_f32_16x16x32_bf16 v[56:59], a[36:39], a[24:27], v[56:59]
    ds_read_b128 a[68:71], v233 offset:6144
    s_add_u32 s53, s55, s52
    v_mfma_f32_16x16x32_bf16 v[52:55], a[36:39], a[20:23], v[52:55]
    ds_read_b128 a[72:75], v233 offset:8192
    s_lshl_b32 s54, s53, 1
    v_mfma_f32_16x16x32_bf16 v[48:51], a[36:39], a[16:19], v[48:51]
    s_add_u32 s54, s54, 8388608
    v_mfma_f32_16x16x32_bf16 v[44:47], a[36:39], a[12:15], v[44:47]
    ds_read_b128 a[76:79], v233 offset:10240
    s_add_u32 s53, s53, 4194304
    v_mfma_f32_16x16x32_bf16 v[40:43], a[36:39], a[8:11], v[40:43]
    v_lshrrev_b32 v242, 4, v250
    v_mfma_f32_16x16x32_bf16 v[36:39], a[36:39], a[4:7], v[36:39]
    ds_read_b128 a[80:83], v233 offset:12288
    v_lshlrev_b32 v242, 9, v242
    v_mfma_f32_16x16x32_bf16 v[32:35], a[36:39], a[0:3], v[32:35]
    v_and_b32 v243, 15, v250
    v_mfma_f32_16x16x32_bf16 v[64:67], a[40:43], a[0:3], v[64:67]
    ds_read_b128 a[84:87], v233 offset:14336
    v_lshl_add_u32 v240, v243, 4, v242
    v_mfma_f32_16x16x32_bf16 v[68:71], a[40:43], a[4:7], v[68:71]
    v_bfe_u32 v243, v250, 2, 2
    v_mfma_f32_16x16x32_bf16 v[72:75], a[40:43], a[8:11], v[72:75]
    ds_read_b64_tr_b16 a[92:93], v236 offset:49152
    v_lshl_add_u32 v242, v243, 7, v242
    v_mfma_f32_16x16x32_bf16 v[76:79], a[40:43], a[12:15], v[76:79]
    ds_read_b64_tr_b16 a[94:95], v236 offset:53248
    v_and_b32 v243, 3, v250
    v_mfma_f32_16x16x32_bf16 v[80:83], a[40:43], a[16:19], v[80:83]
    v_lshl_add_u32 v241, v243, 4, v242
    v_mfma_f32_16x16x32_bf16 v[84:87], a[40:43], a[20:23], v[84:87]
    ds_read_b64_tr_b16 a[96:97], v235 offset:50176
    s_mov_b32 s56, 0x3e8293ee
    v_mfma_f32_16x16x32_bf16 v[88:91], a[40:43], a[24:27], v[88:91]
    s_lshl_b32 s57, s100, 18
    v_mfma_f32_16x16x32_bf16 v[92:95], a[40:43], a[28:31], v[92:95]
    ds_read_b64_tr_b16 a[98:99], v235 offset:54272
    s_add_u32 s57, s57, 8388608
    v_mfma_f32_16x16x32_bf16 v[124:127], a[44:47], a[28:31], v[124:127]
    s_add_u32 s16, s4, s57
    s_addc_u32 s17, s5, 0
    v_mfma_f32_16x16x32_bf16 v[120:123], a[44:47], a[24:27], v[120:123]
    ds_read_b64_tr_b16 a[100:101], v236 offset:50176
    s_mov_b32 s18, 262144
    v_mfma_f32_16x16x32_bf16 v[116:119], a[44:47], a[20:23], v[116:119]
    s_mul_i32 s57, s49, 384
    v_mfma_f32_16x16x32_bf16 v[112:115], a[44:47], a[16:19], v[112:115]
    ds_read_b64_tr_b16 a[102:103], v236 offset:54272
    s_add_u32 s57, s57, 90112
    v_mfma_f32_16x16x32_bf16 v[108:111], a[44:47], a[12:15], v[108:111]
    ds_read_b64_tr_b16 a[104:105], v235 offset:51200
    v_and_b32 v248, 48, v250
    v_mfma_f32_16x16x32_bf16 v[104:107], a[44:47], a[8:11], v[104:107]
    v_add_u32 v248, s57, v248
    v_mfma_f32_16x16x32_bf16 v[100:103], a[44:47], a[4:7], v[100:103]
    ds_read_b64_tr_b16 a[106:107], v235 offset:55296
    s_lshl_b32 s52, s48, 9
    v_mfma_f32_16x16x32_bf16 v[96:99], a[44:47], a[0:3], v[96:99]
    s_add_u32 s52, s52, 91136
    v_mfma_f32_16x16x32_bf16 v[128:131], a[0:3], a[48:51], v[128:131]
    ds_read_b64_tr_b16 a[108:109], v236 offset:51200
    v_and_b32 v249, 15, v250
    v_mfma_f32_16x16x32_bf16 v[132:135], a[4:7], a[48:51], v[132:135]
    v_lshl_add_u32 v249, v249, 2, s52
    v_mfma_f32_16x16x32_bf16 v[136:139], a[8:11], a[48:51], v[136:139]
    ds_read_b64_tr_b16 a[110:111], v236 offset:55296
    v_and_b32 v222, 15, v250
    v_mfma_f32_16x16x32_bf16 v[140:143], a[12:15], a[48:51], v[140:143]
    v_lshl_add_u32 v222, v222, 2, s57
    v_mfma_f32_16x16x32_bf16 v[144:147], a[16:19], a[48:51], v[144:147]
    s_add_u32 s96, s97, s45
    v_and_b32 v223, 48, v250
    v_mfma_f32_16x16x32_bf16 v[148:151], a[20:23], a[48:51], v[148:151]
    v_add_u32 v223, s52, v223
    v_mfma_f32_16x16x32_bf16 v[152:155], a[24:27], a[48:51], v[152:155]
    s_add_u32 s97, s97, 32768
    v_mfma_f32_16x16x32_bf16 v[156:159], a[28:31], a[48:51], v[156:159]
    v_mfma_f32_16x16x32_bf16 v[188:191], a[28:31], a[52:55], v[188:191]
    s_cmp_eq_u32 s97, 98304
    s_cselect_b32 s97, 0, s97
    v_mfma_f32_16x16x32_bf16 v[184:187], a[24:27], a[52:55], v[184:187]
    v_mfma_f32_16x16x32_bf16 v[180:183], a[20:23], a[52:55], v[180:183]
    v_add_u32 v232, s97, v234
    v_mfma_f32_16x16x32_bf16 v[176:179], a[16:19], a[52:55], v[176:179]
    v_mfma_f32_16x16x32_bf16 v[172:175], a[12:15], a[52:55], v[172:175]
    v_xor_b32 v233, 64, v232
    v_mfma_f32_16x16x32_bf16 v[168:171], a[8:11], a[52:55], v[168:171]
    v_mfma_f32_16x16x32_bf16 v[164:167], a[4:7], a[52:55], v[164:167]
    v_mfma_f32_16x16x32_bf16 v[160:163], a[0:3], a[52:55], v[160:163]
    s_waitcnt vmcnt(0) lgkmcnt(0)
    s_barrier
    v_mfma_f32_16x16x32_bf16 v[0:3], a[88:91], a[56:59], v[0:3]
    v_mfma_f32_16x16x32_bf16 v[4:7], a[88:91], a[60:63], v[4:7]
    v_mfma_f32_16x16x32_bf16 v[8:11], a[88:91], a[64:67], v[8:11]
    ds_read_b32 v224, v249 offset:0
    v_mfma_f32_16x16x32_bf16 v[12:15], a[88:91], a[68:71], v[12:15]
    v_mfma_f32_16x16x32_bf16 v[16:19], a[88:91], a[72:75], v[16:19]
    ds_read_b32 v225, v249 offset:1024
    v_mfma_f32_16x16x32_bf16 v[20:23], a[88:91], a[76:79], v[20:23]
    v_mfma_f32_16x16x32_bf16 v[24:27], a[88:91], a[80:83], v[24:27]
    ds_read_b32 v226, v249 offset:64
    v_mfma_f32_16x16x32_bf16 v[28:31], a[88:91], a[84:87], v[28:31]
    v_mfma_f32_16x16x32_bf16 v[60:63], a[92:95], a[84:87], v[60:63]
    ds_read_b32 v227, v249 offset:1088
    v_mfma_f32_16x16x32_bf16 v[56:59], a[92:95], a[80:83], v[56:59]
    v_mfma_f32_16x16x32_bf16 v[52:55], a[92:95], a[76:79], v[52:55]
    ds_read_b32 v228, v249 offset:128
    v_mfma_f32_16x16x32_bf16 v[48:51], a[92:95], a[72:75], v[48:51]
    v_mfma_f32_16x16x32_bf16 v[44:47], a[92:95], a[68:71], v[44:47]
    ds_read_b32 v229, v249 offset:1152
    v_mfma_f32_16x16x32_bf16 v[40:43], a[92:95], a[64:67], v[40:43]
    v_mfma_f32_16x16x32_bf16 v[36:39], a[92:95], a[60:63], v[36:39]
    ds_read_b32 v230, v249 offset:192
    v_mfma_f32_16x16x32_bf16 v[32:35], a[92:95], a[56:59], v[32:35]
    v_mfma_f32_16x16x32_bf16 v[64:67], a[96:99], a[56:59], v[64:67]
    ds_read_b32 v231, v249 offset:1216
    v_mfma_f32_16x16x32_bf16 v[68:71], a[96:99], a[60:63], v[68:71]
    v_mfma_f32_16x16x32_bf16 v[72:75], a[96:99], a[64:67], v[72:75]
    ds_read_b32 v232, v249 offset:256
    v_mfma_f32_16x16x32_bf16 v[76:79], a[96:99], a[68:71], v[76:79]
    v_mfma_f32_16x16x32_bf16 v[80:83], a[96:99], a[72:75], v[80:83]
    ds_read_b32 v233, v249 offset:1280
    v_mfma_f32_16x16x32_bf16 v[84:87], a[96:99], a[76:79], v[84:87]
    v_mfma_f32_16x16x32_bf16 v[88:91], a[96:99], a[80:83], v[88:91]
    ds_read_b32 v234, v249 offset:320
    v_mfma_f32_16x16x32_bf16 v[92:95], a[96:99], a[84:87], v[92:95]
    v_mfma_f32_16x16x32_bf16 v[124:127], a[100:103], a[84:87], v[124:127]
    ds_read_b32 v235, v249 offset:1344
    v_mfma_f32_16x16x32_bf16 v[120:123], a[100:103], a[80:83], v[120:123]
    v_mfma_f32_16x16x32_bf16 v[116:119], a[100:103], a[76:79], v[116:119]
    ds_read_b32 v236, v249 offset:384
    v_mfma_f32_16x16x32_bf16 v[112:115], a[100:103], a[72:75], v[112:115]
    v_mfma_f32_16x16x32_bf16 v[108:111], a[100:103], a[68:71], v[108:111]
    ds_read_b32 v237, v249 offset:1408
    v_mfma_f32_16x16x32_bf16 v[104:107], a[100:103], a[64:67], v[104:107]
    v_mfma_f32_16x16x32_bf16 v[100:103], a[100:103], a[60:63], v[100:103]
    ds_read_b32 v238, v249 offset:448
    v_mfma_f32_16x16x32_bf16 v[96:99], a[100:103], a[56:59], v[96:99]
    v_mfma_f32_16x16x32_bf16 v[128:131], a[56:59], a[104:107], v[128:131]
    ds_read_b32 v239, v249 offset:1472
    v_mfma_f32_16x16x32_bf16 v[132:135], a[60:63], a[104:107], v[132:135]
    v_mfma_f32_16x16x32_bf16 v[136:139], a[64:67], a[104:107], v[136:139]
    ds_read_b128 v[192:195], v248 offset:0
    v_mfma_f32_16x16x32_bf16 v[140:143], a[68:71], a[104:107], v[140:143]
    v_mfma_f32_16x16x32_bf16 v[144:147], a[72:75], a[104:107], v[144:147]
    ds_read_b128 v[196:199], v248 offset:64
    v_mfma_f32_16x16x32_bf16 v[148:151], a[76:79], a[104:107], v[148:151]
    v_mfma_f32_16x16x32_bf16 v[152:155], a[80:83], a[104:107], v[152:155]
    ds_read_b128 v[200:203], v248 offset:128
    v_mfma_f32_16x16x32_bf16 v[156:159], a[84:87], a[104:107], v[156:159]
    v_mfma_f32_16x16x32_bf16 v[188:191], a[84:87], a[108:111], v[188:191]
    ds_read_b128 v[204:207], v248 offset:192
    v_mfma_f32_16x16x32_bf16 v[184:187], a[80:83], a[108:111], v[184:187]
    v_mfma_f32_16x16x32_bf16 v[180:183], a[76:79], a[108:111], v[180:183]
    ds_read_b32 v208, v222 offset:256
    v_mfma_f32_16x16x32_bf16 v[176:179], a[72:75], a[108:111], v[176:179]
    v_mfma_f32_16x16x32_bf16 v[172:175], a[68:71], a[108:111], v[172:175]
    ds_read_b32 v210, v222 offset:320
    v_mfma_f32_16x16x32_bf16 v[168:171], a[64:67], a[108:111], v[168:171]
    v_mfma_f32_16x16x32_bf16 v[164:167], a[60:63], a[108:111], v[164:167]
    v_mfma_f32_16x16x32_bf16 v[160:163], a[56:59], a[108:111], v[160:163]
    s_add_u32 s24, s4, 0
    s_addc_u32 s25, s5, 0
    s_mov_b32 s26, 36700160
    s_mov_b32 s27, 0x00020000
    s_cmp_lg_u32 s49, 0
    s_cselect_b32 s26, s26, 0
    s_cselect_b64 vcc, -1, 0
    s_lshl_b32 s52, s48, 14
    v_add_u32 v211, s52, v241
    v_add_u32 v222, s52, v240
    s_lshl_b32 s52, s48, 13
    s_add_u32 s52, s52, 98304
    v_add_u32 v209, s52, v240
    s_mov_b32 s101, 0
    s_waitcnt lgkmcnt(0)
    s_nop 4
    ds_read_b128 v[212:215], v223 offset:0
    ds_read_b128 v[216:219], v223 offset:64
    ds_read_b128 v[244:247], v223 offset:1024
    ds_read_b64 v[220:221], v223 offset:1088
    ds_read_b64 v[242:243], v223 offset:1096
    v_pk_fma_f32 v[64:65], v[200:201], v[224:225], v[64:65] op_sel_hi:[1,0,1]
    v_pk_fma_f32 v[66:67], v[202:203], v[224:225], v[66:67] op_sel_hi:[1,0,1]
    v_pk_mul_f32 v[64:65], v[64:65], v[224:225] op_sel:[0,1]
    v_pk_mul_f32 v[66:67], v[66:67], v[224:225] op_sel:[0,1]
    v_pk_fma_f32 v[96:97], v[204:205], v[224:225], v[96:97] op_sel_hi:[1,0,1]
    v_pk_fma_f32 v[98:99], v[206:207], v[224:225], v[98:99] op_sel_hi:[1,0,1]
    v_pk_mul_f32 v[96:97], v[96:97], v[224:225] op_sel:[0,1]
    v_pk_mul_f32 v[98:99], v[98:99], v[224:225] op_sel:[0,1]
    v_cvt_pk_bf16_f32 v64, v64, v65
    v_cvt_pk_bf16_f32 v65, v66, v67
    v_cvt_pk_bf16_f32 v66, v96, v97
    v_cvt_pk_bf16_f32 v67, v98, v99
    buffer_store_dwordx4 v[64:67], v241, s[8:11], s54 offen offset:0 sc1
    s_cbranch_vccnz L_ow12
    ds_write_b128 v211, v[64:67] offset:0
L_ow12:
    v_pk_fma_f32 v[68:69], v[200:201], v[226:227], v[68:69] op_sel_hi:[1,0,1]
    v_pk_fma_f32 v[70:71], v[202:203], v[226:227], v[70:71] op_sel_hi:[1,0,1]
    v_pk_mul_f32 v[68:69], v[68:69], v[226:227] op_sel:[0,1]
    v_pk_mul_f32 v[70:71], v[70:71], v[226:227] op_sel:[0,1]
    v_pk_fma_f32 v[100:101], v[204:205], v[226:227], v[100:101] op_sel_hi:[1,0,1]
    v_pk_fma_f32 v[102:103], v[206:207], v[226:227], v[102:103] op_sel_hi:[1,0,1]
    v_pk_mul_f32 v[100:101], v[100:101], v[226:227] op_sel:[0,1]
    v_pk_mul_f32 v[102:103], v[102:103], v[226:227] op_sel:[0,1]
    v_cvt_pk_bf16_f32 v68, v68, v69
    v_cvt_pk_bf16_f32 v69, v70, v71
    v_cvt_pk_bf16_f32 v70, v100, v101
    v_cvt_pk_bf16_f32 v71, v102, v103
    buffer_store_dwordx4 v[68:71], v241, s[8:11], s54 offen offset:64 sc1
    s_cbranch_vccnz L_ow13
    ds_write_b128 v211, v[68:71] offset:64
L_ow13:
    v_mul_f32 v225, s56, v225
    v_pk_fma_f32 v[0:1], v[192:193], v[224:225], v[0:1] op_sel_hi:[1,0,1]
    v_pk_fma_f32 v[2:3], v[194:195], v[224:225], v[2:3] op_sel_hi:[1,0,1]
    v_pk_mul_f32 v[0:1], v[0:1], v[224:225] op_sel:[0,1]
    v_pk_mul_f32 v[2:3], v[2:3], v[224:225] op_sel:[0,1]
    v_pk_fma_f32 v[32:33], v[196:197], v[224:225], v[32:33] op_sel_hi:[1,0,1]
    v_pk_fma_f32 v[34:35], v[198:199], v[224:225], v[34:35] op_sel_hi:[1,0,1]
    v_pk_mul_f32 v[32:33], v[32:33], v[224:225] op_sel:[0,1]
    v_pk_mul_f32 v[34:35], v[34:35], v[224:225] op_sel:[0,1]
    v_cvt_pk_bf16_f32 v0, v0, v1
    v_cvt_pk_bf16_f32 v1, v2, v3
    v_cvt_pk_bf16_f32 v2, v32, v33
    v_cvt_pk_bf16_f32 v3, v34, v35
    buffer_store_dwordx4 v[0:3], v240, s[24:27], s53 offen offset:0 sc1
    s_cbranch_vccnz L_ow14
    ds_write_b128 v209, v[0:3] offset:0
L_ow14:
    v_mul_f32 v227, s56, v227
    v_pk_fma_f32 v[4:5], v[192:193], v[226:227], v[4:5] op_sel_hi:[1,0,1]
    v_pk_fma_f32 v[6:7], v[194:195], v[226:227], v[6:7] op_sel_hi:[1,0,1]
    v_pk_mul_f32 v[4:5], v[4:5], v[226:227] op_sel:[0,1]
    v_pk_mul_f32 v[6:7], v[6:7], v[226:227] op_sel:[0,1]
    v_pk_fma_f32 v[36:37], v[196:197], v[226:227], v[36:37] op_sel_hi:[1,0,1]
    v_pk_fma_f32 v[38:39], v[198:199], v[226:227], v[38:39] op_sel_hi:[1,0,1]
    v_pk_mul_f32 v[36:37], v[36:37], v[226:227] op_sel:[0,1]
    v_pk_mul_f32 v[38:39], v[38:39], v[226:227] op_sel:[0,1]
    v_cvt_pk_bf16_f32 v4, v4, v5
    v_cvt_pk_bf16_f32 v5, v6, v7
    v_cvt_pk_bf16_f32 v6, v36, v37
    v_cvt_pk_bf16_f32 v7, v38, v39
    buffer_store_dwordx4 v[4:7], v240, s[24:27], s53 offen offset:256 sc1
    s_cbranch_vccnz L_ow15
    ds_write_b128 v209, v[4:7] offset:256
L_ow15:
    s_waitcnt lgkmcnt(0)
    v_pk_fma_f32 v[128:129], v[212:213], v[208:209], v[128:129] op_sel_hi:[1,0,1]
    v_pk_fma_f32 v[130:131], v[214:215], v[208:209], v[130:131] op_sel_hi:[1,0,1]
    v_pk_mul_f32 v[128:129], v[128:129], v[244:245]
    v_pk_mul_f32 v[130:131], v[130:131], v[246:247]
    v_pk_fma_f32 v[132:133], v[216:217], v[208:209], v[132:133] op_sel_hi:[1,0,1]
    v_pk_fma_f32 v[134:135], v[218:219], v[208:209], v[134:135] op_sel_hi:[1,0,1]
    v_pk_mul_f32 v[132:133], v[132:133], v[220:221]
    v_pk_mul_f32 v[134:135], v[134:135], v[242:243]
    v_cvt_pk_bf16_f32 v128, v128, v129
    v_cvt_pk_bf16_f32 v129, v130, v131
    v_cvt_pk_bf16_f32 v130, v132, v133
    v_cvt_pk_bf16_f32 v131, v134, v135
    buffer_store_dwordx4 v[128:131], v240, s[8:11], s54 offen offset:2048 sc1
    s_cbranch_vccnz L_ow16
    ds_write_b128 v222, v[128:131] offset:2048
L_ow16:
    v_pk_fma_f32 v[160:161], v[212:213], v[210:211], v[160:161] op_sel_hi:[1,0,1]
    v_pk_fma_f32 v[162:163], v[214:215], v[210:211], v[162:163] op_sel_hi:[1,0,1]
    v_pk_mul_f32 v[160:161], v[160:161], v[244:245]
    v_pk_mul_f32 v[162:163], v[162:163], v[246:247]
    v_pk_fma_f32 v[164:165], v[216:217], v[210:211], v[164:165] op_sel_hi:[1,0,1]
    v_pk_fma_f32 v[166:167], v[218:219], v[210:211], v[166:167] op_sel_hi:[1,0,1]
    v_pk_mul_f32 v[164:165], v[164:165], v[220:221]
    v_pk_mul_f32 v[166:167], v[166:167], v[242:243]
    v_cvt_pk_bf16_f32 v160, v160, v161
    v_cvt_pk_bf16_f32 v161, v162, v163
    v_cvt_pk_bf16_f32 v162, v164, v165
    v_cvt_pk_bf16_f32 v163, v166, v167
    buffer_store_dwordx4 v[160:163], v240, s[8:11], s54 offen offset:2304 sc1
    s_cbranch_vccnz L_ow17
    ds_write_b128 v222, v[160:163] offset:2304
L_ow17:
    s_add_u32 s53, s53, 2048
    s_add_u32 s54, s54, 4096
    ds_read_b128 v[212:215], v223 offset:128
    ds_read_b128 v[216:219], v223 offset:192
    ds_read_b128 v[244:247], v223 offset:1152
    ds_read_b64 v[220:221], v223 offset:1216
    ds_read_b64 v[242:243], v223 offset:1224
    v_pk_fma_f32 v[72:73], v[200:201], v[228:229], v[72:73] op_sel_hi:[1,0,1]
    v_pk_fma_f32 v[74:75], v[202:203], v[228:229], v[74:75] op_sel_hi:[1,0,1]
    v_pk_mul_f32 v[72:73], v[72:73], v[228:229] op_sel:[0,1]
    v_pk_mul_f32 v[74:75], v[74:75], v[228:229] op_sel:[0,1]
    v_pk_fma_f32 v[104:105], v[204:205], v[228:229], v[104:105] op_sel_hi:[1,0,1]
    v_pk_fma_f32 v[106:107], v[206:207], v[228:229], v[106:107] op_sel_hi:[1,0,1]
    v_pk_mul_f32 v[104:105], v[104:105], v[228:229] op_sel:[0,1]
    v_pk_mul_f32 v[106:107], v[106:107], v[228:229] op_sel:[0,1]
    v_cvt_pk_bf16_f32 v72, v72, v73
    v_cvt_pk_bf16_f32 v73, v74, v75
    v_cvt_pk_bf16_f32 v74, v104, v105
    v_cvt_pk_bf16_f32 v75, v106, v107
    buffer_store_dwordx4 v[72:75], v241, s[8:11], s54 offen offset:0 sc1
    s_cbranch_vccnz L_ow18
    ds_write_b128 v211, v[72:75] offset:4096
L_ow18:
    v_pk_fma_f32 v[76:77], v[200:201], v[230:231], v[76:77] op_sel_hi:[1,0,1]
    v_pk_fma_f32 v[78:79], v[202:203], v[230:231], v[78:79] op_sel_hi:[1,0,1]
    v_pk_mul_f32 v[76:77], v[76:77], v[230:231] op_sel:[0,1]
    v_pk_mul_f32 v[78:79], v[78:79], v[230:231] op_sel:[0,1]
    v_pk_fma_f32 v[108:109], v[204:205], v[230:231], v[108:109] op_sel_hi:[1,0,1]
    v_pk_fma_f32 v[110:111], v[206:207], v[230:231], v[110:111] op_sel_hi:[1,0,1]
    v_pk_mul_f32 v[108:109], v[108:109], v[230:231] op_sel:[0,1]
    v_pk_mul_f32 v[110:111], v[110:111], v[230:231] op_sel:[0,1]
    v_cvt_pk_bf16_f32 v76, v76, v77
    v_cvt_pk_bf16_f32 v77, v78, v79
    v_cvt_pk_bf16_f32 v78, v108, v109
    v_cvt_pk_bf16_f32 v79, v110, v111
    buffer_store_dwordx4 v[76:79], v241, s[8:11], s54 offen offset:64 sc1
    s_cbranch_vccnz L_ow19
    ds_write_b128 v211, v[76:79] offset:4160
L_ow19:
    v_mul_f32 v229, s56, v229
    v_pk_fma_f32 v[8:9], v[192:193], v[228:229], v[8:9] op_sel_hi:[1,0,1]
    v_pk_fma_f32 v[10:11], v[194:195], v[228:229], v[10:11] op_sel_hi:[1,0,1]
    v_pk_mul_f32 v[8:9], v[8:9], v[228:229] op_sel:[0,1]
    v_pk_mul_f32 v[10:11], v[10:11], v[228:229] op_sel:[0,1]
    v_pk_fma_f32 v[40:41], v[196:197], v[228:229], v[40:41] op_sel_hi:[1,0,1]
    v_pk_fma_f32 v[42:43], v[198:199], v[228:229], v[42:43] op_sel_hi:[1,0,1]
    v_pk_mul_f32 v[40:41], v[40:41], v[228:229] op_sel:[0,1]
    v_pk_mul_f32 v[42:43], v[42:43], v[228:229] op_sel:[0,1]
    v_cvt_pk_bf16_f32 v8, v8, v9
    v_cvt_pk_bf16_f32 v9, v10, v11
    v_cvt_pk_bf16_f32 v10, v40, v41
    v_cvt_pk_bf16_f32 v11, v42, v43
    buffer_store_dwordx4 v[8:11], v240, s[24:27], s53 offen offset:0 sc1
    s_cbranch_vccnz L_ow20
    ds_write_b128 v209, v[8:11] offset:2048
L_ow20:
    v_mul_f32 v231, s56, v231
    v_pk_fma_f32 v[12:13], v[192:193], v[230:231], v[12:13] op_sel_hi:[1,0,1]
    v_pk_fma_f32 v[14:15], v[194:195], v[230:231], v[14:15] op_sel_hi:[1,0,1]
    v_pk_mul_f32 v[12:13], v[12:13], v[230:231] op_sel:[0,1]
    v_pk_mul_f32 v[14:15], v[14:15], v[230:231] op_sel:[0,1]
    v_pk_fma_f32 v[44:45], v[196:197], v[230:231], v[44:45] op_sel_hi:[1,0,1]
    v_pk_fma_f32 v[46:47], v[198:199], v[230:231], v[46:47] op_sel_hi:[1,0,1]
    v_pk_mul_f32 v[44:45], v[44:45], v[230:231] op_sel:[0,1]
    v_pk_mul_f32 v[46:47], v[46:47], v[230:231] op_sel:[0,1]
    v_cvt_pk_bf16_f32 v12, v12, v13
    v_cvt_pk_bf16_f32 v13, v14, v15
    v_cvt_pk_bf16_f32 v14, v44, v45
    v_cvt_pk_bf16_f32 v15, v46, v47
    buffer_store_dwordx4 v[12:15], v240, s[24:27], s53 offen offset:256 sc1
    s_cbranch_vccnz L_ow21
    ds_write_b128 v209, v[12:15] offset:2304
L_ow21:
    s_waitcnt lgkmcnt(0)
    v_pk_fma_f32 v[136:137], v[212:213], v[208:209], v[136:137] op_sel_hi:[1,0,1]
    v_pk_fma_f32 v[138:139], v[214:215], v[208:209], v[138:139] op_sel_hi:[1,0,1]
    v_pk_mul_f32 v[136:137], v[136:137], v[244:245]
    v_pk_mul_f32 v[138:139], v[138:139], v[246:247]
    v_pk_fma_f32 v[140:141], v[216:217], v[208:209], v[140:141] op_sel_hi:[1,0,1]
    v_pk_fma_f32 v[142:143], v[218:219], v[208:209], v[142:143] op_sel_hi:[1,0,1]
    v_pk_mul_f32 v[140:141], v[140:141], v[220:221]
    v_pk_mul_f32 v[142:143], v[142:143], v[242:243]
    v_cvt_pk_bf16_f32 v136, v136, v137
    v_cvt_pk_bf16_f32 v137, v138, v139
    v_cvt_pk_bf16_f32 v138, v140, v141
    v_cvt_pk_bf16_f32 v139, v142, v143
    buffer_store_dwordx4 v[136:139], v240, s[8:11], s54 offen offset:2048 sc1
    s_cbranch_vccnz L_ow22
    ds_write_b128 v222, v[136:139] offset:6144
L_ow22:
    v_pk_fma_f32 v[168:169], v[212:213], v[210:211], v[168:169] op_sel_hi:[1,0,1]
    v_pk_fma_f32 v[170:171], v[214:215], v[210:211], v[170:171] op_sel_hi:[1,0,1]
    v_pk_mul_f32 v[168:169], v[168:169], v[244:245]
    v_pk_mul_f32 v[170:171], v[170:171], v[246:247]
    v_pk_fma_f32 v[172:173], v[216:217], v[210:211], v[172:173] op_sel_hi:[1,0,1]
    v_pk_fma_f32 v[174:175], v[218:219], v[210:211], v[174:175] op_sel_hi:[1,0,1]
    v_pk_mul_f32 v[172:173], v[172:173], v[220:221]
    v_pk_mul_f32 v[174:175], v[174:175], v[242:243]
    v_cvt_pk_bf16_f32 v168, v168, v169
    v_cvt_pk_bf16_f32 v169, v170, v171
    v_cvt_pk_bf16_f32 v170, v172, v173
    v_cvt_pk_bf16_f32 v171, v174, v175
    buffer_store_dwordx4 v[168:171], v240, s[8:11], s54 offen offset:2304 sc1
    s_cbranch_vccnz L_ow23
    ds_write_b128 v222, v[168:171] offset:6400
L_ow23:
    s_add_u32 s53, s53, 2048
    s_add_u32 s54, s54, 4096
    ds_read_b128 v[212:215], v223 offset:256
    ds_read_b128 v[216:219], v223 offset:320
    ds_read_b128 v[244:247], v223 offset:1280
    ds_read_b64 v[220:221], v223 offset:1344
    ds_read_b64 v[242:243], v223 offset:1352
    v_pk_fma_f32 v[80:81], v[200:201], v[232:233], v[80:81] op_sel_hi:[1,0,1]
    v_pk_fma_f32 v[82:83], v[202:203], v[232:233], v[82:83] op_sel_hi:[1,0,1]
    v_pk_mul_f32 v[80:81], v[80:81], v[232:233] op_sel:[0,1]
    v_pk_mul_f32 v[82:83], v[82:83], v[232:233] op_sel:[0,1]
    v_pk_fma_f32 v[112:113], v[204:205], v[232:233], v[112:113] op_sel_hi:[1,0,1]
    v_pk_fma_f32 v[114:115], v[206:207], v[232:233], v[114:115] op_sel_hi:[1,0,1]
    v_pk_mul_f32 v[112:113], v[112:113], v[232:233] op_sel:[0,1]
    v_pk_mul_f32 v[114:115], v[114:115], v[232:233] op_sel:[0,1]
    v_cvt_pk_bf16_f32 v80, v80, v81
    v_cvt_pk_bf16_f32 v81, v82, v83
    v_cvt_pk_bf16_f32 v82, v112, v113
    v_cvt_pk_bf16_f32 v83, v114, v115
    buffer_store_dwordx4 v[80:83], v241, s[8:11], s54 offen offset:0 sc1
    s_cbranch_vccnz L_ow24
    ds_write_b128 v211, v[80:83] offset:8192
L_ow24:
    v_pk_fma_f32 v[84:85], v[200:201], v[234:235], v[84:85] op_sel_hi:[1,0,1]
    v_pk_fma_f32 v[86:87], v[202:203], v[234:235], v[86:87] op_sel_hi:[1,0,1]
    v_pk_mul_f32 v[84:85], v[84:85], v[234:235] op_sel:[0,1]
    v_pk_mul_f32 v[86:87], v[86:87], v[234:235] op_sel:[0,1]
    v_pk_fma_f32 v[116:117], v[204:205], v[234:235], v[116:117] op_sel_hi:[1,0,1]
    v_pk_fma_f32 v[118:119], v[206:207], v[234:235], v[118:119] op_sel_hi:[1,0,1]
    v_pk_mul_f32 v[116:117], v[116:117], v[234:235] op_sel:[0,1]
    v_pk_mul_f32 v[118:119], v[118:119], v[234:235] op_sel:[0,1]
    v_cvt_pk_bf16_f32 v84, v84, v85
    v_cvt_pk_bf16_f32 v85, v86, v87
    v_cvt_pk_bf16_f32 v86, v116, v117
    v_cvt_pk_bf16_f32 v87, v118, v119
    buffer_store_dwordx4 v[84:87], v241, s[8:11], s54 offen offset:64 sc1
    s_cbranch_vccnz L_ow25
    ds_write_b128 v211, v[84:87] offset:8256
L_ow25:
    v_mul_f32 v233, s56, v233
    v_pk_fma_f32 v[16:17], v[192:193], v[232:233], v[16:17] op_sel_hi:[1,0,1]
    v_pk_fma_f32 v[18:19], v[194:195], v[232:233], v[18:19] op_sel_hi:[1,0,1]
    v_pk_mul_f32 v[16:17], v[16:17], v[232:233] op_sel:[0,1]
    v_pk_mul_f32 v[18:19], v[18:19], v[232:233] op_sel:[0,1]
    v_pk_fma_f32 v[48:49], v[196:197], v[232:233], v[48:49] op_sel_hi:[1,0,1]
    v_pk_fma_f32 v[50:51], v[198:199], v[232:233], v[50:51] op_sel_hi:[1,0,1]
    v_pk_mul_f32 v[48:49], v[48:49], v[232:233] op_sel:[0,1]
    v_pk_mul_f32 v[50:51], v[50:51], v[232:233] op_sel:[0,1]
    v_cvt_pk_bf16_f32 v16, v16, v17
    v_cvt_pk_bf16_f32 v17, v18, v19
    v_cvt_pk_bf16_f32 v18, v48, v49
    v_cvt_pk_bf16_f32 v19, v50, v51
    buffer_store_dwordx4 v[16:19], v240, s[24:27], s53 offen offset:0 sc1
    s_cbranch_vccnz L_ow26
    ds_write_b128 v209, v[16:19] offset:4096
L_ow26:
    v_mul_f32 v235, s56, v235
    v_pk_fma_f32 v[20:21], v[192:193], v[234:235], v[20:21] op_sel_hi:[1,0,1]
    v_pk_fma_f32 v[22:23], v[194:195], v[234:235], v[22:23] op_sel_hi:[1,0,1]
    v_pk_mul_f32 v[20:21], v[20:21], v[234:235] op_sel:[0,1]
    v_pk_mul_f32 v[22:23], v[22:23], v[234:235] op_sel:[0,1]
    v_pk_fma_f32 v[52:53], v[196:197], v[234:235], v[52:53] op_sel_hi:[1,0,1]
    v_pk_fma_f32 v[54:55], v[198:199], v[234:235], v[54:55] op_sel_hi:[1,0,1]
    v_pk_mul_f32 v[52:53], v[52:53], v[234:235] op_sel:[0,1]
    v_pk_mul_f32 v[54:55], v[54:55], v[234:235] op_sel:[0,1]
    v_cvt_pk_bf16_f32 v20, v20, v21
    v_cvt_pk_bf16_f32 v21, v22, v23
    v_cvt_pk_bf16_f32 v22, v52, v53
    v_cvt_pk_bf16_f32 v23, v54, v55
    buffer_store_dwordx4 v[20:23], v240, s[24:27], s53 offen offset:256 sc1
    s_cbranch_vccnz L_ow27
    ds_write_b128 v209, v[20:23] offset:4352
L_ow27:
    s_waitcnt lgkmcnt(0)
    v_pk_fma_f32 v[144:145], v[212:213], v[208:209], v[144:145] op_sel_hi:[1,0,1]
    v_pk_fma_f32 v[146:147], v[214:215], v[208:209], v[146:147] op_sel_hi:[1,0,1]
    v_pk_mul_f32 v[144:145], v[144:145], v[244:245]
    v_pk_mul_f32 v[146:147], v[146:147], v[246:247]
    v_pk_fma_f32 v[148:149], v[216:217], v[208:209], v[148:149] op_sel_hi:[1,0,1]
    v_pk_fma_f32 v[150:151], v[218:219], v[208:209], v[150:151] op_sel_hi:[1,0,1]
    v_pk_mul_f32 v[148:149], v[148:149], v[220:221]
    v_pk_mul_f32 v[150:151], v[150:151], v[242:243]
    v_cvt_pk_bf16_f32 v144, v144, v145
    v_cvt_pk_bf16_f32 v145, v146, v147
    v_cvt_pk_bf16_f32 v146, v148, v149
    v_cvt_pk_bf16_f32 v147, v150, v151
    buffer_store_dwordx4 v[144:147], v240, s[8:11], s54 offen offset:2048 sc1
    s_cbranch_vccnz L_ow28
    ds_write_b128 v222, v[144:147] offset:10240
L_ow28:
    v_pk_fma_f32 v[176:177], v[212:213], v[210:211], v[176:177] op_sel_hi:[1,0,1]
    v_pk_fma_f32 v[178:179], v[214:215], v[210:211], v[178:179] op_sel_hi:[1,0,1]
    v_pk_mul_f32 v[176:177], v[176:177], v[244:245]
    v_pk_mul_f32 v[178:179], v[178:179], v[246:247]
    v_pk_fma_f32 v[180:181], v[216:217], v[210:211], v[180:181] op_sel_hi:[1,0,1]
    v_pk_fma_f32 v[182:183], v[218:219], v[210:211], v[182:183] op_sel_hi:[1,0,1]
    v_pk_mul_f32 v[180:181], v[180:181], v[220:221]
    v_pk_mul_f32 v[182:183], v[182:183], v[242:243]
    v_cvt_pk_bf16_f32 v176, v176, v177
    v_cvt_pk_bf16_f32 v177, v178, v179
    v_cvt_pk_bf16_f32 v178, v180, v181
    v_cvt_pk_bf16_f32 v179, v182, v183
    buffer_store_dwordx4 v[176:179], v240, s[8:11], s54 offen offset:2304 sc1
    s_cbranch_vccnz L_ow29
    ds_write_b128 v222, v[176:179] offset:10496
L_ow29:
    s_add_u32 s53, s53, 2048
    s_add_u32 s54, s54, 4096
    ds_read_b128 v[212:215], v223 offset:384
    ds_read_b128 v[216:219], v223 offset:448
    ds_read_b128 v[244:247], v223 offset:1408
    ds_read_b64 v[220:221], v223 offset:1472
    ds_read_b64 v[242:243], v223 offset:1480
    v_pk_fma_f32 v[88:89], v[200:201], v[236:237], v[88:89] op_sel_hi:[1,0,1]
    v_pk_fma_f32 v[90:91], v[202:203], v[236:237], v[90:91] op_sel_hi:[1,0,1]
    v_pk_mul_f32 v[88:89], v[88:89], v[236:237] op_sel:[0,1]
    v_pk_mul_f32 v[90:91], v[90:91], v[236:237] op_sel:[0,1]
    v_pk_fma_f32 v[120:121], v[204:205], v[236:237], v[120:121] op_sel_hi:[1,0,1]
    v_pk_fma_f32 v[122:123], v[206:207], v[236:237], v[122:123] op_sel_hi:[1,0,1]
    v_pk_mul_f32 v[120:121], v[120:121], v[236:237] op_sel:[0,1]
    v_pk_mul_f32 v[122:123], v[122:123], v[236:237] op_sel:[0,1]
    v_cvt_pk_bf16_f32 v88, v88, v89
    v_cvt_pk_bf16_f32 v89, v90, v91
    v_cvt_pk_bf16_f32 v90, v120, v121
    v_cvt_pk_bf16_f32 v91, v122, v123
    buffer_store_dwordx4 v[88:91], v241, s[8:11], s54 offen offset:0 sc1
    s_cbranch_vccnz L_ow30
    ds_write_b128 v211, v[88:91] offset:12288
L_ow30:
    v_pk_fma_f32 v[92:93], v[200:201], v[238:239], v[92:93] op_sel_hi:[1,0,1]
    v_pk_fma_f32 v[94:95], v[202:203], v[238:239], v[94:95] op_sel_hi:[1,0,1]
    v_pk_mul_f32 v[92:93], v[92:93], v[238:239] op_sel:[0,1]
    v_pk_mul_f32 v[94:95], v[94:95], v[238:239] op_sel:[0,1]
    v_pk_fma_f32 v[124:125], v[204:205], v[238:239], v[124:125] op_sel_hi:[1,0,1]
    v_pk_fma_f32 v[126:127], v[206:207], v[238:239], v[126:127] op_sel_hi:[1,0,1]
    v_pk_mul_f32 v[124:125], v[124:125], v[238:239] op_sel:[0,1]
    v_pk_mul_f32 v[126:127], v[126:127], v[238:239] op_sel:[0,1]
    v_cvt_pk_bf16_f32 v92, v92, v93
    v_cvt_pk_bf16_f32 v93, v94, v95
    v_cvt_pk_bf16_f32 v94, v124, v125
    v_cvt_pk_bf16_f32 v95, v126, v127
    buffer_store_dwordx4 v[92:95], v241, s[8:11], s54 offen offset:64 sc1
    s_cbranch_vccnz L_ow31
    ds_write_b128 v211, v[92:95] offset:12352
L_ow31:
    v_mul_f32 v237, s56, v237
    v_pk_fma_f32 v[24:25], v[192:193], v[236:237], v[24:25] op_sel_hi:[1,0,1]
    v_pk_fma_f32 v[26:27], v[194:195], v[236:237], v[26:27] op_sel_hi:[1,0,1]
    v_pk_mul_f32 v[24:25], v[24:25], v[236:237] op_sel:[0,1]
    v_pk_mul_f32 v[26:27], v[26:27], v[236:237] op_sel:[0,1]
    v_pk_fma_f32 v[56:57], v[196:197], v[236:237], v[56:57] op_sel_hi:[1,0,1]
    v_pk_fma_f32 v[58:59], v[198:199], v[236:237], v[58:59] op_sel_hi:[1,0,1]
    v_pk_mul_f32 v[56:57], v[56:57], v[236:237] op_sel:[0,1]
    v_pk_mul_f32 v[58:59], v[58:59], v[236:237] op_sel:[0,1]
    v_cvt_pk_bf16_f32 v24, v24, v25
    v_cvt_pk_bf16_f32 v25, v26, v27
    v_cvt_pk_bf16_f32 v26, v56, v57
    v_cvt_pk_bf16_f32 v27, v58, v59
    buffer_store_dwordx4 v[24:27], v240, s[24:27], s53 offen offset:0 sc1
    s_cbranch_vccnz L_ow32
    ds_write_b128 v209, v[24:27] offset:6144
L_ow32:
    v_mul_f32 v239, s56, v239
    v_pk_fma_f32 v[28:29], v[192:193], v[238:239], v[28:29] op_sel_hi:[1,0,1]
    v_pk_fma_f32 v[30:31], v[194:195], v[238:239], v[30:31] op_sel_hi:[1,0,1]
    v_pk_mul_f32 v[28:29], v[28:29], v[238:239] op_sel:[0,1]
    v_pk_mul_f32 v[30:31], v[30:31], v[238:239] op_sel:[0,1]
    v_pk_fma_f32 v[60:61], v[196:197], v[238:239], v[60:61] op_sel_hi:[1,0,1]
    v_pk_fma_f32 v[62:63], v[198:199], v[238:239], v[62:63] op_sel_hi:[1,0,1]
    v_pk_mul_f32 v[60:61], v[60:61], v[238:239] op_sel:[0,1]
    v_pk_mul_f32 v[62:63], v[62:63], v[238:239] op_sel:[0,1]
    v_cvt_pk_bf16_f32 v28, v28, v29
    v_cvt_pk_bf16_f32 v29, v30, v31
    v_cvt_pk_bf16_f32 v30, v60, v61
    v_cvt_pk_bf16_f32 v31, v62, v63
    buffer_store_dwordx4 v[28:31], v240, s[24:27], s53 offen offset:256 sc1
    s_cbranch_vccnz L_ow33
    ds_write_b128 v209, v[28:31] offset:6400
L_ow33:
    s_waitcnt lgkmcnt(0)
    v_pk_fma_f32 v[152:153], v[212:213], v[208:209], v[152:153] op_sel_hi:[1,0,1]
    v_pk_fma_f32 v[154:155], v[214:215], v[208:209], v[154:155] op_sel_hi:[1,0,1]
    v_pk_mul_f32 v[152:153], v[152:153], v[244:245]
    v_pk_mul_f32 v[154:155], v[154:155], v[246:247]
    v_pk_fma_f32 v[156:157], v[216:217], v[208:209], v[156:157] op_sel_hi:[1,0,1]
    v_pk_fma_f32 v[158:159], v[218:219], v[208:209], v[158:159] op_sel_hi:[1,0,1]
    v_pk_mul_f32 v[156:157], v[156:157], v[220:221]
    v_pk_mul_f32 v[158:159], v[158:159], v[242:243]
    v_cvt_pk_bf16_f32 v152, v152, v153
    v_cvt_pk_bf16_f32 v153, v154, v155
    v_cvt_pk_bf16_f32 v154, v156, v157
    v_cvt_pk_bf16_f32 v155, v158, v159
    buffer_store_dwordx4 v[152:155], v240, s[8:11], s54 offen offset:2048 sc1
    s_cbranch_vccnz L_ow34
    ds_write_b128 v222, v[152:155] offset:14336
L_ow34:
    v_pk_fma_f32 v[184:185], v[212:213], v[210:211], v[184:185] op_sel_hi:[1,0,1]
    v_pk_fma_f32 v[186:187], v[214:215], v[210:211], v[186:187] op_sel_hi:[1,0,1]
    v_pk_mul_f32 v[184:185], v[184:185], v[244:245]
    v_pk_mul_f32 v[186:187], v[186:187], v[246:247]
    v_pk_fma_f32 v[188:189], v[216:217], v[210:211], v[188:189] op_sel_hi:[1,0,1]
    v_pk_fma_f32 v[190:191], v[218:219], v[210:211], v[190:191] op_sel_hi:[1,0,1]
    v_pk_mul_f32 v[188:189], v[188:189], v[220:221]
    v_pk_mul_f32 v[190:191], v[190:191], v[242:243]
    v_cvt_pk_bf16_f32 v184, v184, v185
    v_cvt_pk_bf16_f32 v185, v186, v187
    v_cvt_pk_bf16_f32 v186, v188, v189
    v_cvt_pk_bf16_f32 v187, v190, v191
    buffer_store_dwordx4 v[184:187], v240, s[8:11], s54 offen offset:2304 sc1
    s_cbranch_vccnz L_ow35
    ds_write_b128 v222, v[184:187] offset:14592
L_ow35:
    s_add_u32 s53, s53, 2048
    s_add_u32 s54, s54, 4096
    s_waitcnt lgkmcnt(0)
    s_add_u32 s24, s4, 0
    s_addc_u32 s25, s5, 0
    s_mov_b32 s26, 0
    s_mov_b32 s27, 0x00020000
    s_mov_b32 s49, 0
    s_mov_b32 s50, 0
    s_mov_b32 s55, 0
    s_mov_b32 s56, 0
    v_mov_b32 v220, v251
    v_mfma_f32_32x32x16_bf16 v[80:95], a[128:131], a[128:131], 0
    v_mfma_f32_32x32x16_bf16 v[96:111], a[128:131], a[128:131], 0
    v_and_b32 v232, 7, v250
    v_cmp_eq_u32 vcc, 0, v232
    v_cmp_eq_u32 s[88:89], 4, v232
    v_mov_b32 v234, 0x3f803f80
    v_mov_b32 v221, 0xdddddddd
    v_cndmask_b32 v184, 0, v234, vcc
    v_cndmask_b32 v186, 0, v234, s[88:89]
    v_mov_b32 v185, v184
    v_mov_b32 v187, v186
    s_add_u32 s98, s95, 65536
    s_mov_b32 s97, 0
    v_mov_b64 v[112:113], 0
    v_mov_b64 v[114:115], 0
    v_mov_b64 v[116:117], 0
    v_mov_b64 v[118:119], 0
    v_mov_b64 v[144:145], 0
    v_mov_b64 v[146:147], 0
    v_mov_b64 v[148:149], 0
    v_mov_b64 v[150:151], 0
    v_mov_b64 v[180:181], 0
    v_mov_b64 v[182:183], 0
    s_lshr_b32 s52, s41, 1
    s_lshl_b32 s52, s52, 2
    s_and_b32 s53, s42, 3
    s_add_u32 s46, s52, s53
    s_lshr_b32 s52, s46, 1
    s_lshl_b32 s52, s52, 7
    s_add_u32 s52, s52, 2048
    v_and_b32 v232, 15, v250
    v_lshl_add_u32 v230, v232, 3, s52
    s_add_u32 s12, s30, 0
    s_addc_u32 s13, s31, 0
    s_mov_b32 s14, 7340032
    s_mov_b32 s15, 0x00020000
    s_and_b32 s52, s41, 1
    s_lshl_b32 s52, s52, 3
    s_lshr_b32 s53, s42, 2
    s_add_u32 s48, s52, s53
    s_xor_b32 s48, s48, 4
    s_lshl_b32 s52, s46, 13
    s_add_u32 s53, s40, 1
    s_and_b32 s53, s53, 3
    s_lshl_b32 s53, s53, 11
    s_add_u32 s53, s53, s52
    v_add_u32 v222, s53, v251
    s_add_u32 s53, s40, 2
    s_and_b32 s53, s53, 3
    s_lshl_b32 s53, s53, 11
    s_add_u32 s53, s53, s52
    v_add_u32 v223, s53, v251
    s_add_u32 s53, s40, 3
    s_and_b32 s53, s53, 3
    s_lshl_b32 s53, s53, 11
    s_add_u32 s53, s53, s52
    v_add_u32 v246, s53, v251
    s_add_u32 s53, s40, 4
    s_and_b32 s53, s53, 3
    s_lshl_b32 s53, s53, 11
    s_add_u32 s53, s53, s52
    v_add_u32 v247, s53, v251
    v_lshrrev_b32 v232, 5, v250
    v_bfe_u32 v233, v250, 4, 1
    v_bfe_u32 v234, v250, 2, 2
    v_and_b32 v235, 3, v250
    v_lshl_add_u32 v224, v233, 2, v234
    v_lshlrev_b32 v224, 11, v224
    v_lshlrev_b32 v225, 1, v233
    v_xor_b32 v225, v225, v235
    v_lshl_add_u32 v224, v225, 4, v224
    v_lshl_add_u32 v224, v232, 6, v224
    s_lshl_b32 s52, s48, 7
    v_add_u32 v224, s52, v224
    v_add_u32 v225, 15360, v224
    v_add_u32 v226, 30720, v224
    v_add_u32 v227, 46080, v224
    s_lshl_b32 s45, s40, 14
    s_add_u32 s45, s45, 98304
    v_lshl_add_u32 v228, v232, 10, s45
    v_lshl_add_u32 v228, v233, 8, v228
    v_lshl_add_u32 v228, v234, 6, v228
    v_lshl_add_u32 v228, v233, 5, v228
    v_lshl_add_u32 v228, v235, 3, v228
    v_xor_b32 v229, 32, v228
    s_and_b32 s52, s42, 7
    s_lshl_b32 s52, s52, 2
    s_add_u32 s52, s52, s40
    s_lshl_b32 s52, s52, 8
    s_add_u32 s52, s52, 32768
    v_and_b32 v233, 31, v250
    v_lshlrev_b32 v233, 2, v233
    buffer_load_dword v244, v233, s[8:11], s52 offen offset:0 sc1
    buffer_load_dword v245, v233, s[8:11], s52 offen offset:128 sc1
    s_getpc_b64 s[52:53]
L_pc_36:
    s_sub_u32 s52, s52, L_pc_36-parallel_sum__softmax_full_mha__dense_activation_relu__prompt_kernel
    s_subb_u32 s53, s53, 0
    s_lshl_b32 s54, s42, 2
    s_add_u32 s54, s54, s40
    s_and_b32 s54, s54, 63
    s_lshl_b32 s54, s54, 10
    v_add_u32 v248, s54, v251
    v_min_u32 v248, L_code_end-parallel_sum__softmax_full_mha__dense_activation_relu__prompt_kernel-16, v248
    v_mov_b32 v249, s53
    v_add_co_u32 v248, vcc, s52, v248
    s_nop 1
    v_addc_co_u32 v249, vcc, 0, v249, vcc
    s_mul_i32 s43, s40, 3670016
    s_add_u32 s43, s43, 20971520
    s_mul_i32 s44, s40, 1835008
    s_add_u32 s94, s94, 32768
    s_and_b32 s94, s94, 262143
    v_add_u32 v232, 98304, v252
    v_lshlrev_b32 v233, 7, v250
    v_and_b32 v234, 0xf80, v233
    s_add_u32 s53, s99, 131072
    s_sub_u32 s52, s53, 4194304
    s_lshl_b32 s52, s52, 1
    s_add_u32 s52, s52, 8388608
    s_waitcnt vmcnt(0)
    s_barrier
    s_cmp_lg_u32 s40, 0
    s_cbranch_scc1 L_pb37
    v_mov_b32 v238, s6
    v_mov_b32 v239, s7
    buffer_store_dwordx2 v[238:239], off, s[8:11], s92 sc1
L_pb37:
    buffer_load_dword v235, v234, s[8:11], s53 offen sc1
    buffer_load_dword v235, v233, s[8:11], s52 offen sc1
    ds_read_b128 v[0:3], v232 offset:0
    ds_read_b128 v[4:7], v232 offset:1024
    ds_read_b128 v[8:11], v232 offset:2048
    ds_read_b128 v[12:15], v232 offset:3072
L_at_entry:
    s_barrier
    ds_read_b128 v[152:155], v220 offset:0
    ds_read_b128 v[156:159], v220 offset:1024
    ds_read_b128 v[168:171], v220 offset:2048
    ds_read_b128 v[172:175], v220 offset:3072
    s_waitcnt lgkmcnt(0)
    v_mfma_f32_32x32x16_bf16 v[16:31], v[152:155], v[0:3], 0
    v_mfma_f32_32x32x16_bf16 v[16:31], v[156:159], v[4:7], v[16:31]
    v_mfma_f32_32x32x16_bf16 v[32:47], v[152:155], v[8:11], 0
    v_mfma_f32_32x32x16_bf16 v[32:47], v[156:159], v[12:15], v[32:47]
    s_nop 7
    s_nop 1
    v_max3_f32 v232, v16, v17, v18
    v_max3_f32 v232, v232, v19, v20
    v_max3_f32 v232, v232, v21, v22
    v_max3_f32 v232, v232, v23, v24
    v_max3_f32 v232, v232, v25, v26
    v_max3_f32 v232, v232, v27, v28
    v_max3_f32 v232, v232, v29, v30
    v_max_f32 v232, v232, v31
    v_mov_b32 v234, v232
    s_nop 1
    v_permlane32_swap_b32 v232, v234
    v_max_f32 v232, v232, v234
    v_sub_f32 v48, 0, v232
    v_sub_f32 v49, 0, v232
    v_mov_b64 v[50:51], v[48:49]
    v_mov_b64 v[52:53], v[48:49]
    v_mov_b64 v[54:55], v[48:49]
    v_mov_b64 v[56:57], v[48:49]
    v_mov_b64 v[58:59], v[48:49]
    v_mov_b64 v[60:61], v[48:49]
    v_mov_b64 v[62:63], v[48:49]
    v_pk_add_f32 v[16:17], v[16:17], v[48:49]
    v_pk_add_f32 v[18:19], v[18:19], v[48:49]
    v_pk_add_f32 v[20:21], v[20:21], v[48:49]
    v_pk_add_f32 v[22:23], v[22:23], v[48:49]
    v_pk_add_f32 v[24:25], v[24:25], v[48:49]
    v_pk_add_f32 v[26:27], v[26:27], v[48:49]
    v_pk_add_f32 v[28:29], v[28:29], v[48:49]
    v_pk_add_f32 v[30:31], v[30:31], v[48:49]
    v_max3_f32 v232, v32, v33, v34
    v_max3_f32 v232, v232, v35, v36
    v_max3_f32 v232, v232, v37, v38
    v_max3_f32 v232, v232, v39, v40
    v_max3_f32 v232, v232, v41, v42
    v_max3_f32 v232, v232, v43, v44
    v_max3_f32 v232, v232, v45, v46
    v_max_f32 v232, v232, v47
    v_mov_b32 v234, v232
    s_nop 1
    v_permlane32_swap_b32 v232, v234
    v_max_f32 v232, v232, v234
    v_sub_f32 v64, 0, v232
    v_sub_f32 v65, 0, v232
    v_mov_b64 v[66:67], v[64:65]
    v_mov_b64 v[68:69], v[64:65]
    v_mov_b64 v[70:71], v[64:65]
    v_mov_b64 v[72:73], v[64:65]
    v_mov_b64 v[74:75], v[64:65]
    v_mov_b64 v[76:77], v[64:65]
    v_mov_b64 v[78:79], v[64:65]
    s_nop 1
    v_mfma_f32_32x32x16_bf16 v[32:47], v[152:155], v[8:11], v[64:79]
    ds_read_b128 v[160:163], v220 offset:4096
    v_exp_f32 v120, v16
    v_exp_f32 v121, v17
    v_exp_f32 v122, v18
    v_mfma_f32_32x32x16_bf16 v[32:47], v[156:159], v[12:15], v[32:47]
    ds_read_b128 v[164:167], v220 offset:5120
    v_exp_f32 v123, v19
    v_exp_f32 v124, v20
    v_exp_f32 v125, v21
    v_smfmac_f32_32x32x32_bf16 v[96:111], v[180:183], v[144:151], v221
    buffer_store_dwordx2 a[0:1], v242, s[24:27], s50 offen offset:0 sc1
    v_exp_f32 v126, v22
    v_exp_f32 v127, v23
    v_exp_f32 v128, v24
    v_smfmac_f32_16x16x64_bf16 v[116:119], v[184:187], v[144:151], v221
    buffer_store_dwordx2 a[4:5], v242, s[24:27], s50 offen offset:1024 sc1
    v_exp_f32 v129, v25
    v_exp_f32 v130, v26
    v_smfmac_f32_32x32x32_bf16 v[80:95], v[168:171], v[120:127], v221
    buffer_load_dwordx2 v[254:255], v253, s[8:11], 0 offen sc1
    v_exp_f32 v131, v27
    v_exp_f32 v132, v28
    v_exp_f32 v133, v29
    v_smfmac_f32_16x16x64_bf16 v[112:115], v[184:187], v[120:127], v221
    s_waitcnt lgkmcnt(0)
    v_exp_f32 v134, v30
    v_exp_f32 v135, v31
    v_mfma_f32_32x32x16_bf16 v[16:31], v[160:163], v[0:3], v[48:63]
    ds_read_b128 v[176:179], v220 offset:6144
    v_exp_f32 v136, v32
    v_exp_f32 v137, v33
    v_exp_f32 v138, v34
    v_mfma_f32_32x32x16_bf16 v[16:31], v[164:167], v[4:7], v[16:31]
    ds_read_b128 v[180:183], v220 offset:7168
    v_exp_f32 v139, v35
    v_exp_f32 v140, v36
    v_exp_f32 v141, v37
    v_smfmac_f32_32x32x32_bf16 v[80:95], v[172:175], v[128:135], v221
    buffer_store_dwordx2 a[8:9], v242, s[24:27], s50 offen offset:2048 sc1
    v_exp_f32 v142, v38
    v_exp_f32 v143, v39
    v_exp_f32 v144, v40
    v_smfmac_f32_16x16x64_bf16 v[112:115], v[184:187], v[128:135], v221
    buffer_store_dwordx2 a[12:13], v242, s[24:27], s50 offen offset:3072 sc1
    v_exp_f32 v145, v41
    v_exp_f32 v146, v42
    v_smfmac_f32_32x32x32_bf16 v[96:111], v[168:171], v[136:143], v221
    v_exp_f32 v147, v43
    v_exp_f32 v148, v44
    v_exp_f32 v149, v45
    v_smfmac_f32_16x16x64_bf16 v[116:119], v[184:187], v[136:143], v221
    s_waitcnt lgkmcnt(0)
    v_exp_f32 v150, v46
    v_exp_f32 v151, v47
    v_mfma_f32_32x32x16_bf16 v[32:47], v[160:163], v[8:11], v[64:79]
    ds_read_b128 v[152:155], v220 offset:8192
    v_exp_f32 v120, v16
    v_exp_f32 v121, v17
    v_exp_f32 v122, v18
    v_mfma_f32_32x32x16_bf16 v[32:47], v[164:167], v[12:15], v[32:47]
    ds_read_b128 v[156:159], v220 offset:9216
    v_exp_f32 v123, v19
    v_exp_f32 v124, v20
    v_exp_f32 v125, v21
    v_smfmac_f32_32x32x32_bf16 v[96:111], v[172:175], v[144:151], v221
    buffer_store_dwordx2 a[16:17], v243, s[24:27], s50 offen offset:0 sc1
    v_exp_f32 v126, v22
    v_exp_f32 v127, v23
    v_exp_f32 v128, v24
    v_smfmac_f32_16x16x64_bf16 v[116:119], v[184:187], v[144:151], v221
    buffer_store_dwordx2 a[20:21], v243, s[24:27], s50 offen offset:1024 sc1
    v_exp_f32 v129, v25
    v_exp_f32 v130, v26
    v_smfmac_f32_32x32x32_bf16 v[80:95], v[176:179], v[120:127], v221
    v_exp_f32 v131, v27
    v_exp_f32 v132, v28
    v_exp_f32 v133, v29
    v_smfmac_f32_16x16x64_bf16 v[112:115], v[184:187], v[120:127], v221
    s_waitcnt lgkmcnt(0)
    v_exp_f32 v134, v30
    v_exp_f32 v135, v31
    v_mfma_f32_32x32x16_bf16 v[16:31], v[152:155], v[0:3], v[48:63]
    ds_read_b128 v[168:171], v220 offset:10240
    v_exp_f32 v136, v32
    v_exp_f32 v137, v33
    v_exp_f32 v138, v34
    v_mfma_f32_32x32x16_bf16 v[16:31], v[156:159], v[4:7], v[16:31]
    ds_read_b128 v[172:175], v220 offset:11264
    v_exp_f32 v139, v35
    v_exp_f32 v140, v36
    v_exp_f32 v141, v37
    v_smfmac_f32_32x32x32_bf16 v[80:95], v[180:183], v[128:135], v221
    buffer_store_dwordx2 a[24:25], v243, s[24:27], s50 offen offset:2048 sc1
    v_exp_f32 v142, v38
    v_exp_f32 v143, v39
    v_exp_f32 v144, v40
    v_smfmac_f32_16x16x64_bf16 v[112:115], v[184:187], v[128:135], v221
    buffer_store_dwordx2 a[28:29], v243, s[24:27], s50 offen offset:3072 sc1
    v_exp_f32 v145, v41
    v_exp_f32 v146, v42
    v_smfmac_f32_32x32x32_bf16 v[96:111], v[176:179], v[136:143], v221
    v_exp_f32 v147, v43
    v_exp_f32 v148, v44
    v_exp_f32 v149, v45
    v_smfmac_f32_16x16x64_bf16 v[116:119], v[184:187], v[136:143], v221
    s_waitcnt lgkmcnt(0)
    v_exp_f32 v150, v46
    v_exp_f32 v151, v47
    v_mfma_f32_32x32x16_bf16 v[32:47], v[152:155], v[8:11], v[64:79]
    ds_read_b128 v[160:163], v220 offset:12288
    v_exp_f32 v120, v16
    v_exp_f32 v121, v17
    v_exp_f32 v122, v18
    v_mfma_f32_32x32x16_bf16 v[32:47], v[156:159], v[12:15], v[32:47]
    ds_read_b128 v[164:167], v220 offset:13312
    v_exp_f32 v123, v19
    v_exp_f32 v124, v20
    v_exp_f32 v125, v21
    v_smfmac_f32_32x32x32_bf16 v[96:111], v[180:183], v[144:151], v221
    buffer_store_dwordx4 a[32:35], v240, s[24:27], s49 offen offset:2048 sc1
    v_exp_f32 v126, v22
    v_exp_f32 v127, v23
    v_exp_f32 v128, v24
    v_smfmac_f32_16x16x64_bf16 v[116:119], v[184:187], v[144:151], v221
    buffer_store_dwordx4 a[36:39], v240, s[24:27], s49 offen offset:3072 sc1
    v_exp_f32 v129, v25
    v_exp_f32 v130, v26
    v_smfmac_f32_32x32x32_bf16 v[80:95], v[168:171], v[120:127], v221
    v_exp_f32 v131, v27
    v_exp_f32 v132, v28
    v_exp_f32 v133, v29
    v_smfmac_f32_16x16x64_bf16 v[112:115], v[184:187], v[120:127], v221
    s_waitcnt lgkmcnt(0)
    v_exp_f32 v134, v30
    v_exp_f32 v135, v31
    v_mfma_f32_32x32x16_bf16 v[16:31], v[160:163], v[0:3], v[48:63]
    ds_read_b128 v[176:179], v220 offset:14336
    v_exp_f32 v136, v32
    v_exp_f32 v137, v33
    v_exp_f32 v138, v34
    v_mfma_f32_32x32x16_bf16 v[16:31], v[164:167], v[4:7], v[16:31]
    ds_read_b128 v[180:183], v220 offset:15360
    v_exp_f32 v139, v35
    v_exp_f32 v140, v36
    v_exp_f32 v141, v37
    v_smfmac_f32_32x32x32_bf16 v[80:95], v[172:175], v[128:135], v221
    buffer_store_dwordx4 a[40:43], v241, s[24:27], s49 offen offset:0 sc1
    v_exp_f32 v142, v38
    v_exp_f32 v143, v39
    v_exp_f32 v144, v40
    v_smfmac_f32_16x16x64_bf16 v[112:115], v[184:187], v[128:135], v221
    buffer_store_dwordx4 a[44:47], v241, s[24:27], s49 offen offset:1024 sc1
    v_exp_f32 v145, v41
    v_exp_f32 v146, v42
    v_smfmac_f32_32x32x32_bf16 v[96:111], v[168:171], v[136:143], v221
    v_exp_f32 v147, v43
    v_exp_f32 v148, v44
    v_exp_f32 v149, v45
    v_smfmac_f32_16x16x64_bf16 v[116:119], v[184:187], v[136:143], v221
    s_waitcnt lgkmcnt(0)
    v_exp_f32 v150, v46
    v_exp_f32 v151, v47
    s_waitcnt vmcnt(10)
    s_mov_b32 s57, 0
    s_branch L_pc38
L_pl38:
    buffer_load_dwordx2 v[254:255], v253, s[8:11], 0 offen sc1
    s_waitcnt vmcnt(0)
L_pc38:
    v_cmp_ne_u64 vcc, s[6:7], v[254:255]
    s_add_u32 s57, s57, 1
    s_nop 0
    s_cbranch_vccz L_pd38
    s_sleep 6
    s_cmp_lt_u32 s57, 0x40000
    s_cbranch_scc1 L_pl38
L_pd38:
    s_barrier
    v_mfma_f32_32x32x16_bf16 v[32:47], v[160:163], v[8:11], v[64:79]
    ds_read_b128 v[152:155], v220 offset:16384
    v_exp_f32 v120, v16
    v_exp_f32 v121, v17
    v_exp_f32 v122, v18
    v_mfma_f32_32x32x16_bf16 v[32:47], v[164:167], v[12:15], v[32:47]
    ds_read_b128 v[156:159], v220 offset:17408
    v_exp_f32 v123, v19
    v_exp_f32 v124, v20
    v_exp_f32 v125, v21
    v_smfmac_f32_32x32x32_bf16 v[96:111], v[172:175], v[144:151], v221
    buffer_store_dwordx4 a[48:51], v241, s[24:27], s49 offen offset:2048 sc1
    v_exp_f32 v126, v22
    v_exp_f32 v127, v23
    v_exp_f32 v128, v24
    v_smfmac_f32_16x16x64_bf16 v[116:119], v[184:187], v[144:151], v221
    s_add_u32 m0, s95, 32768
    s_nop 0
    buffer_load_dwordx4 v252, s[16:19], s94 offen offset:0 sc1 lds
    v_exp_f32 v129, v25
    v_exp_f32 v130, v26
    v_smfmac_f32_32x32x32_bf16 v[80:95], v[176:179], v[120:127], v221
    buffer_load_dwordx4 v252, s[16:19], s94 offen offset:1024 sc1 lds
    v_exp_f32 v131, v27
    v_exp_f32 v132, v28
    v_exp_f32 v133, v29
    v_smfmac_f32_16x16x64_bf16 v[112:115], v[184:187], v[120:127], v221
    s_waitcnt lgkmcnt(0)
    v_exp_f32 v134, v30
    v_exp_f32 v135, v31
    v_mfma_f32_32x32x16_bf16 v[16:31], v[152:155], v[0:3], v[48:63]
    ds_read_b128 v[168:171], v220 offset:18432
    v_exp_f32 v136, v32
    v_exp_f32 v137, v33
    v_exp_f32 v138, v34
    v_mfma_f32_32x32x16_bf16 v[16:31], v[156:159], v[4:7], v[16:31]
    ds_read_b128 v[172:175], v220 offset:19456
    v_exp_f32 v139, v35
    v_exp_f32 v140, v36
    v_exp_f32 v141, v37
    v_smfmac_f32_32x32x32_bf16 v[80:95], v[180:183], v[128:135], v221
    buffer_store_dwordx4 a[52:55], v241, s[24:27], s49 offen offset:3072 sc1
    v_exp_f32 v142, v38
    v_exp_f32 v143, v39
    v_exp_f32 v144, v40
    v_smfmac_f32_16x16x64_bf16 v[112:115], v[184:187], v[128:135], v221
    buffer_load_dwordx4 v252, s[16:19], s94 offen offset:2048 sc1 lds
    v_exp_f32 v145, v41
    v_exp_f32 v146, v42
    v_smfmac_f32_32x32x32_bf16 v[96:111], v[176:179], v[136:143], v221
    buffer_load_dwordx4 v252, s[16:19], s94 offen offset:3072 sc1 lds
    s_add_u32 s94, s94, 16384
    v_exp_f32 v147, v43
    v_exp_f32 v148, v44
    v_exp_f32 v149, v45
    v_smfmac_f32_16x16x64_bf16 v[116:119], v[184:187], v[136:143], v221
    s_waitcnt lgkmcnt(0)
    v_exp_f32 v150, v46
    v_exp_f32 v151, v47
    v_mfma_f32_32x32x16_bf16 v[32:47], v[152:155], v[8:11], v[64:79]
    ds_read_b128 v[160:163], v220 offset:20480
    v_exp_f32 v120, v16
    v_exp_f32 v121, v17
    v_exp_f32 v122, v18
    v_mfma_f32_32x32x16_bf16 v[32:47], v[156:159], v[12:15], v[32:47]
    ds_read_b128 v[164:167], v220 offset:21504
    v_exp_f32 v123, v19
    v_exp_f32 v124, v20
    v_exp_f32 v125, v21
    v_smfmac_f32_32x32x32_bf16 v[96:111], v[180:183], v[144:151], v221
    buffer_store_dwordx4 a[56:59], v240, s[24:27], s55 offen offset:0 sc1
    v_exp_f32 v126, v22
    v_exp_f32 v127, v23
    v_exp_f32 v128, v24
    v_smfmac_f32_16x16x64_bf16 v[116:119], v[184:187], v[144:151], v221
    s_add_u32 m0, s95, 49152
    s_nop 0
    buffer_load_dwordx4 v252, s[16:19], s94 offen offset:0 sc1 lds
    v_exp_f32 v129, v25
    v_exp_f32 v130, v26
    v_smfmac_f32_32x32x32_bf16 v[80:95], v[168:171], v[120:127], v221
    buffer_load_dwordx4 v252, s[16:19], s94 offen offset:1024 sc1 lds
    v_exp_f32 v131, v27
    v_exp_f32 v132, v28
    v_exp_f32 v133, v29
    v_smfmac_f32_16x16x64_bf16 v[112:115], v[184:187], v[120:127], v221
    s_waitcnt lgkmcnt(0)
    v_exp_f32 v134, v30
    v_exp_f32 v135, v31
    v_mfma_f32_32x32x16_bf16 v[16:31], v[160:163], v[0:3], v[48:63]
    ds_read_b128 v[176:179], v220 offset:22528
    v_exp_f32 v136, v32
    v_exp_f32 v137, v33
    v_exp_f32 v138, v34
    v_mfma_f32_32x32x16_bf16 v[16:31], v[164:167], v[4:7], v[16:31]
    ds_read_b128 v[180:183], v220 offset:23552
    v_exp_f32 v139, v35
    v_exp_f32 v140, v36
    v_exp_f32 v141, v37
    v_smfmac_f32_32x32x32_bf16 v[80:95], v[172:175], v[128:135], v221
    buffer_store_dwordx4 a[60:63], v240, s[24:27], s55 offen offset:1024 sc1
    v_exp_f32 v142, v38
    v_exp_f32 v143, v39
    v_exp_f32 v144, v40
    v_smfmac_f32_16x16x64_bf16 v[112:115], v[184:187], v[128:135], v221
    buffer_load_dwordx4 v252, s[16:19], s94 offen offset:2048 sc1 lds
    v_exp_f32 v145, v41
    v_exp_f32 v146, v42
    v_smfmac_f32_32x32x32_bf16 v[96:111], v[168:171], v[136:143], v221
    buffer_load_dwordx4 v252, s[16:19], s94 offen offset:3072 sc1 lds
    s_add_u32 s94, s94, 16384
    s_and_b32 s94, s94, 262143
    v_exp_f32 v147, v43
    v_exp_f32 v148, v44
    v_exp_f32 v149, v45
    v_smfmac_f32_16x16x64_bf16 v[116:119], v[184:187], v[136:143], v221
    s_waitcnt lgkmcnt(0)
    v_exp_f32 v150, v46
    v_exp_f32 v151, v47
    v_mfma_f32_32x32x16_bf16 v[32:47], v[160:163], v[8:11], v[64:79]
    ds_read_b128 v[152:155], v220 offset:24576
    v_exp_f32 v120, v16
    v_exp_f32 v121, v17
    v_exp_f32 v122, v18
    v_mfma_f32_32x32x16_bf16 v[32:47], v[164:167], v[12:15], v[32:47]
    ds_read_b128 v[156:159], v220 offset:25600
    v_exp_f32 v123, v19
    v_exp_f32 v124, v20
    v_exp_f32 v125, v21
    v_smfmac_f32_32x32x32_bf16 v[96:111], v[172:175], v[144:151], v221
    buffer_store_dwordx4 a[64:67], v240, s[24:27], s55 offen offset:2048 sc1
    v_exp_f32 v126, v22
    v_exp_f32 v127, v23
    v_exp_f32 v128, v24
    v_smfmac_f32_16x16x64_bf16 v[116:119], v[184:187], v[144:151], v221
    buffer_store_dwordx4 a[68:71], v240, s[24:27], s55 offen offset:3072 sc1
    v_exp_f32 v129, v25
    v_exp_f32 v130, v26
    v_smfmac_f32_32x32x32_bf16 v[80:95], v[176:179], v[120:127], v221
    v_exp_f32 v131, v27
    v_exp_f32 v132, v28
    v_exp_f32 v133, v29
    v_smfmac_f32_16x16x64_bf16 v[112:115], v[184:187], v[120:127], v221
    s_waitcnt lgkmcnt(0)
    v_exp_f32 v134, v30
    v_exp_f32 v135, v31
    v_mfma_f32_32x32x16_bf16 v[16:31], v[152:155], v[0:3], v[48:63]
    ds_read_b128 v[168:171], v220 offset:26624
    v_exp_f32 v136, v32
    v_exp_f32 v137, v33
    v_exp_f32 v138, v34
    v_mfma_f32_32x32x16_bf16 v[16:31], v[156:159], v[4:7], v[16:31]
    ds_read_b128 v[172:175], v220 offset:27648
    v_exp_f32 v139, v35
    v_exp_f32 v140, v36
    v_exp_f32 v141, v37
    v_smfmac_f32_32x32x32_bf16 v[80:95], v[180:183], v[128:135], v221
    buffer_store_dwordx4 a[72:75], v241, s[24:27], s55 offen offset:0 sc1
    v_exp_f32 v142, v38
    v_exp_f32 v143, v39
    v_exp_f32 v144, v40
    v_smfmac_f32_16x16x64_bf16 v[112:115], v[184:187], v[128:135], v221
    buffer_store_dwordx4 a[76:79], v241, s[24:27], s55 offen offset:1024 sc1
    v_exp_f32 v145, v41
    v_exp_f32 v146, v42
    v_smfmac_f32_32x32x32_bf16 v[96:111], v[176:179], v[136:143], v221
    v_exp_f32 v147, v43
    v_exp_f32 v148, v44
    v_exp_f32 v149, v45
    v_smfmac_f32_16x16x64_bf16 v[116:119], v[184:187], v[136:143], v221
    s_waitcnt lgkmcnt(0)
    v_exp_f32 v150, v46
    v_exp_f32 v151, v47
    v_mfma_f32_32x32x16_bf16 v[32:47], v[152:155], v[8:11], v[64:79]
    ds_read_b128 v[160:163], v220 offset:28672
    v_exp_f32 v120, v16
    v_exp_f32 v121, v17
    v_exp_f32 v122, v18
    v_mfma_f32_32x32x16_bf16 v[32:47], v[156:159], v[12:15], v[32:47]
    ds_read_b128 v[164:167], v220 offset:29696
    v_exp_f32 v123, v19
    v_exp_f32 v124, v20
    v_exp_f32 v125, v21
    v_smfmac_f32_32x32x32_bf16 v[96:111], v[180:183], v[144:151], v221
    s_add_u32 s98, s97, s95
    s_add_u32 s97, s97, 32768
    buffer_store_dwordx4 a[80:83], v241, s[24:27], s55 offen offset:2048 sc1
    v_exp_f32 v126, v22
    v_exp_f32 v127, v23
    v_exp_f32 v128, v24
    v_smfmac_f32_16x16x64_bf16 v[116:119], v[184:187], v[144:151], v221
    s_cmp_eq_u32 s97, 98304
    s_cselect_b32 s97, 0, s97
    buffer_store_dwordx4 a[84:87], v241, s[24:27], s55 offen offset:3072 sc1
    v_exp_f32 v129, v25
    v_exp_f32 v130, v26
    v_smfmac_f32_32x32x32_bf16 v[80:95], v[168:171], v[120:127], v221
    v_exp_f32 v131, v27
    v_exp_f32 v132, v28
    v_exp_f32 v133, v29
    v_smfmac_f32_16x16x64_bf16 v[112:115], v[184:187], v[120:127], v221
    s_waitcnt lgkmcnt(0)
    v_exp_f32 v134, v30
    v_exp_f32 v135, v31
    v_mfma_f32_32x32x16_bf16 v[16:31], v[160:163], v[0:3], v[48:63]
    ds_read_b128 v[176:179], v220 offset:30720
    v_exp_f32 v136, v32
    v_exp_f32 v137, v33
    v_exp_f32 v138, v34
    v_mfma_f32_32x32x16_bf16 v[16:31], v[164:167], v[4:7], v[16:31]
    ds_read_b128 v[180:183], v220 offset:31744
    v_exp_f32 v139, v35
    v_exp_f32 v140, v36
    v_exp_f32 v141, v37
    v_smfmac_f32_32x32x32_bf16 v[80:95], v[172:175], v[128:135], v221
    buffer_store_dwordx4 a[88:91], v240, s[24:27], s56 offen offset:0 sc1
    v_exp_f32 v142, v38
    v_exp_f32 v143, v39
    v_exp_f32 v144, v40
    v_smfmac_f32_16x16x64_bf16 v[112:115], v[184:187], v[128:135], v221
    buffer_store_dwordx4 a[92:95], v240, s[24:27], s56 offen offset:1024 sc1
    v_exp_f32 v145, v41
    v_exp_f32 v146, v42
    v_smfmac_f32_32x32x32_bf16 v[96:111], v[168:171], v[136:143], v221
    v_exp_f32 v147, v43
    v_exp_f32 v148, v44
    v_exp_f32 v149, v45
    v_smfmac_f32_16x16x64_bf16 v[116:119], v[184:187], v[136:143], v221
    s_waitcnt vmcnt(8) lgkmcnt(0)
    s_barrier
    v_add_u32 v220, s97, v251
    v_exp_f32 v150, v46
    v_exp_f32 v151, v47
    v_mfma_f32_32x32x16_bf16 v[32:47], v[160:163], v[8:11], v[64:79]
    ds_read_b128 v[152:155], v220 offset:0
    v_exp_f32 v120, v16
    v_exp_f32 v121, v17
    v_exp_f32 v122, v18
    v_mfma_f32_32x32x16_bf16 v[32:47], v[164:167], v[12:15], v[32:47]
    ds_read_b128 v[156:159], v220 offset:1024
    v_exp_f32 v123, v19
    v_exp_f32 v124, v20
    v_exp_f32 v125, v21
    v_smfmac_f32_32x32x32_bf16 v[96:111], v[172:175], v[144:151], v221
    buffer_store_dwordx4 a[96:99], v240, s[24:27], s56 offen offset:2048 sc1
    v_exp_f32 v126, v22
    v_exp_f32 v127, v23
    v_exp_f32 v128, v24
    v_smfmac_f32_16x16x64_bf16 v[116:119], v[184:187], v[144:151], v221
    buffer_store_dwordx4 a[100:103], v240, s[24:27], s56 offen offset:3072 sc1
    v_exp_f32 v129, v25
    v_exp_f32 v130, v26
    v_smfmac_f32_32x32x32_bf16 v[80:95], v[176:179], v[120:127], v221
    s_add_u32 m0, s95, 65536
    s_nop 0
    buffer_load_dwordx4 v252, s[16:19], s94 offen offset:0 sc1 lds
    v_exp_f32 v131, v27
    v_exp_f32 v132, v28
    v_exp_f32 v133, v29
    v_smfmac_f32_16x16x64_bf16 v[112:115], v[184:187], v[120:127], v221
    s_waitcnt lgkmcnt(0)
    v_exp_f32 v134, v30
    v_exp_f32 v135, v31
    v_mfma_f32_32x32x16_bf16 v[16:31], v[152:155], v[0:3], v[48:63]
    ds_read_b128 v[168:171], v220 offset:2048
    v_exp_f32 v136, v32
    v_exp_f32 v137, v33
    v_exp_f32 v138, v34
    v_mfma_f32_32x32x16_bf16 v[16:31], v[156:159], v[4:7], v[16:31]
    ds_read_b128 v[172:175], v220 offset:3072
    v_exp_f32 v139, v35
    v_exp_f32 v140, v36
    v_exp_f32 v141, v37
    v_smfmac_f32_32x32x32_bf16 v[80:95], v[180:183], v[128:135], v221
    buffer_store_dwordx4 a[104:107], v241, s[24:27], s56 offen offset:0 sc1
    v_exp_f32 v142, v38
    v_exp_f32 v143, v39
    v_exp_f32 v144, v40
    v_smfmac_f32_16x16x64_bf16 v[112:115], v[184:187], v[128:135], v221
    buffer_store_dwordx4 a[108:111], v241, s[24:27], s56 offen offset:1024 sc1
    v_exp_f32 v145, v41
    v_exp_f32 v146, v42
    v_smfmac_f32_32x32x32_bf16 v[96:111], v[176:179], v[136:143], v221
    buffer_load_dwordx4 v252, s[16:19], s94 offen offset:1024 sc1 lds
    v_exp_f32 v147, v43
    v_exp_f32 v148, v44
    v_exp_f32 v149, v45
    v_smfmac_f32_16x16x64_bf16 v[116:119], v[184:187], v[136:143], v221
    s_waitcnt lgkmcnt(0)
    v_exp_f32 v150, v46
    v_exp_f32 v151, v47
    v_mfma_f32_32x32x16_bf16 v[32:47], v[152:155], v[8:11], v[64:79]
    ds_read_b128 v[160:163], v220 offset:4096
    v_exp_f32 v120, v16
    v_exp_f32 v121, v17
    v_exp_f32 v122, v18
    v_mfma_f32_32x32x16_bf16 v[32:47], v[156:159], v[12:15], v[32:47]
    ds_read_b128 v[164:167], v220 offset:5120
    v_exp_f32 v123, v19
    v_exp_f32 v124, v20
    v_exp_f32 v125, v21
    v_smfmac_f32_32x32x32_bf16 v[96:111], v[180:183], v[144:151], v221
    buffer_store_dwordx4 a[112:115], v241, s[24:27], s56 offen offset:2048 sc1
    v_exp_f32 v126, v22
    v_exp_f32 v127, v23
    v_exp_f32 v128, v24
    v_smfmac_f32_16x16x64_bf16 v[116:119], v[184:187], v[144:151], v221
    buffer_store_dwordx4 a[116:119], v241, s[24:27], s56 offen offset:3072 sc1
    v_exp_f32 v129, v25
    v_exp_f32 v130, v26
    v_smfmac_f32_32x32x32_bf16 v[80:95], v[168:171], v[120:127], v221
    buffer_load_dwordx4 v252, s[16:19], s94 offen offset:2048 sc1 lds
    v_exp_f32 v131, v27
    v_exp_f32 v132, v28
    v_exp_f32 v133, v29
    v_smfmac_f32_16x16x64_bf16 v[112:115], v[184:187], v[120:127], v221
    s_waitcnt lgkmcnt(0)
    v_exp_f32 v134, v30
    v_exp_f32 v135, v31
    v_mfma_f32_32x32x16_bf16 v[16:31], v[160:163], v[0:3], v[48:63]
    ds_read_b128 v[176:179], v220 offset:6144
    v_exp_f32 v136, v32
    v_exp_f32 v137, v33
    v_exp_f32 v138, v34
    v_mfma_f32_32x32x16_bf16 v[16:31], v[164:167], v[4:7], v[16:31]
    ds_read_b128 v[180:183], v220 offset:7168
    v_exp_f32 v139, v35
    v_exp_f32 v140, v36
    v_exp_f32 v141, v37
    v_smfmac_f32_32x32x32_bf16 v[80:95], v[172:175], v[128:135], v221
    v_exp_f32 v142, v38
    v_exp_f32 v143, v39
    v_exp_f32 v144, v40
    v_smfmac_f32_16x16x64_bf16 v[112:115], v[184:187], v[128:135], v221
    v_exp_f32 v145, v41
    v_exp_f32 v146, v42
    v_smfmac_f32_32x32x32_bf16 v[96:111], v[168:171], v[136:143], v221
    buffer_load_dwordx4 v252, s[16:19], s94 offen offset:3072 sc1 lds
    s_add_u32 s94, s94, 16384
    v_exp_f32 v147, v43
    v_exp_f32 v148, v44
    v_exp_f32 v149, v45
    v_smfmac_f32_16x16x64_bf16 v[116:119], v[184:187], v[136:143], v221
    s_waitcnt lgkmcnt(0)
    v_exp_f32 v150, v46
    v_exp_f32 v151, v47
    v_mfma_f32_32x32x16_bf16 v[32:47], v[160:163], v[8:11], v[64:79]
    ds_read_b128 v[152:155], v220 offset:8192
    v_exp_f32 v120, v16
    v_exp_f32 v121, v17
    v_exp_f32 v122, v18
    v_mfma_f32_32x32x16_bf16 v[32:47], v[164:167], v[12:15], v[32:47]
    ds_read_b128 v[156:159], v220 offset:9216
    v_exp_f32 v123, v19
    v_exp_f32 v124, v20
    v_exp_f32 v125, v21
    v_smfmac_f32_32x32x32_bf16 v[96:111], v[172:175], v[144:151], v221
    v_exp_f32 v126, v22
    v_exp_f32 v127, v23
    v_exp_f32 v128, v24
    v_smfmac_f32_16x16x64_bf16 v[116:119], v[184:187], v[144:151], v221
    v_exp_f32 v129, v25
    v_exp_f32 v130, v26
    v_smfmac_f32_32x32x32_bf16 v[80:95], v[176:179], v[120:127], v221
    s_add_u32 m0, s95, 81920
    s_nop 0
    buffer_load_dwordx4 v252, s[16:19], s94 offen offset:0 sc1 lds
    v_exp_f32 v131, v27
    v_exp_f32 v132, v28
    v_exp_f32 v133, v29
    v_smfmac_f32_16x16x64_bf16 v[112:115], v[184:187], v[120:127], v221
    s_waitcnt lgkmcnt(0)
    v_exp_f32 v134, v30
    v_exp_f32 v135, v31
    v_mfma_f32_32x32x16_bf16 v[16:31], v[152:155], v[0:3], v[48:63]
    ds_read_b128 v[168:171], v220 offset:10240
    v_exp_f32 v136, v32
    v_exp_f32 v137, v33
    v_exp_f32 v138, v34
    v_mfma_f32_32x32x16_bf16 v[16:31], v[156:159], v[4:7], v[16:31]
    ds_read_b128 v[172:175], v220 offset:11264
    v_exp_f32 v139, v35
    v_exp_f32 v140, v36
    v_exp_f32 v141, v37
    v_smfmac_f32_32x32x32_bf16 v[80:95], v[180:183], v[128:135], v221
    v_exp_f32 v142, v38
    v_exp_f32 v143, v39
    v_exp_f32 v144, v40
    v_smfmac_f32_16x16x64_bf16 v[112:115], v[184:187], v[128:135], v221
    v_exp_f32 v145, v41
    v_exp_f32 v146, v42
    v_smfmac_f32_32x32x32_bf16 v[96:111], v[176:179], v[136:143], v221
    buffer_load_dwordx4 v252, s[16:19], s94 offen offset:1024 sc1 lds
    v_exp_f32 v147, v43
    v_exp_f32 v148, v44
    v_exp_f32 v149, v45
    v_smfmac_f32_16x16x64_bf16 v[116:119], v[184:187], v[136:143], v221
    s_waitcnt vmcnt(4) lgkmcnt(0)
    s_barrier
    v_exp_f32 v150, v46
    v_exp_f32 v151, v47
    s_cmp_eq_u32 s101, 0
    s_cbranch_scc1 L_at_np
    s_cmp_lg_u32 s40, 0
    s_cbranch_scc1 L_pb39
    v_mov_b32 v232, s6
    v_mov_b32 v233, s7
    buffer_store_dwordx2 v[232:233], off, s[8:11], s101 sc1
L_pb39:
L_at_np:
    v_mfma_f32_32x32x16_bf16 v[32:47], v[152:155], v[8:11], v[64:79]
    ds_read_b128 v[160:163], v220 offset:12288
    v_exp_f32 v120, v16
    v_exp_f32 v121, v17
    v_exp_f32 v122, v18
    v_mfma_f32_32x32x16_bf16 v[32:47], v[156:159], v[12:15], v[32:47]
    ds_read_b128 v[164:167], v220 offset:13312
    v_exp_f32 v123, v19
    v_exp_f32 v124, v20
    v_exp_f32 v125, v21
    v_smfmac_f32_32x32x32_bf16 v[96:111], v[180:183], v[144:151], v221
    v_exp_f32 v126, v22
    v_exp_f32 v127, v23
    v_exp_f32 v128, v24
    v_smfmac_f32_16x16x64_bf16 v[116:119], v[184:187], v[144:151], v221
    v_exp_f32 v129, v25
    v_exp_f32 v130, v26
    v_smfmac_f32_32x32x32_bf16 v[80:95], v[168:171], v[120:127], v221
    buffer_load_dwordx4 v252, s[16:19], s94 offen offset:2048 sc1 lds
    v_exp_f32 v131, v27
    v_exp_f32 v132, v28
    v_exp_f32 v133, v29
    v_smfmac_f32_16x16x64_bf16 v[112:115], v[184:187], v[120:127], v221
    s_waitcnt lgkmcnt(0)
    v_exp_f32 v134, v30
    v_exp_f32 v135, v31
    v_mfma_f32_32x32x16_bf16 v[16:31], v[160:163], v[0:3], v[48:63]
    ds_read_b128 v[176:179], v220 offset:14336
    v_exp_f32 v136, v32
    v_exp_f32 v137, v33
    v_exp_f32 v138, v34
    v_mfma_f32_32x32x16_bf16 v[16:31], v[164:167], v[4:7], v[16:31]
    ds_read_b128 v[180:183], v220 offset:15360
    v_exp_f32 v139, v35
    v_exp_f32 v140, v36
    v_exp_f32 v141, v37
    v_smfmac_f32_32x32x32_bf16 v[80:95], v[172:175], v[128:135], v221
    v_exp_f32 v142, v38
    v_exp_f32 v143, v39
    v_exp_f32 v144, v40
    v_smfmac_f32_16x16x64_bf16 v[112:115], v[184:187], v[128:135], v221
    v_exp_f32 v145, v41
    v_exp_f32 v146, v42
    v_smfmac_f32_32x32x32_bf16 v[96:111], v[168:171], v[136:143], v221
    buffer_load_dwordx4 v252, s[16:19], s94 offen offset:3072 sc1 lds
    s_add_u32 s94, s94, 16384
    s_and_b32 s94, s94, 262143
    v_exp_f32 v147, v43
    v_exp_f32 v148, v44
    v_exp_f32 v149, v45
    v_smfmac_f32_16x16x64_bf16 v[116:119], v[184:187], v[136:143], v221
    s_waitcnt lgkmcnt(0)
    v_exp_f32 v150, v46
    v_exp_f32 v151, v47
    v_mfma_f32_32x32x16_bf16 v[32:47], v[160:163], v[8:11], v[64:79]
    ds_read_b128 v[152:155], v220 offset:16384
    v_exp_f32 v120, v16
    v_exp_f32 v121, v17
    v_exp_f32 v122, v18
    v_mfma_f32_32x32x16_bf16 v[32:47], v[164:167], v[12:15], v[32:47]
    ds_read_b128 v[156:159], v220 offset:17408
    v_exp_f32 v123, v19
    v_exp_f32 v124, v20
    v_exp_f32 v125, v21
    v_smfmac_f32_32x32x32_bf16 v[96:111], v[172:175], v[144:151], v221
    v_exp_f32 v126, v22
    v_exp_f32 v127, v23
    v_exp_f32 v128, v24
    v_smfmac_f32_16x16x64_bf16 v[116:119], v[184:187], v[144:151], v221
    v_exp_f32 v129, v25
    v_exp_f32 v130, v26
    v_smfmac_f32_32x32x32_bf16 v[80:95], v[176:179], v[120:127], v221
    s_add_u32 m0, s95, 0
    s_nop 0
    buffer_load_dwordx4 v252, s[16:19], s94 offen offset:0 sc1 lds
    v_exp_f32 v131, v27
    v_exp_f32 v132, v28
    v_exp_f32 v133, v29
    v_smfmac_f32_16x16x64_bf16 v[112:115], v[184:187], v[120:127], v221
    s_waitcnt lgkmcnt(0)
    v_exp_f32 v134, v30
    v_exp_f32 v135, v31
    v_mfma_f32_32x32x16_bf16 v[16:31], v[152:155], v[0:3], v[48:63]
    ds_read_b128 v[168:171], v220 offset:18432
    v_exp_f32 v136, v32
    v_exp_f32 v137, v33
    v_exp_f32 v138, v34
    v_mfma_f32_32x32x16_bf16 v[16:31], v[156:159], v[4:7], v[16:31]
    ds_read_b128 v[172:175], v220 offset:19456
    v_exp_f32 v139, v35
    v_exp_f32 v140, v36
    v_exp_f32 v141, v37
    v_smfmac_f32_32x32x32_bf16 v[80:95], v[180:183], v[128:135], v221
    v_exp_f32 v142, v38
    v_exp_f32 v143, v39
    v_exp_f32 v144, v40
    v_smfmac_f32_16x16x64_bf16 v[112:115], v[184:187], v[128:135], v221
    v_exp_f32 v145, v41
    v_exp_f32 v146, v42
    v_smfmac_f32_32x32x32_bf16 v[96:111], v[176:179], v[136:143], v221
    buffer_load_dwordx4 v252, s[16:19], s94 offen offset:1024 sc1 lds
    v_exp_f32 v147, v43
    v_exp_f32 v148, v44
    v_exp_f32 v149, v45
    v_smfmac_f32_16x16x64_bf16 v[116:119], v[184:187], v[136:143], v221
    s_waitcnt lgkmcnt(0)
    v_exp_f32 v150, v46
    v_exp_f32 v151, v47
    v_mfma_f32_32x32x16_bf16 v[32:47], v[152:155], v[8:11], v[64:79]
    ds_read_b128 v[160:163], v220 offset:20480
    v_exp_f32 v120, v16
    v_exp_f32 v121, v17
    v_exp_f32 v122, v18
    v_mfma_f32_32x32x16_bf16 v[32:47], v[156:159], v[12:15], v[32:47]
    ds_read_b128 v[164:167], v220 offset:21504
    v_exp_f32 v123, v19
    v_exp_f32 v124, v20
    v_exp_f32 v125, v21
    v_smfmac_f32_32x32x32_bf16 v[96:111], v[180:183], v[144:151], v221
    v_exp_f32 v126, v22
    v_exp_f32 v127, v23
    v_exp_f32 v128, v24
    v_smfmac_f32_16x16x64_bf16 v[116:119], v[184:187], v[144:151], v221
    v_exp_f32 v129, v25
    v_exp_f32 v130, v26
    v_smfmac_f32_32x32x32_bf16 v[80:95], v[168:171], v[120:127], v221
    buffer_load_dwordx4 v252, s[16:19], s94 offen offset:2048 sc1 lds
    v_exp_f32 v131, v27
    v_exp_f32 v132, v28
    v_exp_f32 v133, v29
    v_smfmac_f32_16x16x64_bf16 v[112:115], v[184:187], v[120:127], v221
    s_waitcnt lgkmcnt(0)
    v_exp_f32 v134, v30
    v_exp_f32 v135, v31
    v_mfma_f32_32x32x16_bf16 v[16:31], v[160:163], v[0:3], v[48:63]
    ds_read_b128 v[176:179], v220 offset:22528
    v_exp_f32 v136, v32
    v_exp_f32 v137, v33
    v_exp_f32 v138, v34
    v_mfma_f32_32x32x16_bf16 v[16:31], v[164:167], v[4:7], v[16:31]
    ds_read_b128 v[180:183], v220 offset:23552
    v_exp_f32 v139, v35
    v_exp_f32 v140, v36
    v_exp_f32 v141, v37
    v_smfmac_f32_32x32x32_bf16 v[80:95], v[172:175], v[128:135], v221
    v_exp_f32 v142, v38
    v_exp_f32 v143, v39
    v_exp_f32 v144, v40
    v_smfmac_f32_16x16x64_bf16 v[112:115], v[184:187], v[128:135], v221
    v_exp_f32 v145, v41
    v_exp_f32 v146, v42
    v_smfmac_f32_32x32x32_bf16 v[96:111], v[168:171], v[136:143], v221
    buffer_load_dwordx4 v252, s[16:19], s94 offen offset:3072 sc1 lds
    s_add_u32 s94, s94, 16384
    buffer_load_dwordx2 v[254:255], v230, s[8:11], 0 offen sc1
    v_exp_f32 v147, v43
    v_exp_f32 v148, v44
    v_exp_f32 v149, v45
    v_smfmac_f32_16x16x64_bf16 v[116:119], v[184:187], v[136:143], v221
    s_waitcnt lgkmcnt(0)
    v_exp_f32 v150, v46
    v_exp_f32 v151, v47
    v_mfma_f32_32x32x16_bf16 v[32:47], v[160:163], v[8:11], v[64:79]
    ds_read_b128 v[152:155], v220 offset:24576
    v_exp_f32 v120, v16
    v_exp_f32 v121, v17
    v_exp_f32 v122, v18
    v_mfma_f32_32x32x16_bf16 v[32:47], v[164:167], v[12:15], v[32:47]
    ds_read_b128 v[156:159], v220 offset:25600
    v_exp_f32 v123, v19
    v_exp_f32 v124, v20
    v_exp_f32 v125, v21
    v_smfmac_f32_32x32x32_bf16 v[96:111], v[172:175], v[144:151], v221
    v_exp_f32 v126, v22
    v_exp_f32 v127, v23
    v_exp_f32 v128, v24
    v_smfmac_f32_16x16x64_bf16 v[116:119], v[184:187], v[144:151], v221
    v_exp_f32 v129, v25
    v_exp_f32 v130, v26
    v_smfmac_f32_32x32x32_bf16 v[80:95], v[176:179], v[120:127], v221
    s_add_u32 m0, s95, 16384
    s_nop 0
    buffer_load_dwordx4 v252, s[16:19], s94 offen offset:0 sc1 lds
    v_exp_f32 v131, v27
    v_exp_f32 v132, v28
    v_exp_f32 v133, v29
    v_smfmac_f32_16x16x64_bf16 v[112:115], v[184:187], v[120:127], v221
    s_waitcnt lgkmcnt(0)
    v_exp_f32 v134, v30
    v_exp_f32 v135, v31
    v_mfma_f32_32x32x16_bf16 v[16:31], v[152:155], v[0:3], v[48:63]
    ds_read_b128 v[168:171], v220 offset:26624
    v_exp_f32 v136, v32
    v_exp_f32 v137, v33
    v_exp_f32 v138, v34
    v_mfma_f32_32x32x16_bf16 v[16:31], v[156:159], v[4:7], v[16:31]
    ds_read_b128 v[172:175], v220 offset:27648
    v_exp_f32 v139, v35
    v_exp_f32 v140, v36
    v_exp_f32 v141, v37
    v_smfmac_f32_32x32x32_bf16 v[80:95], v[180:183], v[128:135], v221
    v_exp_f32 v142, v38
    v_exp_f32 v143, v39
    v_exp_f32 v144, v40
    v_smfmac_f32_16x16x64_bf16 v[112:115], v[184:187], v[128:135], v221
    v_exp_f32 v145, v41
    v_exp_f32 v146, v42
    v_smfmac_f32_32x32x32_bf16 v[96:111], v[176:179], v[136:143], v221
    buffer_load_dwordx4 v252, s[16:19], s94 offen offset:1024 sc1 lds
    v_exp_f32 v147, v43
    v_exp_f32 v148, v44
    v_exp_f32 v149, v45
    v_smfmac_f32_16x16x64_bf16 v[116:119], v[184:187], v[136:143], v221
    s_waitcnt lgkmcnt(0)
    v_exp_f32 v150, v46
    v_exp_f32 v151, v47
    v_mfma_f32_32x32x16_bf16 v[32:47], v[152:155], v[8:11], v[64:79]
    ds_read_b128 v[160:163], v220 offset:28672
    v_exp_f32 v120, v16
    v_exp_f32 v121, v17
    v_exp_f32 v122, v18
    v_mfma_f32_32x32x16_bf16 v[32:47], v[156:159], v[12:15], v[32:47]
    ds_read_b128 v[164:167], v220 offset:29696
    v_exp_f32 v123, v19
    v_exp_f32 v124, v20
    v_exp_f32 v125, v21
    v_smfmac_f32_32x32x32_bf16 v[96:111], v[180:183], v[144:151], v221
    s_add_u32 s98, s97, s95
    s_add_u32 s97, s97, 32768
    v_exp_f32 v126, v22
    v_exp_f32 v127, v23
    v_exp_f32 v128, v24
    v_smfmac_f32_16x16x64_bf16 v[116:119], v[184:187], v[144:151], v221
    s_cmp_eq_u32 s97, 98304
    s_cselect_b32 s97, 0, s97
    v_exp_f32 v129, v25
    v_exp_f32 v130, v26
    v_smfmac_f32_32x32x32_bf16 v[80:95], v[168:171], v[120:127], v221
    buffer_load_dwordx4 v252, s[16:19], s94 offen offset:2048 sc1 lds
    v_exp_f32 v131, v27
    v_exp_f32 v132, v28
    v_exp_f32 v133, v29
    v_smfmac_f32_16x16x64_bf16 v[112:115], v[184:187], v[120:127], v221
    s_waitcnt lgkmcnt(0)
    v_exp_f32 v134, v30
    v_exp_f32 v135, v31
    v_mfma_f32_32x32x16_bf16 v[16:31], v[160:163], v[0:3], v[48:63]
    ds_read_b128 v[176:179], v220 offset:30720
    v_exp_f32 v136, v32
    v_exp_f32 v137, v33
    v_exp_f32 v138, v34
    v_mfma_f32_32x32x16_bf16 v[16:31], v[164:167], v[4:7], v[16:31]
    ds_read_b128 v[180:183], v220 offset:31744
    v_exp_f32 v139, v35
    v_exp_f32 v140, v36
    v_exp_f32 v141, v37
    v_smfmac_f32_32x32x32_bf16 v[80:95], v[172:175], v[128:135], v221
    v_exp_f32 v142, v38
    v_exp_f32 v143, v39
    v_exp_f32 v144, v40
    v_smfmac_f32_16x16x64_bf16 v[112:115], v[184:187], v[128:135], v221
    v_exp_f32 v145, v41
    v_exp_f32 v146, v42
    v_smfmac_f32_32x32x32_bf16 v[96:111], v[168:171], v[136:143], v221
    buffer_load_dwordx4 v252, s[16:19], s94 offen offset:3072 sc1 lds
    s_add_u32 s94, s94, 16384
    s_and_b32 s94, s94, 262143
    v_exp_f32 v147, v43
    v_exp_f32 v148, v44
    v_exp_f32 v149, v45
    v_smfmac_f32_16x16x64_bf16 v[116:119], v[184:187], v[136:143], v221
    s_waitcnt vmcnt(9) lgkmcnt(0)
    s_barrier
    v_add_u32 v220, s97, v251
    v_exp_f32 v150, v46
    v_exp_f32 v151, v47
    s_mov_b32 s96, 2
    v_mov_b32 v240, v252
    v_mov_b32 v241, v252
    v_mov_b32 v242, v252
    v_mov_b32 v243, v252
    s_mov_b32 s3, 16384
    s_mov_b32 s47, 262143
    s_waitcnt vmcnt(4)
    s_mov_b32 s57, 0
    s_branch L_pc40
L_pl40:
    buffer_load_dwordx2 v[254:255], v230, s[8:11], 0 offen sc1
    s_waitcnt vmcnt(0)
L_pc40:
    v_cmp_ne_u64 vcc, s[6:7], v[254:255]
    s_add_u32 s57, s57, 1
    s_nop 0
    s_cbranch_vccz L_pd40
    s_sleep 6
    s_cmp_lt_u32 s57, 0x40000
    s_cbranch_scc1 L_pl40
L_pd40:
    v_mfma_f32_32x32x16_bf16 v[32:47], v[160:163], v[8:11], v[64:79]
    ds_read_b128 v[152:155], v220 offset:0
    ds_read_b128 v[156:159], v220 offset:1024
    v_exp_f32 v120, v16
    v_exp_f32 v121, v17
    v_exp_f32 v122, v18
    v_mfma_f32_32x32x16_bf16 v[32:47], v[164:167], v[12:15], v[32:47]
    s_and_b32 s94, s94, s47
    v_exp_f32 v123, v19
    v_exp_f32 v124, v20
    v_exp_f32 v125, v21
    v_smfmac_f32_32x32x32_bf16 v[96:111], v[172:175], v[144:151], v221
    s_add_u32 m0, s45, 0
    buffer_load_dwordx4 a[0:3], v222, s[8:11], s43 offen offset:0 sc1
    v_exp_f32 v126, v22
    v_exp_f32 v127, v23
    v_exp_f32 v128, v24
    v_smfmac_f32_16x16x64_bf16 v[116:119], v[184:187], v[144:151], v221
    buffer_load_dwordx4 v224, s[12:15], s44 offen offset:0  lds
    v_exp_f32 v129, v25
    v_exp_f32 v130, v26
    v_smfmac_f32_32x32x32_bf16 v[80:95], v[176:179], v[120:127], v221
    s_mov_b32 m0, s98
    v_exp_f32 v131, v27
    v_exp_f32 v132, v28
    v_exp_f32 v133, v29
    v_smfmac_f32_16x16x64_bf16 v[112:115], v[184:187], v[120:127], v221
    s_waitcnt lgkmcnt(0)
    buffer_load_dwordx4 a[4:7], v222, s[8:11], s43 offen offset:1024 sc1
    buffer_load_dwordx4 v240, s[16:19], s94 offen offset:0 sc1 lds
    v_exp_f32 v134, v30
    v_exp_f32 v135, v31
    v_mfma_f32_32x32x16_bf16 v[16:31], v[152:155], v[0:3], v[48:63]
    ds_read_b128 v[168:171], v220 offset:2048
    ds_read_b128 v[172:175], v220 offset:3072
    v_exp_f32 v136, v32
    v_exp_f32 v137, v33
    v_exp_f32 v138, v34
    v_mfma_f32_32x32x16_bf16 v[16:31], v[156:159], v[4:7], v[16:31]
    v_exp_f32 v139, v35
    v_exp_f32 v140, v36
    v_exp_f32 v141, v37
    v_smfmac_f32_32x32x32_bf16 v[80:95], v[180:183], v[128:135], v221
    s_add_u32 m0, s45, 0
    buffer_load_dwordx4 a[8:11], v223, s[8:11], s43 offen offset:0 sc1
    v_exp_f32 v142, v38
    v_exp_f32 v143, v39
    v_exp_f32 v144, v40
    v_smfmac_f32_16x16x64_bf16 v[112:115], v[184:187], v[128:135], v221
    buffer_load_dwordx4 v225, s[12:15], s44 offen offset:1024  lds
    v_exp_f32 v145, v41
    v_exp_f32 v146, v42
    v_smfmac_f32_32x32x32_bf16 v[96:111], v[176:179], v[136:143], v221
    v_exp_f32 v147, v43
    v_exp_f32 v148, v44
    v_exp_f32 v149, v45
    v_smfmac_f32_16x16x64_bf16 v[116:119], v[184:187], v[136:143], v221
    s_waitcnt lgkmcnt(0)
    buffer_load_dwordx4 a[12:15], v223, s[8:11], s43 offen offset:1024 sc1
    v_exp_f32 v150, v46
    v_exp_f32 v151, v47
    v_mfma_f32_32x32x16_bf16 v[32:47], v[152:155], v[8:11], v[64:79]
    ds_read_b128 v[160:163], v220 offset:4096
    ds_read_b128 v[164:167], v220 offset:5120
    v_exp_f32 v120, v16
    v_exp_f32 v121, v17
    v_exp_f32 v122, v18
    v_mfma_f32_32x32x16_bf16 v[32:47], v[156:159], v[12:15], v[32:47]
    v_exp_f32 v123, v19
    v_exp_f32 v124, v20
    v_exp_f32 v125, v21
    v_smfmac_f32_32x32x32_bf16 v[96:111], v[180:183], v[144:151], v221
    s_add_u32 m0, s45, 0
    buffer_load_dwordx4 a[16:19], v246, s[8:11], s43 offen offset:0 sc1
    v_exp_f32 v126, v22
    v_exp_f32 v127, v23
    v_exp_f32 v128, v24
    v_smfmac_f32_16x16x64_bf16 v[116:119], v[184:187], v[144:151], v221
    buffer_load_dwordx4 v226, s[12:15], s44 offen offset:2048  lds
    v_exp_f32 v129, v25
    v_exp_f32 v130, v26
    v_smfmac_f32_32x32x32_bf16 v[80:95], v[168:171], v[120:127], v221
    s_mov_b32 m0, s98
    v_exp_f32 v131, v27
    v_exp_f32 v132, v28
    v_exp_f32 v133, v29
    v_smfmac_f32_16x16x64_bf16 v[112:115], v[184:187], v[120:127], v221
    s_waitcnt lgkmcnt(0)
    buffer_load_dwordx4 a[20:23], v246, s[8:11], s43 offen offset:1024 sc1
    buffer_load_dwordx4 v241, s[16:19], s94 offen offset:1024 sc1 lds
    v_exp_f32 v134, v30
    v_exp_f32 v135, v31
    v_mfma_f32_32x32x16_bf16 v[16:31], v[160:163], v[0:3], v[48:63]
    ds_read_b128 v[176:179], v220 offset:6144
    ds_read_b128 v[180:183], v220 offset:7168
    v_exp_f32 v136, v32
    v_exp_f32 v137, v33
    v_exp_f32 v138, v34
    v_mfma_f32_32x32x16_bf16 v[16:31], v[164:167], v[4:7], v[16:31]
    v_exp_f32 v139, v35
    v_exp_f32 v140, v36
    v_exp_f32 v141, v37
    v_smfmac_f32_32x32x32_bf16 v[80:95], v[172:175], v[128:135], v221
    s_add_u32 m0, s45, 0
    buffer_load_dwordx4 a[24:27], v247, s[8:11], s43 offen offset:0 sc1
    v_exp_f32 v142, v38
    v_exp_f32 v143, v39
    v_exp_f32 v144, v40
    v_smfmac_f32_16x16x64_bf16 v[112:115], v[184:187], v[128:135], v221
    buffer_load_dwordx4 v227, s[12:15], s44 offen offset:3072  lds
    v_exp_f32 v145, v41
    v_exp_f32 v146, v42
    v_smfmac_f32_32x32x32_bf16 v[96:111], v[168:171], v[136:143], v221
    v_exp_f32 v147, v43
    v_exp_f32 v148, v44
    v_exp_f32 v149, v45
    v_smfmac_f32_16x16x64_bf16 v[116:119], v[184:187], v[136:143], v221
    s_waitcnt vmcnt(28) lgkmcnt(0)
    buffer_load_dwordx4 a[28:31], v247, s[8:11], s43 offen offset:1024 sc1
    s_add_u32 s43, s43, 131072
    s_add_u32 s44, s44, 65536
    v_exp_f32 v150, v46
    v_exp_f32 v151, v47
    v_mfma_f32_32x32x16_bf16 v[32:47], v[160:163], v[8:11], v[64:79]
    ds_read_b128 v[152:155], v220 offset:8192
    ds_read_b128 v[156:159], v220 offset:9216
    v_exp_f32 v120, v16
    v_exp_f32 v121, v17
    v_exp_f32 v122, v18
    v_mfma_f32_32x32x16_bf16 v[32:47], v[164:167], v[12:15], v[32:47]
    v_exp_f32 v123, v19
    v_exp_f32 v124, v20
    v_exp_f32 v125, v21
    v_smfmac_f32_32x32x32_bf16 v[96:111], v[172:175], v[144:151], v221
    s_add_u32 m0, s45, 4096
    buffer_load_dwordx4 a[32:35], v222, s[8:11], s43 offen offset:0 sc1
    v_exp_f32 v126, v22
    v_exp_f32 v127, v23
    v_exp_f32 v128, v24
    v_smfmac_f32_16x16x64_bf16 v[116:119], v[184:187], v[144:151], v221
    buffer_load_dwordx4 v224, s[12:15], s44 offen offset:0  lds
    v_exp_f32 v129, v25
    v_exp_f32 v130, v26
    v_smfmac_f32_32x32x32_bf16 v[80:95], v[176:179], v[120:127], v221
    s_mov_b32 m0, s98
    v_exp_f32 v131, v27
    v_exp_f32 v132, v28
    v_exp_f32 v133, v29
    v_smfmac_f32_16x16x64_bf16 v[112:115], v[184:187], v[120:127], v221
    s_waitcnt lgkmcnt(0)
    buffer_load_dwordx4 a[36:39], v222, s[8:11], s43 offen offset:1024 sc1
    buffer_load_dwordx4 v242, s[16:19], s94 offen offset:2048 sc1 lds
    v_exp_f32 v134, v30
    v_exp_f32 v135, v31
    v_mfma_f32_32x32x16_bf16 v[16:31], v[152:155], v[0:3], v[48:63]
    ds_read_b128 v[168:171], v220 offset:10240
    ds_read_b128 v[172:175], v220 offset:11264
    v_exp_f32 v136, v32
    v_exp_f32 v137, v33
    v_exp_f32 v138, v34
    v_mfma_f32_32x32x16_bf16 v[16:31], v[156:159], v[4:7], v[16:31]
    v_exp_f32 v139, v35
    v_exp_f32 v140, v36
    v_exp_f32 v141, v37
    v_smfmac_f32_32x32x32_bf16 v[80:95], v[180:183], v[128:135], v221
    s_add_u32 m0, s45, 4096
    buffer_load_dwordx4 a[40:43], v223, s[8:11], s43 offen offset:0 sc1
    v_exp_f32 v142, v38
    v_exp_f32 v143, v39
    v_exp_f32 v144, v40
    v_smfmac_f32_16x16x64_bf16 v[112:115], v[184:187], v[128:135], v221
    buffer_load_dwordx4 v225, s[12:15], s44 offen offset:1024  lds
    v_exp_f32 v145, v41
    v_exp_f32 v146, v42
    v_smfmac_f32_32x32x32_bf16 v[96:111], v[176:179], v[136:143], v221
    v_exp_f32 v147, v43
    v_exp_f32 v148, v44
    v_exp_f32 v149, v45
    v_smfmac_f32_16x16x64_bf16 v[116:119], v[184:187], v[136:143], v221
    s_waitcnt lgkmcnt(0)
    buffer_load_dwordx4 a[44:47], v223, s[8:11], s43 offen offset:1024 sc1
    v_exp_f32 v150, v46
    v_exp_f32 v151, v47
    v_mfma_f32_32x32x16_bf16 v[32:47], v[152:155], v[8:11], v[64:79]
    ds_read_b128 v[160:163], v220 offset:12288
    ds_read_b128 v[164:167], v220 offset:13312
    v_exp_f32 v120, v16
    v_exp_f32 v121, v17
    v_exp_f32 v122, v18
    v_mfma_f32_32x32x16_bf16 v[32:47], v[156:159], v[12:15], v[32:47]
    v_exp_f32 v123, v19
    v_exp_f32 v124, v20
    v_exp_f32 v125, v21
    v_smfmac_f32_32x32x32_bf16 v[96:111], v[180:183], v[144:151], v221
    s_add_u32 m0, s45, 4096
    buffer_load_dwordx4 a[48:51], v246, s[8:11], s43 offen offset:0 sc1
    v_exp_f32 v126, v22
    v_exp_f32 v127, v23
    v_exp_f32 v128, v24
    v_smfmac_f32_16x16x64_bf16 v[116:119], v[184:187], v[144:151], v221
    buffer_load_dwordx4 v226, s[12:15], s44 offen offset:2048  lds
    v_exp_f32 v129, v25
    v_exp_f32 v130, v26
    v_smfmac_f32_32x32x32_bf16 v[80:95], v[168:171], v[120:127], v221
    s_mov_b32 m0, s98
    v_exp_f32 v131, v27
    v_exp_f32 v132, v28
    v_exp_f32 v133, v29
    v_smfmac_f32_16x16x64_bf16 v[112:115], v[184:187], v[120:127], v221
    s_waitcnt lgkmcnt(0)
    buffer_load_dwordx4 a[52:55], v246, s[8:11], s43 offen offset:1024 sc1
    buffer_load_dwordx4 v243, s[16:19], s94 offen offset:3072 sc1 lds
    v_exp_f32 v134, v30
    v_exp_f32 v135, v31
    v_mfma_f32_32x32x16_bf16 v[16:31], v[160:163], v[0:3], v[48:63]
    ds_read_b128 v[176:179], v220 offset:14336
    ds_read_b128 v[180:183], v220 offset:15360
    v_exp_f32 v136, v32
    v_exp_f32 v137, v33
    v_exp_f32 v138, v34
    v_mfma_f32_32x32x16_bf16 v[16:31], v[164:167], v[4:7], v[16:31]
    s_add_u32 s94, s94, s3
    v_exp_f32 v139, v35
    v_exp_f32 v140, v36
    v_exp_f32 v141, v37
    v_smfmac_f32_32x32x32_bf16 v[80:95], v[172:175], v[128:135], v221
    s_add_u32 m0, s45, 4096
    buffer_load_dwordx4 a[56:59], v247, s[8:11], s43 offen offset:0 sc1
    v_exp_f32 v142, v38
    v_exp_f32 v143, v39
    v_exp_f32 v144, v40
    v_smfmac_f32_16x16x64_bf16 v[112:115], v[184:187], v[128:135], v221
    buffer_load_dwordx4 v227, s[12:15], s44 offen offset:3072  lds
    v_exp_f32 v145, v41
    v_exp_f32 v146, v42
    v_smfmac_f32_32x32x32_bf16 v[96:111], v[168:171], v[136:143], v221
    v_exp_f32 v147, v43
    v_exp_f32 v148, v44
    v_exp_f32 v149, v45
    v_smfmac_f32_16x16x64_bf16 v[116:119], v[184:187], v[136:143], v221
    s_waitcnt vmcnt(28) lgkmcnt(0)
    buffer_load_dwordx4 a[60:63], v247, s[8:11], s43 offen offset:1024 sc1
    s_add_u32 s43, s43, 131072
    s_add_u32 s44, s44, 65536
    v_exp_f32 v150, v46
    v_exp_f32 v151, v47
    v_mfma_f32_32x32x16_bf16 v[32:47], v[160:163], v[8:11], v[64:79]
    ds_read_b128 v[152:155], v220 offset:16384
    ds_read_b128 v[156:159], v220 offset:17408
    v_exp_f32 v120, v16
    v_exp_f32 v121, v17
    v_exp_f32 v122, v18
    v_mfma_f32_32x32x16_bf16 v[32:47], v[164:167], v[12:15], v[32:47]
    v_exp_f32 v123, v19
    v_exp_f32 v124, v20
    v_exp_f32 v125, v21
    v_smfmac_f32_32x32x32_bf16 v[96:111], v[172:175], v[144:151], v221
    s_add_u32 m0, s45, 8192
    buffer_load_dwordx4 a[64:67], v222, s[8:11], s43 offen offset:0 sc1
    v_exp_f32 v126, v22
    v_exp_f32 v127, v23
    v_exp_f32 v128, v24
    v_smfmac_f32_16x16x64_bf16 v[116:119], v[184:187], v[144:151], v221
    buffer_load_dwordx4 v224, s[12:15], s44 offen offset:0  lds
    v_exp_f32 v129, v25
    v_exp_f32 v130, v26
    v_smfmac_f32_32x32x32_bf16 v[80:95], v[176:179], v[120:127], v221
    s_add_u32 m0, s98, 16384
    v_exp_f32 v131, v27
    v_exp_f32 v132, v28
    v_exp_f32 v133, v29
    v_smfmac_f32_16x16x64_bf16 v[112:115], v[184:187], v[120:127], v221
    s_waitcnt lgkmcnt(0)
    buffer_load_dwordx4 a[68:71], v222, s[8:11], s43 offen offset:1024 sc1
    buffer_load_dwordx4 v240, s[16:19], s94 offen offset:0 sc1 lds
    v_exp_f32 v134, v30
    v_exp_f32 v135, v31
    v_mfma_f32_32x32x16_bf16 v[16:31], v[152:155], v[0:3], v[48:63]
    ds_read_b128 v[168:171], v220 offset:18432
    ds_read_b128 v[172:175], v220 offset:19456
    v_exp_f32 v136, v32
    v_exp_f32 v137, v33
    v_exp_f32 v138, v34
    v_mfma_f32_32x32x16_bf16 v[16:31], v[156:159], v[4:7], v[16:31]
    v_exp_f32 v139, v35
    v_exp_f32 v140, v36
    v_exp_f32 v141, v37
    v_smfmac_f32_32x32x32_bf16 v[80:95], v[180:183], v[128:135], v221
    s_add_u32 m0, s45, 8192
    buffer_load_dwordx4 a[72:75], v223, s[8:11], s43 offen offset:0 sc1
    v_exp_f32 v142, v38
    v_exp_f32 v143, v39
    v_exp_f32 v144, v40
    v_smfmac_f32_16x16x64_bf16 v[112:115], v[184:187], v[128:135], v221
    buffer_load_dwordx4 v225, s[12:15], s44 offen offset:1024  lds
    v_exp_f32 v145, v41
    v_exp_f32 v146, v42
    v_smfmac_f32_32x32x32_bf16 v[96:111], v[176:179], v[136:143], v221
    v_exp_f32 v147, v43
    v_exp_f32 v148, v44
    v_exp_f32 v149, v45
    v_smfmac_f32_16x16x64_bf16 v[116:119], v[184:187], v[136:143], v221
    s_waitcnt lgkmcnt(0)
    buffer_load_dwordx4 a[76:79], v223, s[8:11], s43 offen offset:1024 sc1
    v_exp_f32 v150, v46
    v_exp_f32 v151, v47
    v_mfma_f32_32x32x16_bf16 v[32:47], v[152:155], v[8:11], v[64:79]
    ds_read_b128 v[160:163], v220 offset:20480
    ds_read_b128 v[164:167], v220 offset:21504
    v_exp_f32 v120, v16
    v_exp_f32 v121, v17
    v_exp_f32 v122, v18
    v_mfma_f32_32x32x16_bf16 v[32:47], v[156:159], v[12:15], v[32:47]
    v_exp_f32 v123, v19
    v_exp_f32 v124, v20
    v_exp_f32 v125, v21
    v_smfmac_f32_32x32x32_bf16 v[96:111], v[180:183], v[144:151], v221
    s_add_u32 m0, s45, 8192
    buffer_load_dwordx4 a[80:83], v246, s[8:11], s43 offen offset:0 sc1
    v_exp_f32 v126, v22
    v_exp_f32 v127, v23
    v_exp_f32 v128, v24
    v_smfmac_f32_16x16x64_bf16 v[116:119], v[184:187], v[144:151], v221
    buffer_load_dwordx4 v226, s[12:15], s44 offen offset:2048  lds
    v_exp_f32 v129, v25
    v_exp_f32 v130, v26
    v_smfmac_f32_32x32x32_bf16 v[80:95], v[168:171], v[120:127], v221
    s_add_u32 m0, s98, 16384
    v_exp_f32 v131, v27
    v_exp_f32 v132, v28
    v_exp_f32 v133, v29
    v_smfmac_f32_16x16x64_bf16 v[112:115], v[184:187], v[120:127], v221
    s_waitcnt lgkmcnt(0)
    buffer_load_dwordx4 a[84:87], v246, s[8:11], s43 offen offset:1024 sc1
    buffer_load_dwordx4 v241, s[16:19], s94 offen offset:1024 sc1 lds
    v_exp_f32 v134, v30
    v_exp_f32 v135, v31
    v_mfma_f32_32x32x16_bf16 v[16:31], v[160:163], v[0:3], v[48:63]
    ds_read_b128 v[176:179], v220 offset:22528
    ds_read_b128 v[180:183], v220 offset:23552
    v_exp_f32 v136, v32
    v_exp_f32 v137, v33
    v_exp_f32 v138, v34
    v_mfma_f32_32x32x16_bf16 v[16:31], v[164:167], v[4:7], v[16:31]
    v_exp_f32 v139, v35
    v_exp_f32 v140, v36
    v_exp_f32 v141, v37
    v_smfmac_f32_32x32x32_bf16 v[80:95], v[172:175], v[128:135], v221
    s_add_u32 m0, s45, 8192
    buffer_load_dwordx4 a[88:91], v247, s[8:11], s43 offen offset:0 sc1
    v_exp_f32 v142, v38
    v_exp_f32 v143, v39
    v_exp_f32 v144, v40
    v_smfmac_f32_16x16x64_bf16 v[112:115], v[184:187], v[128:135], v221
    buffer_load_dwordx4 v227, s[12:15], s44 offen offset:3072  lds
    v_exp_f32 v145, v41
    v_exp_f32 v146, v42
    v_smfmac_f32_32x32x32_bf16 v[96:111], v[168:171], v[136:143], v221
    v_exp_f32 v147, v43
    v_exp_f32 v148, v44
    v_exp_f32 v149, v45
    v_smfmac_f32_16x16x64_bf16 v[116:119], v[184:187], v[136:143], v221
    s_waitcnt vmcnt(28) lgkmcnt(0)
    buffer_load_dwordx4 a[92:95], v247, s[8:11], s43 offen offset:1024 sc1
    s_add_u32 s43, s43, 131072
    s_add_u32 s44, s44, 65536
    v_exp_f32 v150, v46
    v_exp_f32 v151, v47
    v_mfma_f32_32x32x16_bf16 v[32:47], v[160:163], v[8:11], v[64:79]
    ds_read_b128 v[152:155], v220 offset:24576
    ds_read_b128 v[156:159], v220 offset:25600
    v_exp_f32 v120, v16
    v_exp_f32 v121, v17
    v_exp_f32 v122, v18
    v_mfma_f32_32x32x16_bf16 v[32:47], v[164:167], v[12:15], v[32:47]
    ds_read_b64_tr_b16 v[188:189], v228 offset:0
    ds_read_b64_tr_b16 v[190:191], v228 offset:2048
    v_exp_f32 v123, v19
    v_exp_f32 v124, v20
    v_exp_f32 v125, v21
    v_smfmac_f32_32x32x32_bf16 v[96:111], v[172:175], v[144:151], v221
    s_add_u32 m0, s45, 12288
    buffer_load_dwordx4 a[96:99], v222, s[8:11], s43 offen offset:0 sc1
    v_exp_f32 v126, v22
    v_exp_f32 v127, v23
    v_exp_f32 v128, v24
    v_smfmac_f32_16x16x64_bf16 v[116:119], v[184:187], v[144:151], v221
    buffer_load_dwordx4 v224, s[12:15], s44 offen offset:0  lds
    v_exp_f32 v129, v25
    v_exp_f32 v130, v26
    v_smfmac_f32_32x32x32_bf16 v[80:95], v[176:179], v[120:127], v221
    s_add_u32 m0, s98, 16384
    v_exp_f32 v131, v27
    v_exp_f32 v132, v28
    v_exp_f32 v133, v29
    v_smfmac_f32_16x16x64_bf16 v[112:115], v[184:187], v[120:127], v221
    s_waitcnt lgkmcnt(0)
    buffer_load_dwordx4 a[100:103], v222, s[8:11], s43 offen offset:1024 sc1
    buffer_load_dwordx4 v242, s[16:19], s94 offen offset:2048 sc1 lds
    v_exp_f32 v134, v30
    v_exp_f32 v135, v31
    v_mfma_f32_32x32x16_bf16 v[16:31], v[152:155], v[0:3], v[48:63]
    ds_read_b128 v[168:171], v220 offset:26624
    ds_read_b128 v[172:175], v220 offset:27648
    v_exp_f32 v136, v32
    v_exp_f32 v137, v33
    v_exp_f32 v138, v34
    v_mfma_f32_32x32x16_bf16 v[16:31], v[156:159], v[4:7], v[16:31]
    ds_read_b64_tr_b16 v[192:193], v229 offset:0
    ds_read_b64_tr_b16 v[194:195], v229 offset:2048
    v_exp_f32 v139, v35
    v_exp_f32 v140, v36
    v_exp_f32 v141, v37
    v_smfmac_f32_32x32x32_bf16 v[80:95], v[180:183], v[128:135], v221
    s_add_u32 m0, s45, 12288
    buffer_load_dwordx4 a[104:107], v223, s[8:11], s43 offen offset:0 sc1
    v_exp_f32 v142, v38
    v_exp_f32 v143, v39
    v_exp_f32 v144, v40
    v_smfmac_f32_16x16x64_bf16 v[112:115], v[184:187], v[128:135], v221
    buffer_load_dwordx4 v225, s[12:15], s44 offen offset:1024  lds
    v_exp_f32 v145, v41
    v_exp_f32 v146, v42
    v_smfmac_f32_32x32x32_bf16 v[96:111], v[176:179], v[136:143], v221
    v_exp_f32 v147, v43
    v_exp_f32 v148, v44
    v_exp_f32 v149, v45
    v_smfmac_f32_16x16x64_bf16 v[116:119], v[184:187], v[136:143], v221
    s_waitcnt lgkmcnt(0)
    buffer_load_dwordx4 a[108:111], v223, s[8:11], s43 offen offset:1024 sc1
    v_exp_f32 v150, v46
    v_exp_f32 v151, v47
    v_mfma_f32_32x32x16_bf16 v[32:47], v[152:155], v[8:11], v[64:79]
    ds_read_b128 v[160:163], v220 offset:28672
    ds_read_b128 v[164:167], v220 offset:29696
    v_exp_f32 v120, v16
    v_exp_f32 v121, v17
    v_exp_f32 v122, v18
    v_mfma_f32_32x32x16_bf16 v[32:47], v[156:159], v[12:15], v[32:47]
    ds_read_b64_tr_b16 v[196:197], v228 offset:512
    ds_read_b64_tr_b16 v[198:199], v228 offset:2560
    v_exp_f32 v123, v19
    v_exp_f32 v124, v20
    v_exp_f32 v125, v21
    v_smfmac_f32_32x32x32_bf16 v[96:111], v[180:183], v[144:151], v221
    s_add_u32 m0, s45, 12288
    buffer_load_dwordx4 a[112:115], v246, s[8:11], s43 offen offset:0 sc1
    v_exp_f32 v126, v22
    v_exp_f32 v127, v23
    v_exp_f32 v128, v24
    v_smfmac_f32_16x16x64_bf16 v[116:119], v[184:187], v[144:151], v221
    buffer_load_dwordx4 v226, s[12:15], s44 offen offset:2048  lds
    v_exp_f32 v129, v25
    v_exp_f32 v130, v26
    v_smfmac_f32_32x32x32_bf16 v[80:95], v[168:171], v[120:127], v221
    s_add_u32 m0, s98, 16384
    v_exp_f32 v131, v27
    v_exp_f32 v132, v28
    v_exp_f32 v133, v29
    v_smfmac_f32_16x16x64_bf16 v[112:115], v[184:187], v[120:127], v221
    s_waitcnt lgkmcnt(0)
    buffer_load_dwordx4 a[116:119], v246, s[8:11], s43 offen offset:1024 sc1
    buffer_load_dwordx4 v243, s[16:19], s94 offen offset:3072 sc1 lds
    v_exp_f32 v134, v30
    v_exp_f32 v135, v31
    v_mfma_f32_32x32x16_bf16 v[16:31], v[160:163], v[0:3], v[48:63]
    ds_read_b128 v[176:179], v220 offset:30720
    ds_read_b128 v[180:183], v220 offset:31744
    v_exp_f32 v136, v32
    v_exp_f32 v137, v33
    v_exp_f32 v138, v34
    v_mfma_f32_32x32x16_bf16 v[16:31], v[164:167], v[4:7], v[16:31]
    s_add_u32 s94, s94, s3
    s_add_u32 s98, s97, s95
    ds_read_b64_tr_b16 v[200:201], v229 offset:512
    ds_read_b64_tr_b16 v[202:203], v229 offset:2560
    v_exp_f32 v139, v35
    v_exp_f32 v140, v36
    v_exp_f32 v141, v37
    v_smfmac_f32_32x32x32_bf16 v[80:95], v[172:175], v[128:135], v221
    s_add_u32 m0, s45, 12288
    buffer_load_dwordx4 a[120:123], v247, s[8:11], s43 offen offset:0 sc1
    v_exp_f32 v142, v38
    v_exp_f32 v143, v39
    v_exp_f32 v144, v40
    v_smfmac_f32_16x16x64_bf16 v[112:115], v[184:187], v[128:135], v221
    s_add_u32 s97, s97, 32768
    s_cmp_eq_u32 s97, 98304
    s_cselect_b32 s97, 0, s97
    buffer_load_dwordx4 v227, s[12:15], s44 offen offset:3072  lds
    v_exp_f32 v145, v41
    v_exp_f32 v146, v42
    v_smfmac_f32_32x32x32_bf16 v[96:111], v[168:171], v[136:143], v221
    s_add_u32 s96, s96, 1
    v_exp_f32 v147, v43
    v_exp_f32 v148, v44
    v_exp_f32 v149, v45
    v_smfmac_f32_16x16x64_bf16 v[116:119], v[184:187], v[136:143], v221
    s_waitcnt vmcnt(28) lgkmcnt(0)
    buffer_load_dwordx4 a[124:127], v247, s[8:11], s43 offen offset:1024 sc1
    s_add_u32 s43, s43, 131072
    s_add_u32 s44, s44, 65536
    s_barrier
    v_add_u32 v220, s97, v251
    v_exp_f32 v150, v46
    v_exp_f32 v151, v47
.p2align 6
L_cb_loop:
    v_mfma_f32_16x16x32_bf16 a[128:131], v[188:191], a[0:3], a[128:131]
    ds_read_b128 v[152:155], v220 offset:0
    ds_read_b128 v[156:159], v220 offset:1024
    v_mfma_f32_32x32x16_bf16 v[32:47], v[160:163], v[8:11], v[64:79]
    s_and_b32 s94, s94, s47
    v_exp_f32 v120, v16
    v_exp_f32 v121, v17
    v_exp_f32 v122, v18
    v_mfma_f32_16x16x32_bf16 a[132:135], v[192:195], a[0:3], a[132:135]
    v_exp_f32 v123, v19
    v_mfma_f32_32x32x16_bf16 v[32:47], v[164:167], v[12:15], v[32:47]
    v_exp_f32 v124, v20
    v_exp_f32 v125, v21
    v_exp_f32 v126, v22
    v_mfma_f32_16x16x32_bf16 a[136:139], v[196:199], a[0:3], a[136:139]
    v_exp_f32 v127, v23
    v_smfmac_f32_32x32x32_bf16 v[96:111], v[172:175], v[144:151], v221
    ds_read_b64_tr_b16 v[204:205], v228 offset:4096
    v_exp_f32 v128, v24
    v_exp_f32 v129, v25
    v_smfmac_f32_16x16x64_bf16 v[116:119], v[184:187], v[144:151], v221
    ds_read_b64_tr_b16 v[206:207], v228 offset:6144
    v_mfma_f32_16x16x32_bf16 a[140:143], v[200:203], a[0:3], a[140:143]
    v_exp_f32 v130, v26
    v_smfmac_f32_32x32x32_bf16 v[80:95], v[176:179], v[120:127], v221
    buffer_load_dwordx4 a[0:3], v222, s[8:11], s43 offen offset:0 sc1
    v_exp_f32 v131, v27
    v_exp_f32 v132, v28
    v_mfma_f32_16x16x32_bf16 a[156:159], v[200:203], a[4:7], a[156:159]
    s_add_u32 m0, s45, 0
    v_exp_f32 v133, v29
    v_smfmac_f32_16x16x64_bf16 v[112:115], v[184:187], v[120:127], v221
    buffer_load_dwordx4 v224, s[12:15], s44 offen offset:0  lds
    v_mfma_f32_16x16x32_bf16 a[152:155], v[196:199], a[4:7], a[152:155]
    s_mov_b32 m0, s98
    v_exp_f32 v134, v30
    v_mfma_f32_16x16x32_bf16 a[148:151], v[192:195], a[4:7], a[148:151]
    s_waitcnt lgkmcnt(0)
    v_exp_f32 v135, v31
    v_mfma_f32_16x16x32_bf16 a[144:147], v[188:191], a[4:7], a[144:147]
    buffer_load_dwordx4 a[4:7], v222, s[8:11], s43 offen offset:1024 sc1
    buffer_load_dwordx4 v240, s[16:19], s94 offen offset:0 sc1 lds
    v_mfma_f32_16x16x32_bf16 a[160:163], v[188:191], a[8:11], a[160:163]
    ds_read_b128 v[168:171], v220 offset:2048
    ds_read_b128 v[172:175], v220 offset:3072
    v_mfma_f32_32x32x16_bf16 v[16:31], v[152:155], v[0:3], v[48:63]
    v_exp_f32 v136, v32
    v_exp_f32 v137, v33
    v_exp_f32 v138, v34
    v_mfma_f32_16x16x32_bf16 a[164:167], v[192:195], a[8:11], a[164:167]
    v_exp_f32 v139, v35
    v_mfma_f32_32x32x16_bf16 v[16:31], v[156:159], v[4:7], v[16:31]
    v_exp_f32 v140, v36
    v_exp_f32 v141, v37
    v_exp_f32 v142, v38
    v_mfma_f32_16x16x32_bf16 a[168:171], v[196:199], a[8:11], a[168:171]
    v_exp_f32 v143, v39
    v_smfmac_f32_32x32x32_bf16 v[80:95], v[180:183], v[128:135], v221
    ds_read_b64_tr_b16 v[208:209], v229 offset:4096
    v_exp_f32 v144, v40
    v_exp_f32 v145, v41
    v_smfmac_f32_16x16x64_bf16 v[112:115], v[184:187], v[128:135], v221
    ds_read_b64_tr_b16 v[210:211], v229 offset:6144
    v_mfma_f32_16x16x32_bf16 a[172:175], v[200:203], a[8:11], a[172:175]
    v_exp_f32 v146, v42
    v_smfmac_f32_32x32x32_bf16 v[96:111], v[176:179], v[136:143], v221
    buffer_load_dwordx4 a[8:11], v223, s[8:11], s43 offen offset:0 sc1
    v_exp_f32 v147, v43
    v_exp_f32 v148, v44
    v_mfma_f32_16x16x32_bf16 a[188:191], v[200:203], a[12:15], a[188:191]
    s_add_u32 m0, s45, 0
    v_exp_f32 v149, v45
    v_smfmac_f32_16x16x64_bf16 v[116:119], v[184:187], v[136:143], v221
    buffer_load_dwordx4 v225, s[12:15], s44 offen offset:1024  lds
    v_mfma_f32_16x16x32_bf16 a[184:187], v[196:199], a[12:15], a[184:187]
    v_exp_f32 v150, v46
    v_mfma_f32_16x16x32_bf16 a[180:183], v[192:195], a[12:15], a[180:183]
    s_waitcnt lgkmcnt(0)
    v_exp_f32 v151, v47
    v_mfma_f32_16x16x32_bf16 a[176:179], v[188:191], a[12:15], a[176:179]
    buffer_load_dwordx4 a[12:15], v223, s[8:11], s43 offen offset:1024 sc1
    v_mfma_f32_16x16x32_bf16 a[192:195], v[188:191], a[16:19], a[192:195]
    ds_read_b128 v[160:163], v220 offset:4096
    ds_read_b128 v[164:167], v220 offset:5120
    v_mfma_f32_32x32x16_bf16 v[32:47], v[152:155], v[8:11], v[64:79]
    v_exp_f32 v120, v16
    v_exp_f32 v121, v17
    v_exp_f32 v122, v18
    v_mfma_f32_16x16x32_bf16 a[196:199], v[192:195], a[16:19], a[196:199]
    v_exp_f32 v123, v19
    v_mfma_f32_32x32x16_bf16 v[32:47], v[156:159], v[12:15], v[32:47]
    v_exp_f32 v124, v20
    v_exp_f32 v125, v21
    v_exp_f32 v126, v22
    v_mfma_f32_16x16x32_bf16 a[200:203], v[196:199], a[16:19], a[200:203]
    v_exp_f32 v127, v23
    v_smfmac_f32_32x32x32_bf16 v[96:111], v[180:183], v[144:151], v221
    ds_read_b64_tr_b16 v[212:213], v228 offset:4608
    v_exp_f32 v128, v24
    v_exp_f32 v129, v25
    v_smfmac_f32_16x16x64_bf16 v[116:119], v[184:187], v[144:151], v221
    ds_read_b64_tr_b16 v[214:215], v228 offset:6656
    v_mfma_f32_16x16x32_bf16 a[204:207], v[200:203], a[16:19], a[204:207]
    v_exp_f32 v130, v26
    v_smfmac_f32_32x32x32_bf16 v[80:95], v[168:171], v[120:127], v221
    buffer_load_dwordx4 a[16:19], v246, s[8:11], s43 offen offset:0 sc1
    v_exp_f32 v131, v27
    v_exp_f32 v132, v28
    v_mfma_f32_16x16x32_bf16 a[220:223], v[200:203], a[20:23], a[220:223]
    s_add_u32 m0, s45, 0
    v_exp_f32 v133, v29
    v_smfmac_f32_16x16x64_bf16 v[112:115], v[184:187], v[120:127], v221
    buffer_load_dwordx4 v226, s[12:15], s44 offen offset:2048  lds
    v_mfma_f32_16x16x32_bf16 a[216:219], v[196:199], a[20:23], a[216:219]
    s_mov_b32 m0, s98
    v_exp_f32 v134, v30
    v_mfma_f32_16x16x32_bf16 a[212:215], v[192:195], a[20:23], a[212:215]
    s_waitcnt lgkmcnt(0)
    v_exp_f32 v135, v31
    v_mfma_f32_16x16x32_bf16 a[208:211], v[188:191], a[20:23], a[208:211]
    buffer_load_dwordx4 a[20:23], v246, s[8:11], s43 offen offset:1024 sc1
    buffer_load_dwordx4 v241, s[16:19], s94 offen offset:1024 sc1 lds
    v_mfma_f32_16x16x32_bf16 a[224:227], v[188:191], a[24:27], a[224:227]
    ds_read_b128 v[176:179], v220 offset:6144
    ds_read_b128 v[180:183], v220 offset:7168
    v_mfma_f32_32x32x16_bf16 v[16:31], v[160:163], v[0:3], v[48:63]
    v_exp_f32 v136, v32
    v_exp_f32 v137, v33
    v_exp_f32 v138, v34
    v_mfma_f32_16x16x32_bf16 a[228:231], v[192:195], a[24:27], a[228:231]
    v_exp_f32 v139, v35
    v_mfma_f32_32x32x16_bf16 v[16:31], v[164:167], v[4:7], v[16:31]
    v_exp_f32 v140, v36
    v_exp_f32 v141, v37
    v_exp_f32 v142, v38
    v_mfma_f32_16x16x32_bf16 a[232:235], v[196:199], a[24:27], a[232:235]
    v_exp_f32 v143, v39
    v_smfmac_f32_32x32x32_bf16 v[80:95], v[172:175], v[128:135], v221
    ds_read_b64_tr_b16 v[216:217], v229 offset:4608
    v_exp_f32 v144, v40
    v_exp_f32 v145, v41
    v_smfmac_f32_16x16x64_bf16 v[112:115], v[184:187], v[128:135], v221
    ds_read_b64_tr_b16 v[218:219], v229 offset:6656
    v_mfma_f32_16x16x32_bf16 a[236:239], v[200:203], a[24:27], a[236:239]
    v_exp_f32 v146, v42
    v_smfmac_f32_32x32x32_bf16 v[96:111], v[168:171], v[136:143], v221
    buffer_load_dwordx4 a[24:27], v247, s[8:11], s43 offen offset:0 sc1
    v_exp_f32 v147, v43
    v_exp_f32 v148, v44
    v_mfma_f32_16x16x32_bf16 a[252:255], v[200:203], a[28:31], a[252:255]
    s_add_u32 m0, s45, 0
    v_exp_f32 v149, v45
    v_smfmac_f32_16x16x64_bf16 v[116:119], v[184:187], v[136:143], v221
    buffer_load_dwordx4 v227, s[12:15], s44 offen offset:3072  lds
    v_mfma_f32_16x16x32_bf16 a[248:251], v[196:199], a[28:31], a[248:251]
    v_exp_f32 v150, v46
    v_mfma_f32_16x16x32_bf16 a[244:247], v[192:195], a[28:31], a[244:247]
    s_waitcnt vmcnt(28) lgkmcnt(0)
    v_exp_f32 v151, v47
    v_mfma_f32_16x16x32_bf16 a[240:243], v[188:191], a[28:31], a[240:243]
    buffer_load_dwordx4 a[28:31], v247, s[8:11], s43 offen offset:1024 sc1
    s_add_u32 s43, s43, 131072
    s_add_u32 s44, s44, 65536
    v_mfma_f32_16x16x32_bf16 a[128:131], v[204:207], a[32:35], a[128:131]
    ds_read_b128 v[152:155], v220 offset:8192
    ds_read_b128 v[156:159], v220 offset:9216
    v_mfma_f32_32x32x16_bf16 v[32:47], v[160:163], v[8:11], v[64:79]
    v_exp_f32 v120, v16
    v_exp_f32 v121, v17
    v_exp_f32 v122, v18
    v_mfma_f32_16x16x32_bf16 a[132:135], v[208:211], a[32:35], a[132:135]
    v_exp_f32 v123, v19
    v_mfma_f32_32x32x16_bf16 v[32:47], v[164:167], v[12:15], v[32:47]
    v_exp_f32 v124, v20
    v_exp_f32 v125, v21
    v_exp_f32 v126, v22
    v_mfma_f32_16x16x32_bf16 a[136:139], v[212:215], a[32:35], a[136:139]
    v_exp_f32 v127, v23
    v_smfmac_f32_32x32x32_bf16 v[96:111], v[172:175], v[144:151], v221
    ds_read_b64_tr_b16 v[188:189], v228 offset:8192
    v_exp_f32 v128, v24
    v_exp_f32 v129, v25
    v_smfmac_f32_16x16x64_bf16 v[116:119], v[184:187], v[144:151], v221
    ds_read_b64_tr_b16 v[190:191], v228 offset:10240
    v_mfma_f32_16x16x32_bf16 a[140:143], v[216:219], a[32:35], a[140:143]
    v_exp_f32 v130, v26
    v_smfmac_f32_32x32x32_bf16 v[80:95], v[176:179], v[120:127], v221
    buffer_load_dwordx4 a[32:35], v222, s[8:11], s43 offen offset:0 sc1
    v_exp_f32 v131, v27
    v_exp_f32 v132, v28
    v_mfma_f32_16x16x32_bf16 a[156:159], v[216:219], a[36:39], a[156:159]
    s_add_u32 m0, s45, 4096
    v_exp_f32 v133, v29
    v_smfmac_f32_16x16x64_bf16 v[112:115], v[184:187], v[120:127], v221
    buffer_load_dwordx4 v224, s[12:15], s44 offen offset:0  lds
    v_mfma_f32_16x16x32_bf16 a[152:155], v[212:215], a[36:39], a[152:155]
    s_mov_b32 m0, s98
    v_exp_f32 v134, v30
    v_mfma_f32_16x16x32_bf16 a[148:151], v[208:211], a[36:39], a[148:151]
    s_waitcnt lgkmcnt(0)
    v_exp_f32 v135, v31
    v_mfma_f32_16x16x32_bf16 a[144:147], v[204:207], a[36:39], a[144:147]
    buffer_load_dwordx4 a[36:39], v222, s[8:11], s43 offen offset:1024 sc1
    buffer_load_dwordx4 v242, s[16:19], s94 offen offset:2048 sc1 lds
    v_mfma_f32_16x16x32_bf16 a[160:163], v[204:207], a[40:43], a[160:163]
    ds_read_b128 v[168:171], v220 offset:10240
    ds_read_b128 v[172:175], v220 offset:11264
    v_mfma_f32_32x32x16_bf16 v[16:31], v[152:155], v[0:3], v[48:63]
    v_exp_f32 v136, v32
    v_exp_f32 v137, v33
    v_exp_f32 v138, v34
    v_mfma_f32_16x16x32_bf16 a[164:167], v[208:211], a[40:43], a[164:167]
    v_exp_f32 v139, v35
    v_mfma_f32_32x32x16_bf16 v[16:31], v[156:159], v[4:7], v[16:31]
    v_exp_f32 v140, v36
    v_exp_f32 v141, v37
    v_exp_f32 v142, v38
    v_mfma_f32_16x16x32_bf16 a[168:171], v[212:215], a[40:43], a[168:171]
    v_exp_f32 v143, v39
    v_smfmac_f32_32x32x32_bf16 v[80:95], v[180:183], v[128:135], v221
    ds_read_b64_tr_b16 v[192:193], v229 offset:8192
    v_exp_f32 v144, v40
    v_exp_f32 v145, v41
    v_smfmac_f32_16x16x64_bf16 v[112:115], v[184:187], v[128:135], v221
    ds_read_b64_tr_b16 v[194:195], v229 offset:10240
    v_mfma_f32_16x16x32_bf16 a[172:175], v[216:219], a[40:43], a[172:175]
    v_exp_f32 v146, v42
    v_smfmac_f32_32x32x32_bf16 v[96:111], v[176:179], v[136:143], v221
    buffer_load_dwordx4 a[40:43], v223, s[8:11], s43 offen offset:0 sc1
    v_exp_f32 v147, v43
    v_exp_f32 v148, v44
    v_mfma_f32_16x16x32_bf16 a[188:191], v[216:219], a[44:47], a[188:191]
    s_add_u32 m0, s45, 4096
    v_exp_f32 v149, v45
    v_smfmac_f32_16x16x64_bf16 v[116:119], v[184:187], v[136:143], v221
    buffer_load_dwordx4 v225, s[12:15], s44 offen offset:1024  lds
    v_mfma_f32_16x16x32_bf16 a[184:187], v[212:215], a[44:47], a[184:187]
    v_exp_f32 v150, v46
    v_mfma_f32_16x16x32_bf16 a[180:183], v[208:211], a[44:47], a[180:183]
    s_waitcnt lgkmcnt(0)
    v_exp_f32 v151, v47
    v_mfma_f32_16x16x32_bf16 a[176:179], v[204:207], a[44:47], a[176:179]
    buffer_load_dwordx4 a[44:47], v223, s[8:11], s43 offen offset:1024 sc1
    global_load_dwordx4 v[236:239], v[248:249], off
    v_mfma_f32_16x16x32_bf16 a[192:195], v[204:207], a[48:51], a[192:195]
    ds_read_b128 v[160:163], v220 offset:12288
    ds_read_b128 v[164:167], v220 offset:13312
    v_mfma_f32_32x32x16_bf16 v[32:47], v[152:155], v[8:11], v[64:79]
    v_exp_f32 v120, v16
    v_exp_f32 v121, v17
    v_exp_f32 v122, v18
    v_mfma_f32_16x16x32_bf16 a[196:199], v[208:211], a[48:51], a[196:199]
    v_exp_f32 v123, v19
    v_mfma_f32_32x32x16_bf16 v[32:47], v[156:159], v[12:15], v[32:47]
    v_exp_f32 v124, v20
    v_exp_f32 v125, v21
    v_exp_f32 v126, v22
    v_mfma_f32_16x16x32_bf16 a[200:203], v[212:215], a[48:51], a[200:203]
    v_exp_f32 v127, v23
    v_smfmac_f32_32x32x32_bf16 v[96:111], v[180:183], v[144:151], v221
    ds_read_b64_tr_b16 v[196:197], v228 offset:8704
    v_exp_f32 v128, v24
    v_exp_f32 v129, v25
    v_smfmac_f32_16x16x64_bf16 v[116:119], v[184:187], v[144:151], v221
    ds_read_b64_tr_b16 v[198:199], v228 offset:10752
    v_mfma_f32_16x16x32_bf16 a[204:207], v[216:219], a[48:51], a[204:207]
    v_exp_f32 v130, v26
    v_smfmac_f32_32x32x32_bf16 v[80:95], v[168:171], v[120:127], v221
    buffer_load_dwordx4 a[48:51], v246, s[8:11], s43 offen offset:0 sc1
    v_exp_f32 v131, v27
    v_exp_f32 v132, v28
    v_mfma_f32_16x16x32_bf16 a[220:223], v[216:219], a[52:55], a[220:223]
    s_add_u32 m0, s45, 4096
    v_exp_f32 v133, v29
    v_smfmac_f32_16x16x64_bf16 v[112:115], v[184:187], v[120:127], v221
    buffer_load_dwordx4 v226, s[12:15], s44 offen offset:2048  lds
    v_mfma_f32_16x16x32_bf16 a[216:219], v[212:215], a[52:55], a[216:219]
    s_mov_b32 m0, s98
    v_exp_f32 v134, v30
    v_mfma_f32_16x16x32_bf16 a[212:215], v[208:211], a[52:55], a[212:215]
    s_waitcnt lgkmcnt(0)
    v_exp_f32 v135, v31
    v_mfma_f32_16x16x32_bf16 a[208:211], v[204:207], a[52:55], a[208:211]
    buffer_load_dwordx4 a[52:55], v246, s[8:11], s43 offen offset:1024 sc1
    buffer_load_dwordx4 v243, s[16:19], s94 offen offset:3072 sc1 lds
    v_mfma_f32_16x16x32_bf16 a[224:227], v[204:207], a[56:59], a[224:227]
    ds_read_b128 v[176:179], v220 offset:14336
    ds_read_b128 v[180:183], v220 offset:15360
    v_mfma_f32_32x32x16_bf16 v[16:31], v[160:163], v[0:3], v[48:63]
    s_add_u32 s94, s94, s3
    v_exp_f32 v136, v32
    v_exp_f32 v137, v33
    v_exp_f32 v138, v34
    v_mfma_f32_16x16x32_bf16 a[228:231], v[208:211], a[56:59], a[228:231]
    v_exp_f32 v139, v35
    v_mfma_f32_32x32x16_bf16 v[16:31], v[164:167], v[4:7], v[16:31]
    v_exp_f32 v140, v36
    v_exp_f32 v141, v37
    v_exp_f32 v142, v38
    v_mfma_f32_16x16x32_bf16 a[232:235], v[212:215], a[56:59], a[232:235]
    v_exp_f32 v143, v39
    v_smfmac_f32_32x32x32_bf16 v[80:95], v[172:175], v[128:135], v221
    ds_read_b64_tr_b16 v[200:201], v229 offset:8704
    v_exp_f32 v144, v40
    v_exp_f32 v145, v41
    v_smfmac_f32_16x16x64_bf16 v[112:115], v[184:187], v[128:135], v221
    ds_read_b64_tr_b16 v[202:203], v229 offset:10752
    v_mfma_f32_16x16x32_bf16 a[236:239], v[216:219], a[56:59], a[236:239]
    v_exp_f32 v146, v42
    v_smfmac_f32_32x32x32_bf16 v[96:111], v[168:171], v[136:143], v221
    buffer_load_dwordx4 a[56:59], v247, s[8:11], s43 offen offset:0 sc1
    v_exp_f32 v147, v43
    v_exp_f32 v148, v44
    v_mfma_f32_16x16x32_bf16 a[252:255], v[216:219], a[60:63], a[252:255]
    s_add_u32 m0, s45, 4096
    v_exp_f32 v149, v45
    v_smfmac_f32_16x16x64_bf16 v[116:119], v[184:187], v[136:143], v221
    buffer_load_dwordx4 v227, s[12:15], s44 offen offset:3072  lds
    v_mfma_f32_16x16x32_bf16 a[248:251], v[212:215], a[60:63], a[248:251]
    v_exp_f32 v150, v46
    v_mfma_f32_16x16x32_bf16 a[244:247], v[208:211], a[60:63], a[244:247]
    s_waitcnt vmcnt(28) lgkmcnt(0)
    v_exp_f32 v151, v47
    v_mfma_f32_16x16x32_bf16 a[240:243], v[204:207], a[60:63], a[240:243]
    buffer_load_dwordx4 a[60:63], v247, s[8:11], s43 offen offset:1024 sc1
    s_add_u32 s43, s43, 131072
    s_add_u32 s44, s44, 65536
    v_mfma_f32_16x16x32_bf16 a[128:131], v[188:191], a[64:67], a[128:131]
    ds_read_b128 v[152:155], v220 offset:16384
    ds_read_b128 v[156:159], v220 offset:17408
    v_mfma_f32_32x32x16_bf16 v[32:47], v[160:163], v[8:11], v[64:79]
    v_exp_f32 v120, v16
    v_exp_f32 v121, v17
    v_exp_f32 v122, v18
    v_mfma_f32_16x16x32_bf16 a[132:135], v[192:195], a[64:67], a[132:135]
    v_exp_f32 v123, v19
    v_mfma_f32_32x32x16_bf16 v[32:47], v[164:167], v[12:15], v[32:47]
    v_exp_f32 v124, v20
    v_exp_f32 v125, v21
    v_exp_f32 v126, v22
    v_mfma_f32_16x16x32_bf16 a[136:139], v[196:199], a[64:67], a[136:139]
    v_exp_f32 v127, v23
    v_smfmac_f32_32x32x32_bf16 v[96:111], v[172:175], v[144:151], v221
    ds_read_b64_tr_b16 v[204:205], v228 offset:12288
    v_exp_f32 v128, v24
    v_exp_f32 v129, v25
    v_smfmac_f32_16x16x64_bf16 v[116:119], v[184:187], v[144:151], v221
    ds_read_b64_tr_b16 v[206:207], v228 offset:14336
    v_mfma_f32_16x16x32_bf16 a[140:143], v[200:203], a[64:67], a[140:143]
    v_exp_f32 v130, v26
    v_smfmac_f32_32x32x32_bf16 v[80:95], v[176:179], v[120:127], v221
    buffer_load_dwordx4 a[64:67], v222, s[8:11], s43 offen offset:0 sc1
    v_exp_f32 v131, v27
    v_exp_f32 v132, v28
    v_mfma_f32_16x16x32_bf16 a[156:159], v[200:203], a[68:71], a[156:159]
    s_add_u32 m0, s45, 8192
    v_exp_f32 v133, v29
    v_smfmac_f32_16x16x64_bf16 v[112:115], v[184:187], v[120:127], v221
    buffer_load_dwordx4 v224, s[12:15], s44 offen offset:0  lds
    v_mfma_f32_16x16x32_bf16 a[152:155], v[196:199], a[68:71], a[152:155]
    s_add_u32 m0, s98, 16384
    v_exp_f32 v134, v30
    v_mfma_f32_16x16x32_bf16 a[148:151], v[192:195], a[68:71], a[148:151]
    s_waitcnt lgkmcnt(0)
    v_exp_f32 v135, v31
    v_mfma_f32_16x16x32_bf16 a[144:147], v[188:191], a[68:71], a[144:147]
    buffer_load_dwordx4 a[68:71], v222, s[8:11], s43 offen offset:1024 sc1
    buffer_load_dwordx4 v240, s[16:19], s94 offen offset:0 sc1 lds
    v_mfma_f32_16x16x32_bf16 a[160:163], v[188:191], a[72:75], a[160:163]
    ds_read_b128 v[168:171], v220 offset:18432
    ds_read_b128 v[172:175], v220 offset:19456
    v_mfma_f32_32x32x16_bf16 v[16:31], v[152:155], v[0:3], v[48:63]
    v_exp_f32 v136, v32
    v_exp_f32 v137, v33
    v_exp_f32 v138, v34
    v_mfma_f32_16x16x32_bf16 a[164:167], v[192:195], a[72:75], a[164:167]
    v_exp_f32 v139, v35
    v_mfma_f32_32x32x16_bf16 v[16:31], v[156:159], v[4:7], v[16:31]
    v_exp_f32 v140, v36
    v_exp_f32 v141, v37
    v_exp_f32 v142, v38
    v_mfma_f32_16x16x32_bf16 a[168:171], v[196:199], a[72:75], a[168:171]
    v_exp_f32 v143, v39
    v_smfmac_f32_32x32x32_bf16 v[80:95], v[180:183], v[128:135], v221
    ds_read_b64_tr_b16 v[208:209], v229 offset:12288
    v_exp_f32 v144, v40
    v_exp_f32 v145, v41
    v_smfmac_f32_16x16x64_bf16 v[112:115], v[184:187], v[128:135], v221
    ds_read_b64_tr_b16 v[210:211], v229 offset:14336
    v_mfma_f32_16x16x32_bf16 a[172:175], v[200:203], a[72:75], a[172:175]
    v_exp_f32 v146, v42
    v_smfmac_f32_32x32x32_bf16 v[96:111], v[176:179], v[136:143], v221
    buffer_load_dwordx4 a[72:75], v223, s[8:11], s43 offen offset:0 sc1
    v_exp_f32 v147, v43
    v_exp_f32 v148, v44
    v_mfma_f32_16x16x32_bf16 a[188:191], v[200:203], a[76:79], a[188:191]
    s_add_u32 m0, s45, 8192
    v_exp_f32 v149, v45
    v_smfmac_f32_16x16x64_bf16 v[116:119], v[184:187], v[136:143], v221
    buffer_load_dwordx4 v225, s[12:15], s44 offen offset:1024  lds
    v_mfma_f32_16x16x32_bf16 a[184:187], v[196:199], a[76:79], a[184:187]
    v_exp_f32 v150, v46
    v_mfma_f32_16x16x32_bf16 a[180:183], v[192:195], a[76:79], a[180:183]
    s_waitcnt lgkmcnt(0)
    v_exp_f32 v151, v47
    v_mfma_f32_16x16x32_bf16 a[176:179], v[188:191], a[76:79], a[176:179]
    buffer_load_dwordx4 a[76:79], v223, s[8:11], s43 offen offset:1024 sc1
    v_mfma_f32_16x16x32_bf16 a[192:195], v[188:191], a[80:83], a[192:195]
    ds_read_b128 v[160:163], v220 offset:20480
    ds_read_b128 v[164:167], v220 offset:21504
    v_mfma_f32_32x32x16_bf16 v[32:47], v[152:155], v[8:11], v[64:79]
    v_exp_f32 v120, v16
    v_exp_f32 v121, v17
    v_exp_f32 v122, v18
    v_mfma_f32_16x16x32_bf16 a[196:199], v[192:195], a[80:83], a[196:199]
    v_exp_f32 v123, v19
    v_mfma_f32_32x32x16_bf16 v[32:47], v[156:159], v[12:15], v[32:47]
    v_exp_f32 v124, v20
    v_exp_f32 v125, v21
    v_exp_f32 v126, v22
    v_mfma_f32_16x16x32_bf16 a[200:203], v[196:199], a[80:83], a[200:203]
    v_exp_f32 v127, v23
    v_smfmac_f32_32x32x32_bf16 v[96:111], v[180:183], v[144:151], v221
    ds_read_b64_tr_b16 v[212:213], v228 offset:12800
    v_exp_f32 v128, v24
    v_exp_f32 v129, v25
    v_smfmac_f32_16x16x64_bf16 v[116:119], v[184:187], v[144:151], v221
    ds_read_b64_tr_b16 v[214:215], v228 offset:14848
    v_mfma_f32_16x16x32_bf16 a[204:207], v[200:203], a[80:83], a[204:207]
    v_exp_f32 v130, v26
    v_smfmac_f32_32x32x32_bf16 v[80:95], v[168:171], v[120:127], v221
    buffer_load_dwordx4 a[80:83], v246, s[8:11], s43 offen offset:0 sc1
    v_exp_f32 v131, v27
    v_exp_f32 v132, v28
    v_mfma_f32_16x16x32_bf16 a[220:223], v[200:203], a[84:87], a[220:223]
    s_add_u32 m0, s45, 8192
    v_exp_f32 v133, v29
    v_smfmac_f32_16x16x64_bf16 v[112:115], v[184:187], v[120:127], v221
    buffer_load_dwordx4 v226, s[12:15], s44 offen offset:2048  lds
    v_mfma_f32_16x16x32_bf16 a[216:219], v[196:199], a[84:87], a[216:219]
    s_add_u32 m0, s98, 16384
    v_exp_f32 v134, v30
    v_mfma_f32_16x16x32_bf16 a[212:215], v[192:195], a[84:87], a[212:215]
    s_waitcnt lgkmcnt(0)
    v_exp_f32 v135, v31
    v_mfma_f32_16x16x32_bf16 a[208:211], v[188:191], a[84:87], a[208:211]
    buffer_load_dwordx4 a[84:87], v246, s[8:11], s43 offen offset:1024 sc1
    buffer_load_dwordx4 v241, s[16:19], s94 offen offset:1024 sc1 lds
    v_mfma_f32_16x16x32_bf16 a[224:227], v[188:191], a[88:91], a[224:227]
    ds_read_b128 v[176:179], v220 offset:22528
    ds_read_b128 v[180:183], v220 offset:23552
    v_mfma_f32_32x32x16_bf16 v[16:31], v[160:163], v[0:3], v[48:63]
    v_exp_f32 v136, v32
    v_exp_f32 v137, v33
    v_exp_f32 v138, v34
    v_mfma_f32_16x16x32_bf16 a[228:231], v[192:195], a[88:91], a[228:231]
    v_exp_f32 v139, v35
    v_mfma_f32_32x32x16_bf16 v[16:31], v[164:167], v[4:7], v[16:31]
    v_exp_f32 v140, v36
    v_exp_f32 v141, v37
    v_exp_f32 v142, v38
    v_mfma_f32_16x16x32_bf16 a[232:235], v[196:199], a[88:91], a[232:235]
    v_exp_f32 v143, v39
    v_smfmac_f32_32x32x32_bf16 v[80:95], v[172:175], v[128:135], v221
    ds_read_b64_tr_b16 v[216:217], v229 offset:12800
    v_exp_f32 v144, v40
    v_exp_f32 v145, v41
    v_smfmac_f32_16x16x64_bf16 v[112:115], v[184:187], v[128:135], v221
    ds_read_b64_tr_b16 v[218:219], v229 offset:14848
    v_mfma_f32_16x16x32_bf16 a[236:239], v[200:203], a[88:91], a[236:239]
    v_exp_f32 v146, v42
    v_smfmac_f32_32x32x32_bf16 v[96:111], v[168:171], v[136:143], v221
    buffer_load_dwordx4 a[88:91], v247, s[8:11], s43 offen offset:0 sc1
    v_exp_f32 v147, v43
    v_exp_f32 v148, v44
    v_mfma_f32_16x16x32_bf16 a[252:255], v[200:203], a[92:95], a[252:255]
    s_add_u32 m0, s45, 8192
    v_exp_f32 v149, v45
    v_smfmac_f32_16x16x64_bf16 v[116:119], v[184:187], v[136:143], v221
    buffer_load_dwordx4 v227, s[12:15], s44 offen offset:3072  lds
    v_mfma_f32_16x16x32_bf16 a[248:251], v[196:199], a[92:95], a[248:251]
    v_exp_f32 v150, v46
    v_mfma_f32_16x16x32_bf16 a[244:247], v[192:195], a[92:95], a[244:247]
    s_waitcnt vmcnt(28) lgkmcnt(0)
    v_exp_f32 v151, v47
    v_mfma_f32_16x16x32_bf16 a[240:243], v[188:191], a[92:95], a[240:243]
    buffer_load_dwordx4 a[92:95], v247, s[8:11], s43 offen offset:1024 sc1
    s_add_u32 s43, s43, 131072
    s_add_u32 s44, s44, 65536
    v_mfma_f32_16x16x32_bf16 a[128:131], v[204:207], a[96:99], a[128:131]
    ds_read_b128 v[152:155], v220 offset:24576
    ds_read_b128 v[156:159], v220 offset:25600
    v_mfma_f32_32x32x16_bf16 v[32:47], v[160:163], v[8:11], v[64:79]
    v_exp_f32 v120, v16
    v_exp_f32 v121, v17
    v_exp_f32 v122, v18
    v_mfma_f32_16x16x32_bf16 a[132:135], v[208:211], a[96:99], a[132:135]
    v_exp_f32 v123, v19
    v_mfma_f32_32x32x16_bf16 v[32:47], v[164:167], v[12:15], v[32:47]
    v_exp_f32 v124, v20
    v_exp_f32 v125, v21
    v_exp_f32 v126, v22
    v_mfma_f32_16x16x32_bf16 a[136:139], v[212:215], a[96:99], a[136:139]
    v_exp_f32 v127, v23
    v_smfmac_f32_32x32x32_bf16 v[96:111], v[172:175], v[144:151], v221
    ds_read_b64_tr_b16 v[188:189], v228 offset:0
    v_exp_f32 v128, v24
    v_exp_f32 v129, v25
    v_smfmac_f32_16x16x64_bf16 v[116:119], v[184:187], v[144:151], v221
    ds_read_b64_tr_b16 v[190:191], v228 offset:2048
    v_mfma_f32_16x16x32_bf16 a[140:143], v[216:219], a[96:99], a[140:143]
    v_exp_f32 v130, v26
    v_smfmac_f32_32x32x32_bf16 v[80:95], v[176:179], v[120:127], v221
    buffer_load_dwordx4 a[96:99], v222, s[8:11], s43 offen offset:0 sc1
    v_exp_f32 v131, v27
    v_exp_f32 v132, v28
    v_mfma_f32_16x16x32_bf16 a[156:159], v[216:219], a[100:103], a[156:159]
    s_add_u32 m0, s45, 12288
    v_exp_f32 v133, v29
    v_smfmac_f32_16x16x64_bf16 v[112:115], v[184:187], v[120:127], v221
    buffer_load_dwordx4 v224, s[12:15], s44 offen offset:0  lds
    v_mfma_f32_16x16x32_bf16 a[152:155], v[212:215], a[100:103], a[152:155]
    s_add_u32 m0, s98, 16384
    v_exp_f32 v134, v30
    v_mfma_f32_16x16x32_bf16 a[148:151], v[208:211], a[100:103], a[148:151]
    s_waitcnt lgkmcnt(0)
    v_exp_f32 v135, v31
    v_mfma_f32_16x16x32_bf16 a[144:147], v[204:207], a[100:103], a[144:147]
    buffer_load_dwordx4 a[100:103], v222, s[8:11], s43 offen offset:1024 sc1
    buffer_load_dwordx4 v242, s[16:19], s94 offen offset:2048 sc1 lds
    v_mfma_f32_16x16x32_bf16 a[160:163], v[204:207], a[104:107], a[160:163]
    ds_read_b128 v[168:171], v220 offset:26624
    ds_read_b128 v[172:175], v220 offset:27648
    v_mfma_f32_32x32x16_bf16 v[16:31], v[152:155], v[0:3], v[48:63]
    v_exp_f32 v136, v32
    v_exp_f32 v137, v33
    v_exp_f32 v138, v34
    v_mfma_f32_16x16x32_bf16 a[164:167], v[208:211], a[104:107], a[164:167]
    v_exp_f32 v139, v35
    v_mfma_f32_32x32x16_bf16 v[16:31], v[156:159], v[4:7], v[16:31]
    v_exp_f32 v140, v36
    v_exp_f32 v141, v37
    v_exp_f32 v142, v38
    v_mfma_f32_16x16x32_bf16 a[168:171], v[212:215], a[104:107], a[168:171]
    v_exp_f32 v143, v39
    v_smfmac_f32_32x32x32_bf16 v[80:95], v[180:183], v[128:135], v221
    ds_read_b64_tr_b16 v[192:193], v229 offset:0
    v_exp_f32 v144, v40
    v_exp_f32 v145, v41
    v_smfmac_f32_16x16x64_bf16 v[112:115], v[184:187], v[128:135], v221
    ds_read_b64_tr_b16 v[194:195], v229 offset:2048
    v_mfma_f32_16x16x32_bf16 a[172:175], v[216:219], a[104:107], a[172:175]
    v_exp_f32 v146, v42
    v_smfmac_f32_32x32x32_bf16 v[96:111], v[176:179], v[136:143], v221
    buffer_load_dwordx4 a[104:107], v223, s[8:11], s43 offen offset:0 sc1
    v_exp_f32 v147, v43
    v_exp_f32 v148, v44
    v_mfma_f32_16x16x32_bf16 a[188:191], v[216:219], a[108:111], a[188:191]
    s_add_u32 m0, s45, 12288
    v_exp_f32 v149, v45
    v_smfmac_f32_16x16x64_bf16 v[116:119], v[184:187], v[136:143], v221
    buffer_load_dwordx4 v225, s[12:15], s44 offen offset:1024  lds
    v_mfma_f32_16x16x32_bf16 a[184:187], v[212:215], a[108:111], a[184:187]
    v_exp_f32 v150, v46
    v_mfma_f32_16x16x32_bf16 a[180:183], v[208:211], a[108:111], a[180:183]
    s_waitcnt lgkmcnt(0)
    v_exp_f32 v151, v47
    v_mfma_f32_16x16x32_bf16 a[176:179], v[204:207], a[108:111], a[176:179]
    buffer_load_dwordx4 a[108:111], v223, s[8:11], s43 offen offset:1024 sc1
    v_mfma_f32_16x16x32_bf16 a[192:195], v[204:207], a[112:115], a[192:195]
    ds_read_b128 v[160:163], v220 offset:28672
    ds_read_b128 v[164:167], v220 offset:29696
    v_mfma_f32_32x32x16_bf16 v[32:47], v[152:155], v[8:11], v[64:79]
    v_exp_f32 v120, v16
    v_exp_f32 v121, v17
    v_exp_f32 v122, v18
    v_mfma_f32_16x16x32_bf16 a[196:199], v[208:211], a[112:115], a[196:199]
    v_exp_f32 v123, v19
    v_mfma_f32_32x32x16_bf16 v[32:47], v[156:159], v[12:15], v[32:47]
    v_exp_f32 v124, v20
    v_exp_f32 v125, v21
    v_exp_f32 v126, v22
    v_mfma_f32_16x16x32_bf16 a[200:203], v[212:215], a[112:115], a[200:203]
    v_exp_f32 v127, v23
    v_smfmac_f32_32x32x32_bf16 v[96:111], v[180:183], v[144:151], v221
    ds_read_b64_tr_b16 v[196:197], v228 offset:512
    v_exp_f32 v128, v24
    v_exp_f32 v129, v25
    v_smfmac_f32_16x16x64_bf16 v[116:119], v[184:187], v[144:151], v221
    ds_read_b64_tr_b16 v[198:199], v228 offset:2560
    v_mfma_f32_16x16x32_bf16 a[204:207], v[216:219], a[112:115], a[204:207]
    v_exp_f32 v130, v26
    v_smfmac_f32_32x32x32_bf16 v[80:95], v[168:171], v[120:127], v221
    buffer_load_dwordx4 a[112:115], v246, s[8:11], s43 offen offset:0 sc1
    v_exp_f32 v131, v27
    v_exp_f32 v132, v28
    v_mfma_f32_16x16x32_bf16 a[220:223], v[216:219], a[116:119], a[220:223]
    s_add_u32 m0, s45, 12288
    v_exp_f32 v133, v29
    v_smfmac_f32_16x16x64_bf16 v[112:115], v[184:187], v[120:127], v221
    buffer_load_dwordx4 v226, s[12:15], s44 offen offset:2048  lds
    v_mfma_f32_16x16x32_bf16 a[216:219], v[212:215], a[116:119], a[216:219]
    s_add_u32 m0, s98, 16384
    v_exp_f32 v134, v30
    v_mfma_f32_16x16x32_bf16 a[212:215], v[208:211], a[116:119], a[212:215]
    s_waitcnt lgkmcnt(0)
    v_exp_f32 v135, v31
    v_mfma_f32_16x16x32_bf16 a[208:211], v[204:207], a[116:119], a[208:211]
    buffer_load_dwordx4 a[116:119], v246, s[8:11], s43 offen offset:1024 sc1
    buffer_load_dwordx4 v243, s[16:19], s94 offen offset:3072 sc1 lds
    v_mfma_f32_16x16x32_bf16 a[224:227], v[204:207], a[120:123], a[224:227]
    ds_read_b128 v[176:179], v220 offset:30720
    ds_read_b128 v[180:183], v220 offset:31744
    v_mfma_f32_32x32x16_bf16 v[16:31], v[160:163], v[0:3], v[48:63]
    s_add_u32 s94, s94, s3
    v_exp_f32 v136, v32
    v_exp_f32 v137, v33
    v_exp_f32 v138, v34
    v_mfma_f32_16x16x32_bf16 a[228:231], v[208:211], a[120:123], a[228:231]
    s_add_u32 s98, s97, s95
    v_exp_f32 v139, v35
    v_mfma_f32_32x32x16_bf16 v[16:31], v[164:167], v[4:7], v[16:31]
    s_add_u32 s97, s97, 32768
    v_exp_f32 v140, v36
    v_exp_f32 v141, v37
    v_exp_f32 v142, v38
    v_mfma_f32_16x16x32_bf16 a[232:235], v[212:215], a[120:123], a[232:235]
    s_cmp_eq_u32 s97, 98304
    v_exp_f32 v143, v39
    v_smfmac_f32_32x32x32_bf16 v[80:95], v[172:175], v[128:135], v221
    ds_read_b64_tr_b16 v[200:201], v229 offset:512
    v_exp_f32 v144, v40
    v_exp_f32 v145, v41
    v_smfmac_f32_16x16x64_bf16 v[112:115], v[184:187], v[128:135], v221
    ds_read_b64_tr_b16 v[202:203], v229 offset:2560
    v_mfma_f32_16x16x32_bf16 a[236:239], v[216:219], a[120:123], a[236:239]
    s_cselect_b32 s97, 0, s97
    v_exp_f32 v146, v42
    v_smfmac_f32_32x32x32_bf16 v[96:111], v[168:171], v[136:143], v221
    buffer_load_dwordx4 a[120:123], v247, s[8:11], s43 offen offset:0 sc1
    v_exp_f32 v147, v43
    v_exp_f32 v148, v44
    v_mfma_f32_16x16x32_bf16 a[252:255], v[216:219], a[124:127], a[252:255]
    s_add_u32 m0, s45, 12288
    v_exp_f32 v149, v45
    v_smfmac_f32_16x16x64_bf16 v[116:119], v[184:187], v[136:143], v221
    buffer_load_dwordx4 v227, s[12:15], s44 offen offset:3072  lds
    v_mfma_f32_16x16x32_bf16 a[248:251], v[212:215], a[124:127], a[248:251]
    s_add_u32 s96, s96, 1
    v_exp_f32 v150, v46
    v_mfma_f32_16x16x32_bf16 a[244:247], v[208:211], a[124:127], a[244:247]
    s_waitcnt vmcnt(28) lgkmcnt(0)
    s_barrier
    v_exp_f32 v151, v47
    v_mfma_f32_16x16x32_bf16 a[240:243], v[204:207], a[124:127], a[240:243]
    buffer_load_dwordx4 a[124:127], v247, s[8:11], s43 offen offset:1024 sc1
    s_add_u32 s43, s43, 131072
    s_add_u32 s44, s44, 65536
    v_add_u32 v220, s97, v251
    s_bitcmp1_b32 320, s96
    s_cbranch_scc0 L_cb_loop
    s_cmp_eq_u32 s96, 6
    s_cbranch_scc1 L_cb_sw
    v_mfma_f32_32x32x16_bf16 v[32:47], v[160:163], v[8:11], v[64:79]
    v_exp_f32 v120, v16
    v_exp_f32 v121, v17
    v_exp_f32 v122, v18
    v_mfma_f32_32x32x16_bf16 v[32:47], v[164:167], v[12:15], v[32:47]
    v_exp_f32 v123, v19
    v_exp_f32 v124, v20
    v_exp_f32 v125, v21
    v_smfmac_f32_32x32x32_bf16 v[96:111], v[172:175], v[144:151], v221
    v_exp_f32 v126, v22
    v_exp_f32 v127, v23
    v_exp_f32 v128, v24
    v_smfmac_f32_16x16x64_bf16 v[116:119], v[184:187], v[144:151], v221
    v_exp_f32 v129, v25
    v_exp_f32 v130, v26
    v_smfmac_f32_32x32x32_bf16 v[80:95], v[176:179], v[120:127], v221
    v_exp_f32 v131, v27
    v_exp_f32 v132, v28
    v_exp_f32 v133, v29
    v_smfmac_f32_16x16x64_bf16 v[112:115], v[184:187], v[120:127], v221
    v_exp_f32 v134, v30
    v_exp_f32 v135, v31
    v_exp_f32 v136, v32
    v_exp_f32 v137, v33
    v_exp_f32 v138, v34
    v_exp_f32 v139, v35
    v_exp_f32 v140, v36
    v_exp_f32 v141, v37
    v_smfmac_f32_32x32x32_bf16 v[80:95], v[180:183], v[128:135], v221
    v_exp_f32 v142, v38
    v_exp_f32 v143, v39
    v_exp_f32 v144, v40
    v_smfmac_f32_16x16x64_bf16 v[112:115], v[184:187], v[128:135], v221
    v_exp_f32 v145, v41
    v_exp_f32 v146, v42
    v_smfmac_f32_32x32x32_bf16 v[96:111], v[176:179], v[136:143], v221
    v_exp_f32 v147, v43
    v_exp_f32 v148, v44
    v_exp_f32 v149, v45
    v_smfmac_f32_16x16x64_bf16 v[116:119], v[184:187], v[136:143], v221
    v_exp_f32 v150, v46
    v_exp_f32 v151, v47
    s_nop 1
    v_smfmac_f32_32x32x32_bf16 v[96:111], v[180:183], v[144:151], v221
    v_smfmac_f32_16x16x64_bf16 v[116:119], v[184:187], v[144:151], v221
    v_bfe_u32 v234, v250, 4, 1
    v_lshlrev_b32 v234, 10, v234
    v_lshrrev_b32 v235, 5, v250
    v_lshl_add_u32 v234, v235, 8, v234
    v_and_b32 v235, 15, v250
    v_lshl_add_u32 v234, v235, 4, v234
    s_lshr_b32 s52, s46, 1
    s_lshl_b32 s52, s52, 8
    s_add_u32 s52, s52, 4096
    v_and_b32 v235, 31, v250
    v_lshl_add_u32 v230, v235, 3, s52
    s_add_u32 s99, s99, 12582912
    s_mov_b32 s52, 0x53800000
    v_pk_mul_f32 v[232:233], v[80:81], 0 op_sel_hi:[1,0]
    v_pk_fma_f32 v[232:233], v[82:83], 0, v[232:233] op_sel_hi:[1,0,1]
    v_pk_fma_f32 v[232:233], v[84:85], 0, v[232:233] op_sel_hi:[1,0,1]
    v_pk_fma_f32 v[232:233], v[86:87], 0, v[232:233] op_sel_hi:[1,0,1]
    v_pk_fma_f32 v[232:233], v[88:89], 0, v[232:233] op_sel_hi:[1,0,1]
    v_pk_fma_f32 v[232:233], v[90:91], 0, v[232:233] op_sel_hi:[1,0,1]
    v_pk_fma_f32 v[232:233], v[92:93], 0, v[232:233] op_sel_hi:[1,0,1]
    v_pk_fma_f32 v[232:233], v[94:95], 0, v[232:233] op_sel_hi:[1,0,1]
    v_pk_fma_f32 v[232:233], v[96:97], 0, v[232:233] op_sel_hi:[1,0,1]
    v_pk_fma_f32 v[232:233], v[98:99], 0, v[232:233] op_sel_hi:[1,0,1]
    v_pk_fma_f32 v[232:233], v[100:101], 0, v[232:233] op_sel_hi:[1,0,1]
    v_pk_fma_f32 v[232:233], v[102:103], 0, v[232:233] op_sel_hi:[1,0,1]
    v_pk_fma_f32 v[232:233], v[104:105], 0, v[232:233] op_sel_hi:[1,0,1]
    v_pk_fma_f32 v[232:233], v[106:107], 0, v[232:233] op_sel_hi:[1,0,1]
    v_pk_fma_f32 v[232:233], v[108:109], 0, v[232:233] op_sel_hi:[1,0,1]
    v_pk_fma_f32 v[232:233], v[110:111], 0, v[232:233] op_sel_hi:[1,0,1]
    v_add_f32 v232, v232, v233
    v_add_f32 v233, v112, v116
    v_add_f32 v232, v232, v233
    v_cmp_ngt_f32 vcc, s52, v232
    s_nop 1
    s_cbranch_vccnz L_at_slow
L_at_fin:
    v_rcp_f32 v232, v112
    s_nop 0
    v_mul_f32 v232, v232, v244
    v_pk_mul_f32 v[80:81], v[80:81], v[232:233] op_sel_hi:[1,0]
    v_pk_mul_f32 v[82:83], v[82:83], v[232:233] op_sel_hi:[1,0]
    v_pk_mul_f32 v[84:85], v[84:85], v[232:233] op_sel_hi:[1,0]
    v_pk_mul_f32 v[86:87], v[86:87], v[232:233] op_sel_hi:[1,0]
    v_pk_mul_f32 v[88:89], v[88:89], v[232:233] op_sel_hi:[1,0]
    v_pk_mul_f32 v[90:91], v[90:91], v[232:233] op_sel_hi:[1,0]
    v_pk_mul_f32 v[92:93], v[92:93], v[232:233] op_sel_hi:[1,0]
    v_pk_mul_f32 v[94:95], v[94:95], v[232:233] op_sel_hi:[1,0]
    v_cvt_pk_bf16_f32 v120, v80, v81
    v_cvt_pk_bf16_f32 v121, v82, v83
    v_cvt_pk_bf16_f32 v122, v88, v89
    v_cvt_pk_bf16_f32 v123, v90, v91
    buffer_store_dwordx4 v[120:123], v234, s[8:11], s99 offen offset:0 sc1
    v_cvt_pk_bf16_f32 v124, v84, v85
    v_cvt_pk_bf16_f32 v125, v86, v87
    v_cvt_pk_bf16_f32 v126, v92, v93
    v_cvt_pk_bf16_f32 v127, v94, v95
    buffer_store_dwordx4 v[124:127], v234, s[8:11], s99 offen offset:512 sc1
    v_rcp_f32 v232, v116
    s_nop 0
    v_mul_f32 v232, v232, v245
    v_pk_mul_f32 v[96:97], v[96:97], v[232:233] op_sel_hi:[1,0]
    v_pk_mul_f32 v[98:99], v[98:99], v[232:233] op_sel_hi:[1,0]
    v_pk_mul_f32 v[100:101], v[100:101], v[232:233] op_sel_hi:[1,0]
    v_pk_mul_f32 v[102:103], v[102:103], v[232:233] op_sel_hi:[1,0]
    v_pk_mul_f32 v[104:105], v[104:105], v[232:233] op_sel_hi:[1,0]
    v_pk_mul_f32 v[106:107], v[106:107], v[232:233] op_sel_hi:[1,0]
    v_pk_mul_f32 v[108:109], v[108:109], v[232:233] op_sel_hi:[1,0]
    v_pk_mul_f32 v[110:111], v[110:111], v[232:233] op_sel_hi:[1,0]
    v_cvt_pk_bf16_f32 v136, v96, v97
    v_cvt_pk_bf16_f32 v137, v98, v99
    v_cvt_pk_bf16_f32 v138, v104, v105
    v_cvt_pk_bf16_f32 v139, v106, v107
    buffer_store_dwordx4 v[136:139], v234, s[8:11], s99 offen offset:2048 sc1
    v_cvt_pk_bf16_f32 v140, v100, v101
    v_cvt_pk_bf16_f32 v141, v102, v103
    v_cvt_pk_bf16_f32 v142, v108, v109
    v_cvt_pk_bf16_f32 v143, v110, v111
    buffer_store_dwordx4 v[140:143], v234, s[8:11], s99 offen offset:2560 sc1
    s_waitcnt lgkmcnt(0)
    v_mfma_f32_16x16x32_bf16 a[128:131], v[188:191], a[0:3], a[128:131]
    s_add_u32 m0, s45, 0
    v_mfma_f32_16x16x32_bf16 a[132:135], v[192:195], a[0:3], a[132:135]
    buffer_load_dwordx4 v224, s[12:15], s44 offen offset:0 lds
    s_sub_u32 s56, s95, s45
    v_mfma_f32_16x16x32_bf16 a[136:139], v[196:199], a[0:3], a[136:139]
    buffer_load_dwordx4 v225, s[12:15], s44 offen offset:1024 lds
    v_add_u32 v220, s56, v228
    v_mfma_f32_16x16x32_bf16 a[140:143], v[200:203], a[0:3], a[140:143]
    buffer_load_dwordx4 v226, s[12:15], s44 offen offset:2048 lds
    v_add_u32 v221, s56, v229
    v_mfma_f32_16x16x32_bf16 a[156:159], v[200:203], a[4:7], a[156:159]
    buffer_load_dwordx4 v227, s[12:15], s44 offen offset:3072 lds
    v_add_u32 v236, 0x10000, v220
    v_mfma_f32_16x16x32_bf16 a[152:155], v[196:199], a[4:7], a[152:155]
    s_add_u32 s44, s44, 65536
    v_add_u32 v237, 0x10000, v221
    v_mfma_f32_16x16x32_bf16 a[148:151], v[192:195], a[4:7], a[148:151]
    buffer_load_dwordx4 a[0:3], v222, s[8:11], s43 offen offset:0 sc1
    v_mfma_f32_16x16x32_bf16 a[144:147], v[188:191], a[4:7], a[144:147]
    s_add_u32 s20, s34, 0
    s_addc_u32 s21, s35, 0
    buffer_load_dwordx4 a[4:7], v222, s[8:11], s43 offen offset:1024 sc1
    v_mfma_f32_16x16x32_bf16 a[160:163], v[188:191], a[8:11], a[160:163]
    s_mov_b32 s22, 4194304
    ds_read_b64_tr_b16 v[204:205], v228 offset:4096
    s_mov_b32 s23, 0x00020000
    v_mfma_f32_16x16x32_bf16 a[164:167], v[192:195], a[8:11], a[164:167]
    s_add_u32 s24, s36, 0
    s_addc_u32 s25, s37, 0
    v_mfma_f32_16x16x32_bf16 a[168:171], v[196:199], a[8:11], a[168:171]
    ds_read_b64_tr_b16 v[206:207], v228 offset:6144
    s_mov_b32 s26, 4194304
    v_mfma_f32_16x16x32_bf16 a[172:175], v[200:203], a[8:11], a[172:175]
    buffer_load_dwordx4 a[8:11], v223, s[8:11], s43 offen offset:0 sc1
    s_mov_b32 s27, 0x00020000
    v_mfma_f32_16x16x32_bf16 a[188:191], v[200:203], a[12:15], a[188:191]
    ds_read_b64_tr_b16 v[208:209], v229 offset:4096
    s_mov_b32 s58, 32768
    v_mfma_f32_16x16x32_bf16 a[184:187], v[196:199], a[12:15], a[184:187]
    s_lshl_b32 s56, s46, 7
    v_mfma_f32_16x16x32_bf16 a[180:183], v[192:195], a[12:15], a[180:183]
    ds_read_b64_tr_b16 v[210:211], v229 offset:6144
    s_lshl_b32 s57, s40, 5
    v_mfma_f32_16x16x32_bf16 a[176:179], v[188:191], a[12:15], a[176:179]
    buffer_load_dwordx4 a[12:15], v223, s[8:11], s43 offen offset:1024 sc1
    s_add_u32 s56, s56, s57
    v_mfma_f32_16x16x32_bf16 a[192:195], v[188:191], a[16:19], a[192:195]
    ds_read_b64_tr_b16 v[212:213], v228 offset:4608
    s_lshl_b32 s49, s56, 2
    v_mfma_f32_16x16x32_bf16 a[196:199], v[192:195], a[16:19], a[196:199]
    s_add_u32 s49, s49, 24576
    v_mfma_f32_16x16x32_bf16 a[200:203], v[196:199], a[16:19], a[200:203]
    ds_read_b64_tr_b16 v[214:215], v228 offset:6656
    s_lshl_b32 s56, s56, 11
    v_mfma_f32_16x16x32_bf16 a[204:207], v[200:203], a[16:19], a[204:207]
    buffer_load_dwordx4 a[16:19], v246, s[8:11], s43 offen offset:0 sc1
    s_lshl_b32 s57, s48, 7
    v_mfma_f32_16x16x32_bf16 a[220:223], v[200:203], a[20:23], a[220:223]
    ds_read_b64_tr_b16 v[216:217], v229 offset:4608
    s_add_u32 s56, s56, s57
    v_mfma_f32_16x16x32_bf16 a[216:219], v[196:199], a[20:23], a[216:219]
    v_mfma_f32_16x16x32_bf16 a[212:215], v[192:195], a[20:23], a[212:215]
    ds_read_b64_tr_b16 v[218:219], v229 offset:6656
    v_mfma_f32_16x16x32_bf16 a[208:211], v[188:191], a[20:23], a[208:211]
    buffer_load_dwordx4 a[20:23], v246, s[8:11], s43 offen offset:1024 sc1
    v_mfma_f32_16x16x32_bf16 a[224:227], v[188:191], a[24:27], a[224:227]
    v_mfma_f32_16x16x32_bf16 a[228:231], v[192:195], a[24:27], a[228:231]
    v_mfma_f32_16x16x32_bf16 a[232:235], v[196:199], a[24:27], a[232:235]
    v_mfma_f32_16x16x32_bf16 a[236:239], v[200:203], a[24:27], a[236:239]
    buffer_load_dwordx4 a[24:27], v247, s[8:11], s43 offen offset:0 sc1
    v_mfma_f32_16x16x32_bf16 a[252:255], v[200:203], a[28:31], a[252:255]
    v_mfma_f32_16x16x32_bf16 a[248:251], v[196:199], a[28:31], a[248:251]
    v_mfma_f32_16x16x32_bf16 a[244:247], v[192:195], a[28:31], a[244:247]
    v_mfma_f32_16x16x32_bf16 a[240:243], v[188:191], a[28:31], a[240:243]
    buffer_load_dwordx4 a[28:31], v247, s[8:11], s43 offen offset:1024 sc1
    s_add_u32 s43, s43, 131072
    s_waitcnt vmcnt(12)
    s_barrier
    s_cmp_lg_u32 s40, 0
    s_cbranch_scc1 L_pb41
    v_mov_b32 v184, s6
    v_mov_b32 v185, s7
    buffer_store_dwordx2 v[184:185], off, s[8:11], s93 sc1
L_pb41:
    s_waitcnt vmcnt(16) lgkmcnt(0)
    v_mfma_f32_16x16x32_bf16 a[128:131], v[204:207], a[32:35], a[128:131]
    s_add_u32 m0, s45, 4096
    v_mfma_f32_16x16x32_bf16 a[132:135], v[208:211], a[32:35], a[132:135]
    buffer_load_dwordx4 v224, s[12:15], s44 offen offset:0 lds
    v_and_b32 v238, 15, v250
    v_mfma_f32_16x16x32_bf16 a[136:139], v[212:215], a[32:35], a[136:139]
    buffer_load_dwordx4 v225, s[12:15], s44 offen offset:1024 lds
    v_lshl_add_u32 v231, v238, 11, s56
    v_mfma_f32_16x16x32_bf16 a[140:143], v[216:219], a[32:35], a[140:143]
    buffer_load_dwordx4 v226, s[12:15], s44 offen offset:2048 lds
    v_lshlrev_b32 v233, 2, v238
    v_mfma_f32_16x16x32_bf16 a[156:159], v[216:219], a[36:39], a[156:159]
    buffer_load_dwordx4 v227, s[12:15], s44 offen offset:3072 lds
    v_bfe_u32 v238, v250, 4, 1
    v_mfma_f32_16x16x32_bf16 a[152:155], v[212:215], a[36:39], a[152:155]
    s_add_u32 s44, s44, 65536
    v_lshl_add_u32 v239, v238, 5, v231
    v_mfma_f32_16x16x32_bf16 a[148:151], v[208:211], a[36:39], a[148:151]
    buffer_load_dwordx4 a[32:35], v222, s[8:11], s43 offen offset:0 sc1
    v_lshrrev_b32 v238, 5, v250
    v_mfma_f32_16x16x32_bf16 a[144:147], v[204:207], a[36:39], a[144:147]
    buffer_load_dwordx4 a[36:39], v222, s[8:11], s43 offen offset:1024 sc1
    v_lshl_add_u32 v239, v238, 4, v239
    v_mfma_f32_16x16x32_bf16 a[160:163], v[204:207], a[40:43], a[160:163]
    ds_read_b64_tr_b16 v[188:189], v228 offset:8192
    v_add_u32 v238, s95, v251
    v_mfma_f32_16x16x32_bf16 a[164:167], v[208:211], a[40:43], a[164:167]
    v_mfma_f32_16x16x32_bf16 a[168:171], v[212:215], a[40:43], a[168:171]
    ds_read_b64_tr_b16 v[190:191], v228 offset:10240
    v_mfma_f32_16x16x32_bf16 a[172:175], v[216:219], a[40:43], a[172:175]
    buffer_load_dwordx4 a[40:43], v223, s[8:11], s43 offen offset:0 sc1
    v_mfma_f32_16x16x32_bf16 a[188:191], v[216:219], a[44:47], a[188:191]
    ds_read_b64_tr_b16 v[192:193], v229 offset:8192
    v_mfma_f32_16x16x32_bf16 a[184:187], v[212:215], a[44:47], a[184:187]
    v_mfma_f32_16x16x32_bf16 a[180:183], v[208:211], a[44:47], a[180:183]
    ds_read_b64_tr_b16 v[194:195], v229 offset:10240
    v_mfma_f32_16x16x32_bf16 a[176:179], v[204:207], a[44:47], a[176:179]
    buffer_load_dwordx4 a[44:47], v223, s[8:11], s43 offen offset:1024 sc1
    v_mfma_f32_16x16x32_bf16 a[192:195], v[204:207], a[48:51], a[192:195]
    ds_read_b64_tr_b16 v[196:197], v228 offset:8704
    v_mfma_f32_16x16x32_bf16 a[196:199], v[208:211], a[48:51], a[196:199]
    v_mfma_f32_16x16x32_bf16 a[200:203], v[212:215], a[48:51], a[200:203]
    ds_read_b64_tr_b16 v[198:199], v228 offset:10752
    v_mfma_f32_16x16x32_bf16 a[204:207], v[216:219], a[48:51], a[204:207]
    buffer_load_dwordx4 a[48:51], v246, s[8:11], s43 offen offset:0 sc1
    v_mfma_f32_16x16x32_bf16 a[220:223], v[216:219], a[52:55], a[220:223]
    ds_read_b64_tr_b16 v[200:201], v229 offset:8704
    v_mfma_f32_16x16x32_bf16 a[216:219], v[212:215], a[52:55], a[216:219]
    v_mfma_f32_16x16x32_bf16 a[212:215], v[208:211], a[52:55], a[212:215]
    ds_read_b64_tr_b16 v[202:203], v229 offset:10752
    v_mfma_f32_16x16x32_bf16 a[208:211], v[204:207], a[52:55], a[208:211]
    buffer_load_dwordx4 a[52:55], v246, s[8:11], s43 offen offset:1024 sc1
    v_mfma_f32_16x16x32_bf16 a[224:227], v[204:207], a[56:59], a[224:227]
    v_mfma_f32_16x16x32_bf16 a[228:231], v[208:211], a[56:59], a[228:231]
    v_mfma_f32_16x16x32_bf16 a[232:235], v[212:215], a[56:59], a[232:235]
    v_mfma_f32_16x16x32_bf16 a[236:239], v[216:219], a[56:59], a[236:239]
    buffer_load_dwordx4 a[56:59], v247, s[8:11], s43 offen offset:0 sc1
    v_mfma_f32_16x16x32_bf16 a[252:255], v[216:219], a[60:63], a[252:255]
    v_mfma_f32_16x16x32_bf16 a[248:251], v[212:215], a[60:63], a[248:251]
    v_mfma_f32_16x16x32_bf16 a[244:247], v[208:211], a[60:63], a[244:247]
    v_mfma_f32_16x16x32_bf16 a[240:243], v[204:207], a[60:63], a[240:243]
    buffer_load_dwordx4 a[60:63], v247, s[8:11], s43 offen offset:1024 sc1
    s_add_u32 s43, s43, 131072
    s_waitcnt vmcnt(28) lgkmcnt(0)
    v_mfma_f32_16x16x32_bf16 a[128:131], v[188:191], a[64:67], a[128:131]
    s_add_u32 m0, s45, 8192
    v_mfma_f32_16x16x32_bf16 a[132:135], v[192:195], a[64:67], a[132:135]
    buffer_load_dwordx4 v224, s[12:15], s44 offen offset:0 lds
    v_mfma_f32_16x16x32_bf16 a[136:139], v[196:199], a[64:67], a[136:139]
    buffer_load_dwordx4 v225, s[12:15], s44 offen offset:1024 lds
    v_mfma_f32_16x16x32_bf16 a[140:143], v[200:203], a[64:67], a[140:143]
    buffer_load_dwordx4 v226, s[12:15], s44 offen offset:2048 lds
    v_mfma_f32_16x16x32_bf16 a[156:159], v[200:203], a[68:71], a[156:159]
    buffer_load_dwordx4 v227, s[12:15], s44 offen offset:3072 lds
    v_mfma_f32_16x16x32_bf16 a[152:155], v[196:199], a[68:71], a[152:155]
    s_add_u32 s44, s44, 65536
    v_mfma_f32_16x16x32_bf16 a[148:151], v[192:195], a[68:71], a[148:151]
    buffer_load_dwordx4 a[64:67], v222, s[8:11], s43 offen offset:0 sc1
    v_mfma_f32_16x16x32_bf16 a[144:147], v[188:191], a[68:71], a[144:147]
    buffer_load_dwordx4 a[68:71], v222, s[8:11], s43 offen offset:1024 sc1
    v_mfma_f32_16x16x32_bf16 a[160:163], v[188:191], a[72:75], a[160:163]
    ds_read_b64_tr_b16 v[204:205], v228 offset:12288
    v_mfma_f32_16x16x32_bf16 a[164:167], v[192:195], a[72:75], a[164:167]
    v_mfma_f32_16x16x32_bf16 a[168:171], v[196:199], a[72:75], a[168:171]
    ds_read_b64_tr_b16 v[206:207], v228 offset:14336
    v_mfma_f32_16x16x32_bf16 a[172:175], v[200:203], a[72:75], a[172:175]
    buffer_load_dwordx4 a[72:75], v223, s[8:11], s43 offen offset:0 sc1
    v_mfma_f32_16x16x32_bf16 a[188:191], v[200:203], a[76:79], a[188:191]
    ds_read_b64_tr_b16 v[208:209], v229 offset:12288
    v_mfma_f32_16x16x32_bf16 a[184:187], v[196:199], a[76:79], a[184:187]
    v_mfma_f32_16x16x32_bf16 a[180:183], v[192:195], a[76:79], a[180:183]
    ds_read_b64_tr_b16 v[210:211], v229 offset:14336
    v_mfma_f32_16x16x32_bf16 a[176:179], v[188:191], a[76:79], a[176:179]
    buffer_load_dwordx4 a[76:79], v223, s[8:11], s43 offen offset:1024 sc1
    v_mfma_f32_16x16x32_bf16 a[192:195], v[188:191], a[80:83], a[192:195]
    ds_read_b64_tr_b16 v[212:213], v228 offset:12800
    v_mfma_f32_16x16x32_bf16 a[196:199], v[192:195], a[80:83], a[196:199]
    v_mfma_f32_16x16x32_bf16 a[200:203], v[196:199], a[80:83], a[200:203]
    ds_read_b64_tr_b16 v[214:215], v228 offset:14848
    v_mfma_f32_16x16x32_bf16 a[204:207], v[200:203], a[80:83], a[204:207]
    buffer_load_dwordx4 a[80:83], v246, s[8:11], s43 offen offset:0 sc1
    v_mfma_f32_16x16x32_bf16 a[220:223], v[200:203], a[84:87], a[220:223]
    ds_read_b64_tr_b16 v[216:217], v229 offset:12800
    v_mfma_f32_16x16x32_bf16 a[216:219], v[196:199], a[84:87], a[216:219]
    v_mfma_f32_16x16x32_bf16 a[212:215], v[192:195], a[84:87], a[212:215]
    ds_read_b64_tr_b16 v[218:219], v229 offset:14848
    v_mfma_f32_16x16x32_bf16 a[208:211], v[188:191], a[84:87], a[208:211]
    buffer_load_dwordx4 a[84:87], v246, s[8:11], s43 offen offset:1024 sc1
    v_mfma_f32_16x16x32_bf16 a[224:227], v[188:191], a[88:91], a[224:227]
    v_mfma_f32_16x16x32_bf16 a[228:231], v[192:195], a[88:91], a[228:231]
    v_mfma_f32_16x16x32_bf16 a[232:235], v[196:199], a[88:91], a[232:235]
    v_mfma_f32_16x16x32_bf16 a[236:239], v[200:203], a[88:91], a[236:239]
    buffer_load_dwordx4 a[88:91], v247, s[8:11], s43 offen offset:0 sc1
    v_mfma_f32_16x16x32_bf16 a[252:255], v[200:203], a[92:95], a[252:255]
    v_mfma_f32_16x16x32_bf16 a[248:251], v[196:199], a[92:95], a[248:251]
    v_mfma_f32_16x16x32_bf16 a[244:247], v[192:195], a[92:95], a[244:247]
    v_mfma_f32_16x16x32_bf16 a[240:243], v[188:191], a[92:95], a[240:243]
    buffer_load_dwordx4 a[92:95], v247, s[8:11], s43 offen offset:1024 sc1
    s_add_u32 s43, s43, 131072
    s_waitcnt vmcnt(32) lgkmcnt(0)
    v_mfma_f32_16x16x32_bf16 a[128:131], v[204:207], a[96:99], a[128:131]
    s_add_u32 m0, s45, 12288
    v_mfma_f32_16x16x32_bf16 a[132:135], v[208:211], a[96:99], a[132:135]
    buffer_load_dwordx4 v224, s[12:15], s44 offen offset:0 lds
    v_mfma_f32_16x16x32_bf16 a[136:139], v[212:215], a[96:99], a[136:139]
    buffer_load_dwordx4 v225, s[12:15], s44 offen offset:1024 lds
    v_mfma_f32_16x16x32_bf16 a[140:143], v[216:219], a[96:99], a[140:143]
    buffer_load_dwordx4 v226, s[12:15], s44 offen offset:2048 lds
    v_mfma_f32_16x16x32_bf16 a[156:159], v[216:219], a[100:103], a[156:159]
    buffer_load_dwordx4 v227, s[12:15], s44 offen offset:3072 lds
    v_mfma_f32_16x16x32_bf16 a[152:155], v[212:215], a[100:103], a[152:155]
    s_add_u32 s44, s44, 65536
    v_mfma_f32_16x16x32_bf16 a[148:151], v[208:211], a[100:103], a[148:151]
    buffer_load_dwordx4 a[96:99], v222, s[8:11], s43 offen offset:0 sc1
    v_mfma_f32_16x16x32_bf16 a[144:147], v[204:207], a[100:103], a[144:147]
    buffer_load_dwordx4 a[100:103], v222, s[8:11], s43 offen offset:1024 sc1
    v_mfma_f32_16x16x32_bf16 a[160:163], v[204:207], a[104:107], a[160:163]
    ds_read_b64_tr_b16 v[188:189], v228 offset:0
    v_mfma_f32_16x16x32_bf16 a[164:167], v[208:211], a[104:107], a[164:167]
    v_mfma_f32_16x16x32_bf16 a[168:171], v[212:215], a[104:107], a[168:171]
    ds_read_b64_tr_b16 v[190:191], v228 offset:2048
    v_mfma_f32_16x16x32_bf16 a[172:175], v[216:219], a[104:107], a[172:175]
    buffer_load_dwordx4 a[104:107], v223, s[8:11], s43 offen offset:0 sc1
    v_mfma_f32_16x16x32_bf16 a[188:191], v[216:219], a[108:111], a[188:191]
    ds_read_b64_tr_b16 v[192:193], v229 offset:0
    v_mfma_f32_16x16x32_bf16 a[184:187], v[212:215], a[108:111], a[184:187]
    v_mfma_f32_16x16x32_bf16 a[180:183], v[208:211], a[108:111], a[180:183]
    ds_read_b64_tr_b16 v[194:195], v229 offset:2048
    v_mfma_f32_16x16x32_bf16 a[176:179], v[204:207], a[108:111], a[176:179]
    buffer_load_dwordx4 a[108:111], v223, s[8:11], s43 offen offset:1024 sc1
    v_mfma_f32_16x16x32_bf16 a[192:195], v[204:207], a[112:115], a[192:195]
    ds_read_b64_tr_b16 v[196:197], v228 offset:512
    v_mfma_f32_16x16x32_bf16 a[196:199], v[208:211], a[112:115], a[196:199]
    v_mfma_f32_16x16x32_bf16 a[200:203], v[212:215], a[112:115], a[200:203]
    ds_read_b64_tr_b16 v[198:199], v228 offset:2560
    v_mfma_f32_16x16x32_bf16 a[204:207], v[216:219], a[112:115], a[204:207]
    buffer_load_dwordx4 a[112:115], v246, s[8:11], s43 offen offset:0 sc1
    v_mfma_f32_16x16x32_bf16 a[220:223], v[216:219], a[116:119], a[220:223]
    ds_read_b64_tr_b16 v[200:201], v229 offset:512
    v_mfma_f32_16x16x32_bf16 a[216:219], v[212:215], a[116:119], a[216:219]
    v_mfma_f32_16x16x32_bf16 a[212:215], v[208:211], a[116:119], a[212:215]
    ds_read_b64_tr_b16 v[202:203], v229 offset:2560
    v_mfma_f32_16x16x32_bf16 a[208:211], v[204:207], a[116:119], a[208:211]
    buffer_load_dwordx4 a[116:119], v246, s[8:11], s43 offen offset:1024 sc1
    v_mfma_f32_16x16x32_bf16 a[224:227], v[204:207], a[120:123], a[224:227]
    v_mfma_f32_16x16x32_bf16 a[228:231], v[208:211], a[120:123], a[228:231]
    v_mfma_f32_16x16x32_bf16 a[232:235], v[212:215], a[120:123], a[232:235]
    v_mfma_f32_16x16x32_bf16 a[236:239], v[216:219], a[120:123], a[236:239]
    buffer_load_dwordx4 a[120:123], v247, s[8:11], s43 offen offset:0 sc1
    v_mfma_f32_16x16x32_bf16 a[252:255], v[216:219], a[124:127], a[252:255]
    v_mfma_f32_16x16x32_bf16 a[248:251], v[212:215], a[124:127], a[248:251]
    v_mfma_f32_16x16x32_bf16 a[244:247], v[208:211], a[124:127], a[244:247]
    v_mfma_f32_16x16x32_bf16 a[240:243], v[204:207], a[124:127], a[240:243]
    buffer_load_dwordx4 a[124:127], v247, s[8:11], s43 offen offset:1024 sc1
    s_add_u32 s43, s43, 131072
    s_waitcnt vmcnt(32) lgkmcnt(0)
    v_mfma_f32_16x16x32_bf16 a[128:131], v[188:191], a[0:3], a[128:131]
    buffer_load_dwordx4 v[112:115], v239, s[20:23], 0 offen offset:0
    ds_read_b64_tr_b16 v[204:205], v228 offset:4096
    v_mfma_f32_16x16x32_bf16 a[132:135], v[192:195], a[0:3], a[132:135]
    buffer_load_dwordx4 v[116:119], v239, s[20:23], 0 offen offset:64
    ds_read_b64_tr_b16 v[206:207], v228 offset:6144
    v_mfma_f32_16x16x32_bf16 a[136:139], v[196:199], a[0:3], a[136:139]
    ds_read_b64_tr_b16 v[208:209], v229 offset:4096
    v_mfma_f32_16x16x32_bf16 a[140:143], v[200:203], a[0:3], a[140:143]
    buffer_load_dwordx4 v[120:123], v239, s[20:23], s58 offen offset:0
    ds_read_b64_tr_b16 v[210:211], v229 offset:6144
    v_mfma_f32_16x16x32_bf16 a[156:159], v[200:203], a[4:7], a[156:159]
    ds_read_b64_tr_b16 v[212:213], v228 offset:4608
    v_mfma_f32_16x16x32_bf16 a[152:155], v[196:199], a[4:7], a[152:155]
    buffer_load_dwordx4 v[124:127], v239, s[20:23], s58 offen offset:64
    ds_read_b64_tr_b16 v[214:215], v228 offset:6656
    v_mfma_f32_16x16x32_bf16 a[148:151], v[192:195], a[4:7], a[148:151]
    ds_read_b64_tr_b16 v[216:217], v229 offset:4608
    v_mfma_f32_16x16x32_bf16 a[144:147], v[188:191], a[4:7], a[144:147]
    buffer_load_dword v244, v233, s[8:11], s49 offen offset:0 sc1
    ds_read_b64_tr_b16 v[218:219], v229 offset:6656
    v_mfma_f32_16x16x32_bf16 a[160:163], v[188:191], a[8:11], a[160:163]
    ds_read_b64_tr_b16 v[0:1], v236 offset:0
    v_mfma_f32_16x16x32_bf16 a[164:167], v[192:195], a[8:11], a[164:167]
    buffer_load_dword v245, v233, s[8:11], s49 offen offset:64 sc1
    ds_read_b64_tr_b16 v[2:3], v236 offset:2048
    v_mfma_f32_16x16x32_bf16 a[168:171], v[196:199], a[8:11], a[168:171]
    ds_read_b64_tr_b16 v[4:5], v237 offset:0
    v_mfma_f32_16x16x32_bf16 a[172:175], v[200:203], a[8:11], a[172:175]
    s_add_u32 m0, s95, 32768
    ds_read_b64_tr_b16 v[6:7], v237 offset:2048
    v_mfma_f32_16x16x32_bf16 a[188:191], v[200:203], a[12:15], a[188:191]
    v_mfma_f32_16x16x32_bf16 a[184:187], v[196:199], a[12:15], a[184:187]
    buffer_load_dwordx4 v224, s[16:19], s94 offen offset:0 lds
    ds_read_b64_tr_b16 v[8:9], v236 offset:512
    v_mfma_f32_16x16x32_bf16 a[180:183], v[192:195], a[12:15], a[180:183]
    ds_read_b64_tr_b16 v[10:11], v236 offset:2560
    v_mfma_f32_16x16x32_bf16 a[176:179], v[188:191], a[12:15], a[176:179]
    buffer_load_dwordx4 v225, s[16:19], s94 offen offset:1024 lds
    ds_read_b64_tr_b16 v[12:13], v237 offset:512
    v_mfma_f32_16x16x32_bf16 a[192:195], v[188:191], a[16:19], a[192:195]
    buffer_load_dwordx2 v[254:255], v230, s[8:11], 0 offen sc1
    ds_read_b64_tr_b16 v[14:15], v237 offset:2560
    v_mfma_f32_16x16x32_bf16 a[196:199], v[192:195], a[16:19], a[196:199]
    ds_read_b64_tr_b16 v[16:17], v236 offset:16384
    v_mfma_f32_16x16x32_bf16 a[200:203], v[196:199], a[16:19], a[200:203]
    buffer_load_dwordx4 v226, s[16:19], s94 offen offset:2048 lds
    ds_read_b64_tr_b16 v[18:19], v236 offset:18432
    v_mfma_f32_16x16x32_bf16 a[204:207], v[200:203], a[16:19], a[204:207]
    ds_read_b64_tr_b16 v[20:21], v237 offset:16384
    v_mfma_f32_16x16x32_bf16 a[220:223], v[200:203], a[20:23], a[220:223]
    buffer_load_dwordx4 v227, s[16:19], s94 offen offset:3072 lds
    ds_read_b64_tr_b16 v[22:23], v237 offset:18432
    v_mfma_f32_16x16x32_bf16 a[216:219], v[196:199], a[20:23], a[216:219]
    ds_read_b64_tr_b16 v[24:25], v236 offset:16896
    v_mfma_f32_16x16x32_bf16 a[212:215], v[192:195], a[20:23], a[212:215]
    s_add_u32 s94, s94, 65536
    ds_read_b64_tr_b16 v[26:27], v236 offset:18944
    v_mfma_f32_16x16x32_bf16 a[208:211], v[188:191], a[20:23], a[208:211]
    ds_read_b64_tr_b16 v[28:29], v237 offset:16896
    v_mfma_f32_16x16x32_bf16 a[224:227], v[188:191], a[24:27], a[224:227]
    s_add_u32 m0, s95, 49152
    ds_read_b64_tr_b16 v[30:31], v237 offset:18944
    v_mfma_f32_16x16x32_bf16 a[228:231], v[192:195], a[24:27], a[228:231]
    v_mfma_f32_16x16x32_bf16 a[232:235], v[196:199], a[24:27], a[232:235]
    buffer_load_dwordx4 v224, s[16:19], s94 offen offset:0 lds
    v_mfma_f32_16x16x32_bf16 a[236:239], v[200:203], a[24:27], a[236:239]
    v_mfma_f32_16x16x32_bf16 a[252:255], v[200:203], a[28:31], a[252:255]
    buffer_load_dwordx4 v225, s[16:19], s94 offen offset:1024 lds
    v_mfma_f32_16x16x32_bf16 a[248:251], v[196:199], a[28:31], a[248:251]
    v_mfma_f32_16x16x32_bf16 a[244:247], v[192:195], a[28:31], a[244:247]
    v_mfma_f32_16x16x32_bf16 a[240:243], v[188:191], a[28:31], a[240:243]
    s_waitcnt vmcnt(33) lgkmcnt(0)
    v_mfma_f32_16x16x32_bf16 a[128:131], v[204:207], a[32:35], a[128:131]
    buffer_load_dwordx4 v226, s[16:19], s94 offen offset:2048 lds
    ds_read_b64_tr_b16 v[188:189], v228 offset:8192
    v_mfma_f32_16x16x32_bf16 a[132:135], v[208:211], a[32:35], a[132:135]
    ds_read_b64_tr_b16 v[190:191], v228 offset:10240
    s_sub_u32 s56, s40, 1
    v_mfma_f32_16x16x32_bf16 a[136:139], v[212:215], a[32:35], a[136:139]
    buffer_load_dwordx4 v227, s[16:19], s94 offen offset:3072 lds
    ds_read_b64_tr_b16 v[192:193], v229 offset:8192
    v_mfma_f32_16x16x32_bf16 a[140:143], v[216:219], a[32:35], a[140:143]
    s_and_b32 s56, s56, 3
    ds_read_b64_tr_b16 v[194:195], v229 offset:10240
    s_lshl_b32 s56, s56, 12
    v_mfma_f32_16x16x32_bf16 a[156:159], v[216:219], a[36:39], a[156:159]
    s_add_u32 s94, s94, 65536
    ds_read_b64_tr_b16 v[196:197], v228 offset:8704
    s_add_u32 s56, s56, 0
    v_mfma_f32_16x16x32_bf16 a[152:155], v[212:215], a[36:39], a[152:155]
    ds_read_b64_tr_b16 v[198:199], v228 offset:10752
    v_add_u32 v233, s56, v251
    v_mfma_f32_16x16x32_bf16 a[148:151], v[208:211], a[36:39], a[148:151]
    s_add_u32 m0, s45, 0
    ds_read_b64_tr_b16 v[200:201], v229 offset:8704
    s_sub_u32 s56, s40, 2
    v_mfma_f32_16x16x32_bf16 a[144:147], v[204:207], a[36:39], a[144:147]
    ds_read_b64_tr_b16 v[202:203], v229 offset:10752
    s_and_b32 s56, s56, 3
    v_mfma_f32_16x16x32_bf16 a[160:163], v[204:207], a[40:43], a[160:163]
    buffer_load_dwordx4 v224, s[16:19], s94 offen offset:0 lds
    ds_read_b64_tr_b16 v[32:33], v220 offset:0
    v_mfma_f32_16x16x32_bf16 a[164:167], v[208:211], a[40:43], a[164:167]
    s_lshl_b32 s56, s56, 12
    ds_read_b64_tr_b16 v[34:35], v220 offset:2048
    s_add_u32 s56, s56, 32768
    v_mfma_f32_16x16x32_bf16 a[168:171], v[212:215], a[40:43], a[168:171]
    buffer_load_dwordx4 v225, s[16:19], s94 offen offset:1024 lds
    ds_read_b64_tr_b16 v[36:37], v221 offset:0
    v_mfma_f32_16x16x32_bf16 a[172:175], v[216:219], a[40:43], a[172:175]
    v_add_u32 v234, s56, v251
    ds_read_b64_tr_b16 v[38:39], v221 offset:2048
    v_mfma_f32_16x16x32_bf16 a[188:191], v[216:219], a[44:47], a[188:191]
    s_sub_u32 s56, s40, 3
    buffer_load_dwordx4 v226, s[16:19], s94 offen offset:2048 lds
    s_and_b32 s56, s56, 3
    v_mfma_f32_16x16x32_bf16 a[184:187], v[212:215], a[44:47], a[184:187]
    ds_read_b64_tr_b16 v[40:41], v220 offset:512
    s_lshl_b32 s56, s56, 12
    v_mfma_f32_16x16x32_bf16 a[180:183], v[208:211], a[44:47], a[180:183]
    buffer_load_dwordx4 v227, s[16:19], s94 offen offset:3072 lds
    ds_read_b64_tr_b16 v[42:43], v220 offset:2560
    v_mfma_f32_16x16x32_bf16 a[176:179], v[204:207], a[44:47], a[176:179]
    s_add_u32 s56, s56, 65536
    ds_read_b64_tr_b16 v[44:45], v221 offset:512
    v_add_u32 v235, s56, v251
    v_mfma_f32_16x16x32_bf16 a[192:195], v[204:207], a[48:51], a[192:195]
    s_add_u32 s94, s94, 65536
    ds_read_b64_tr_b16 v[46:47], v221 offset:2560
    s_lshl_b32 s56, s40, 20
    v_mfma_f32_16x16x32_bf16 a[196:199], v[208:211], a[48:51], a[196:199]
    ds_read_b64_tr_b16 v[48:49], v220 offset:16384
    s_add_u32 s52, s56, 16777216
    v_mfma_f32_16x16x32_bf16 a[200:203], v[212:215], a[48:51], a[200:203]
    s_add_u32 m0, s45, 4096
    ds_read_b64_tr_b16 v[50:51], v220 offset:18432
    s_add_u32 s53, s56, 16908288
    v_mfma_f32_16x16x32_bf16 a[204:207], v[216:219], a[48:51], a[204:207]
    ds_read_b64_tr_b16 v[52:53], v221 offset:16384
    s_add_u32 s54, s56, 17039360
    v_mfma_f32_16x16x32_bf16 a[220:223], v[216:219], a[52:55], a[220:223]
    buffer_load_dwordx4 v224, s[16:19], s94 offen offset:0 lds
    ds_read_b64_tr_b16 v[54:55], v221 offset:18432
    v_mfma_f32_16x16x32_bf16 a[216:219], v[212:215], a[52:55], a[216:219]
    s_add_u32 s55, s56, 17170432
    ds_read_b64_tr_b16 v[56:57], v220 offset:16896
    s_add_u32 s88, s56, 17301504
    v_mfma_f32_16x16x32_bf16 a[212:215], v[208:211], a[52:55], a[212:215]
    buffer_load_dwordx4 v225, s[16:19], s94 offen offset:1024 lds
    ds_read_b64_tr_b16 v[58:59], v220 offset:18944
    v_mfma_f32_16x16x32_bf16 a[208:211], v[204:207], a[52:55], a[208:211]
    s_add_u32 s89, s56, 17432576
    ds_read_b64_tr_b16 v[60:61], v221 offset:16896
    s_add_u32 s90, s56, 17563648
    v_mfma_f32_16x16x32_bf16 a[224:227], v[204:207], a[56:59], a[224:227]
    buffer_load_dwordx4 v226, s[16:19], s94 offen offset:2048 lds
    ds_read_b64_tr_b16 v[62:63], v221 offset:18944
    v_mfma_f32_16x16x32_bf16 a[228:231], v[208:211], a[56:59], a[228:231]
    s_add_u32 s91, s56, 17694720
    v_mfma_f32_16x16x32_bf16 a[232:235], v[212:215], a[56:59], a[232:235]
    buffer_load_dwordx4 v227, s[16:19], s94 offen offset:3072 lds
    v_mfma_f32_16x16x32_bf16 a[236:239], v[216:219], a[56:59], a[236:239]
    v_mfma_f32_16x16x32_bf16 a[252:255], v[216:219], a[60:63], a[252:255]
    s_add_u32 s94, s94, 65536
    v_mfma_f32_16x16x32_bf16 a[248:251], v[212:215], a[60:63], a[248:251]
    v_mfma_f32_16x16x32_bf16 a[244:247], v[208:211], a[60:63], a[244:247]
    v_mfma_f32_16x16x32_bf16 a[240:243], v[204:207], a[60:63], a[240:243]
    s_waitcnt vmcnt(14)
    s_mov_b32 s57, 0
    s_branch L_pc42
L_pl42:
    buffer_load_dwordx2 v[254:255], v230, s[8:11], 0 offen sc1
    s_waitcnt vmcnt(0)
L_pc42:
    v_cmp_ne_u64 vcc, s[6:7], v[254:255]
    s_add_u32 s57, s57, 1
    s_nop 0
    s_cbranch_vccz L_pd42
    s_sleep 6
    s_cmp_lt_u32 s57, 0x40000
    s_cbranch_scc1 L_pl42
L_pd42:
    s_waitcnt vmcnt(8) lgkmcnt(0)
    v_mfma_f32_16x16x32_bf16 a[128:131], v[188:191], a[64:67], a[128:131]
    buffer_load_dwordx4 a[0:3], v222, s[8:11], s52 offen offset:0 sc1
    ds_read_b64_tr_b16 v[204:205], v228 offset:12288
    v_mfma_f32_16x16x32_bf16 a[132:135], v[192:195], a[64:67], a[132:135]
    ds_read_b64_tr_b16 v[206:207], v228 offset:14336
    v_mfma_f32_16x16x32_bf16 a[136:139], v[196:199], a[64:67], a[136:139]
    buffer_load_dwordx4 a[4:7], v222, s[8:11], s53 offen offset:0 sc1
    ds_read_b64_tr_b16 v[208:209], v229 offset:12288
    v_mfma_f32_16x16x32_bf16 a[140:143], v[200:203], a[64:67], a[140:143]
    ds_read_b64_tr_b16 v[210:211], v229 offset:14336
    v_mfma_f32_16x16x32_bf16 a[156:159], v[200:203], a[68:71], a[156:159]
    ds_read_b64_tr_b16 v[212:213], v228 offset:12800
    v_mfma_f32_16x16x32_bf16 a[152:155], v[196:199], a[68:71], a[152:155]
    buffer_load_dwordx4 a[8:11], v222, s[8:11], s54 offen offset:0 sc1
    ds_read_b64_tr_b16 v[214:215], v228 offset:14848
    v_mfma_f32_16x16x32_bf16 a[148:151], v[192:195], a[68:71], a[148:151]
    ds_read_b64_tr_b16 v[216:217], v229 offset:12800
    v_mfma_f32_16x16x32_bf16 a[144:147], v[188:191], a[68:71], a[144:147]
    buffer_load_dwordx4 a[12:15], v222, s[8:11], s55 offen offset:0 sc1
    ds_read_b64_tr_b16 v[218:219], v229 offset:14848
    v_mfma_f32_16x16x32_bf16 a[160:163], v[188:191], a[72:75], a[160:163]
    ds_read_b64_tr_b16 v[64:65], v220 offset:32768
    v_mfma_f32_16x16x32_bf16 a[164:167], v[192:195], a[72:75], a[164:167]
    ds_read_b64_tr_b16 v[66:67], v220 offset:34816
    v_mfma_f32_16x16x32_bf16 a[168:171], v[196:199], a[72:75], a[168:171]
    buffer_load_dwordx4 a[16:19], v222, s[8:11], s88 offen offset:0 sc1
    ds_read_b64_tr_b16 v[68:69], v221 offset:32768
    v_mfma_f32_16x16x32_bf16 a[172:175], v[200:203], a[72:75], a[172:175]
    ds_read_b64_tr_b16 v[70:71], v221 offset:34816
    v_mfma_f32_16x16x32_bf16 a[188:191], v[200:203], a[76:79], a[188:191]
    buffer_load_dwordx4 a[20:23], v222, s[8:11], s89 offen offset:0 sc1
    v_mfma_f32_16x16x32_bf16 a[184:187], v[196:199], a[76:79], a[184:187]
    ds_read_b64_tr_b16 v[72:73], v220 offset:33280
    v_mfma_f32_16x16x32_bf16 a[180:183], v[192:195], a[76:79], a[180:183]
    ds_read_b64_tr_b16 v[74:75], v220 offset:35328
    v_mfma_f32_16x16x32_bf16 a[176:179], v[188:191], a[76:79], a[176:179]
    buffer_load_dwordx4 a[24:27], v222, s[8:11], s90 offen offset:0 sc1
    ds_read_b64_tr_b16 v[76:77], v221 offset:33280
    v_mfma_f32_16x16x32_bf16 a[192:195], v[188:191], a[80:83], a[192:195]
    ds_read_b64_tr_b16 v[78:79], v221 offset:35328
    v_mfma_f32_16x16x32_bf16 a[196:199], v[192:195], a[80:83], a[196:199]
    buffer_load_dwordx4 a[28:31], v222, s[8:11], s91 offen offset:0 sc1
    ds_read_b64_tr_b16 v[80:81], v220 offset:49152
    v_mfma_f32_16x16x32_bf16 a[200:203], v[196:199], a[80:83], a[200:203]
    ds_read_b64_tr_b16 v[82:83], v220 offset:51200
    v_mfma_f32_16x16x32_bf16 a[204:207], v[200:203], a[80:83], a[204:207]
    ds_read_b64_tr_b16 v[84:85], v221 offset:49152
    v_mfma_f32_16x16x32_bf16 a[220:223], v[200:203], a[84:87], a[220:223]
    buffer_load_dwordx4 a[32:35], v222, s[8:11], s52 offen offset:1024 sc1
    ds_read_b64_tr_b16 v[86:87], v221 offset:51200
    v_mfma_f32_16x16x32_bf16 a[216:219], v[196:199], a[84:87], a[216:219]
    ds_read_b64_tr_b16 v[88:89], v220 offset:49664
    v_mfma_f32_16x16x32_bf16 a[212:215], v[192:195], a[84:87], a[212:215]
    buffer_load_dwordx4 a[36:39], v222, s[8:11], s53 offen offset:1024 sc1
    ds_read_b64_tr_b16 v[90:91], v220 offset:51712
    v_mfma_f32_16x16x32_bf16 a[208:211], v[188:191], a[84:87], a[208:211]
    ds_read_b64_tr_b16 v[92:93], v221 offset:49664
    v_mfma_f32_16x16x32_bf16 a[224:227], v[188:191], a[88:91], a[224:227]
    ds_read_b64_tr_b16 v[94:95], v221 offset:51712
    v_mfma_f32_16x16x32_bf16 a[228:231], v[192:195], a[88:91], a[228:231]
    buffer_load_dwordx4 a[40:43], v222, s[8:11], s54 offen offset:1024 sc1
    v_mfma_f32_16x16x32_bf16 a[232:235], v[196:199], a[88:91], a[232:235]
    v_mfma_f32_16x16x32_bf16 a[236:239], v[200:203], a[88:91], a[236:239]
    buffer_load_dwordx4 a[44:47], v222, s[8:11], s55 offen offset:1024 sc1
    v_mfma_f32_16x16x32_bf16 a[252:255], v[200:203], a[92:95], a[252:255]
    v_mfma_f32_16x16x32_bf16 a[248:251], v[196:199], a[92:95], a[248:251]
    v_mfma_f32_16x16x32_bf16 a[244:247], v[192:195], a[92:95], a[244:247]
    v_mfma_f32_16x16x32_bf16 a[240:243], v[188:191], a[92:95], a[240:243]
    s_waitcnt vmcnt(12) lgkmcnt(0)
    v_mfma_f32_16x16x32_bf16 a[128:131], v[204:207], a[96:99], a[128:131]
    buffer_load_dwordx4 a[48:51], v222, s[8:11], s88 offen offset:1024 sc1
    ds_read_b64_tr_b16 v[96:97], v228 offset:0
    v_mfma_f32_16x16x32_bf16 a[132:135], v[208:211], a[96:99], a[132:135]
    ds_read_b64_tr_b16 v[98:99], v228 offset:2048
    v_mfma_f32_16x16x32_bf16 a[136:139], v[212:215], a[96:99], a[136:139]
    buffer_load_dwordx4 a[52:55], v222, s[8:11], s89 offen offset:1024 sc1
    v_mfma_f32_16x16x32_bf16 a[140:143], v[216:219], a[96:99], a[140:143]
    ds_read_b64_tr_b16 v[100:101], v229 offset:0
    v_mfma_f32_16x16x32_bf16 a[156:159], v[216:219], a[100:103], a[156:159]
    ds_read_b64_tr_b16 v[102:103], v229 offset:2048
    v_mfma_f32_16x16x32_bf16 a[152:155], v[212:215], a[100:103], a[152:155]
    buffer_load_dwordx4 a[56:59], v222, s[8:11], s90 offen offset:1024 sc1
    v_mfma_f32_16x16x32_bf16 a[148:151], v[208:211], a[100:103], a[148:151]
    ds_read_b64_tr_b16 v[104:105], v228 offset:512
    v_mfma_f32_16x16x32_bf16 a[144:147], v[204:207], a[100:103], a[144:147]
    buffer_load_dwordx4 a[60:63], v222, s[8:11], s91 offen offset:1024 sc1
    v_mfma_f32_16x16x32_bf16 a[160:163], v[204:207], a[104:107], a[160:163]
    ds_read_b64_tr_b16 v[106:107], v228 offset:2560
    v_mfma_f32_16x16x32_bf16 a[164:167], v[208:211], a[104:107], a[164:167]
    ds_read_b64_tr_b16 v[108:109], v229 offset:512
    v_mfma_f32_16x16x32_bf16 a[168:171], v[212:215], a[104:107], a[168:171]
    buffer_load_dwordx4 a[64:67], v223, s[8:11], s52 offen offset:0 sc1
    v_mfma_f32_16x16x32_bf16 a[172:175], v[216:219], a[104:107], a[172:175]
    ds_read_b64_tr_b16 v[110:111], v229 offset:2560
    v_mfma_f32_16x16x32_bf16 a[188:191], v[216:219], a[108:111], a[188:191]
    buffer_load_dwordx4 a[68:71], v223, s[8:11], s53 offen offset:0 sc1
    v_mfma_f32_16x16x32_bf16 a[184:187], v[212:215], a[108:111], a[184:187]
    ds_read_b64_tr_b16 v[128:129], v228 offset:4096
    v_mfma_f32_16x16x32_bf16 a[180:183], v[208:211], a[108:111], a[180:183]
    ds_read_b64_tr_b16 v[130:131], v228 offset:6144
    v_mfma_f32_16x16x32_bf16 a[176:179], v[204:207], a[108:111], a[176:179]
    buffer_load_dwordx4 a[72:75], v223, s[8:11], s54 offen offset:0 sc1
    v_mfma_f32_16x16x32_bf16 a[192:195], v[204:207], a[112:115], a[192:195]
    ds_read_b64_tr_b16 v[132:133], v229 offset:4096
    v_mfma_f32_16x16x32_bf16 a[196:199], v[208:211], a[112:115], a[196:199]
    buffer_load_dwordx4 a[76:79], v223, s[8:11], s55 offen offset:0 sc1
    ds_read_b64_tr_b16 v[134:135], v229 offset:6144
    v_mfma_f32_16x16x32_bf16 a[200:203], v[212:215], a[112:115], a[200:203]
    v_mfma_f32_16x16x32_bf16 a[204:207], v[216:219], a[112:115], a[204:207]
    ds_read_b64_tr_b16 v[136:137], v228 offset:4608
    v_mfma_f32_16x16x32_bf16 a[220:223], v[216:219], a[116:119], a[220:223]
    buffer_load_dwordx4 a[80:83], v223, s[8:11], s88 offen offset:0 sc1
    v_mfma_f32_16x16x32_bf16 a[216:219], v[212:215], a[116:119], a[216:219]
    ds_read_b64_tr_b16 v[138:139], v228 offset:6656
    v_mfma_f32_16x16x32_bf16 a[212:215], v[208:211], a[116:119], a[212:215]
    buffer_load_dwordx4 a[84:87], v223, s[8:11], s89 offen offset:0 sc1
    ds_read_b64_tr_b16 v[140:141], v229 offset:4608
    v_mfma_f32_16x16x32_bf16 a[208:211], v[204:207], a[116:119], a[208:211]
    v_mfma_f32_16x16x32_bf16 a[224:227], v[204:207], a[120:123], a[224:227]
    ds_read_b64_tr_b16 v[142:143], v229 offset:6656
    v_mfma_f32_16x16x32_bf16 a[228:231], v[208:211], a[120:123], a[228:231]
    buffer_load_dwordx4 a[88:91], v223, s[8:11], s90 offen offset:0 sc1
    v_mfma_f32_16x16x32_bf16 a[232:235], v[212:215], a[120:123], a[232:235]
    v_mfma_f32_16x16x32_bf16 a[236:239], v[216:219], a[120:123], a[236:239]
    buffer_load_dwordx4 a[92:95], v223, s[8:11], s91 offen offset:0 sc1
    v_mfma_f32_16x16x32_bf16 a[252:255], v[216:219], a[124:127], a[252:255]
    v_mfma_f32_16x16x32_bf16 a[248:251], v[212:215], a[124:127], a[248:251]
    v_mfma_f32_16x16x32_bf16 a[244:247], v[208:211], a[124:127], a[244:247]
    v_mfma_f32_16x16x32_bf16 a[240:243], v[204:207], a[124:127], a[240:243]
    s_waitcnt vmcnt(16) lgkmcnt(0)
    v_mfma_f32_16x16x32_bf16 a[128:131], v[0:3], a[0:3], a[128:131]
    v_permlane16_swap_b32 v112, v114
    v_mfma_f32_16x16x32_bf16 a[132:135], v[4:7], a[0:3], a[132:135]
    buffer_load_dwordx4 a[96:99], v223, s[8:11], s52 offen offset:1024 sc1
    v_mfma_f32_16x16x32_bf16 a[136:139], v[8:11], a[0:3], a[136:139]
    v_permlane16_swap_b32 v113, v115
    v_mfma_f32_16x16x32_bf16 a[140:143], v[12:15], a[0:3], a[140:143]
    v_mfma_f32_16x16x32_bf16 a[140:143], v[28:31], a[4:7], a[140:143]
    buffer_load_dwordx4 a[100:103], v223, s[8:11], s53 offen offset:1024 sc1
    v_permlane16_swap_b32 v116, v118
    v_mfma_f32_16x16x32_bf16 a[136:139], v[24:27], a[4:7], a[136:139]
    v_mfma_f32_16x16x32_bf16 a[132:135], v[20:23], a[4:7], a[132:135]
    v_permlane16_swap_b32 v117, v119
    v_mfma_f32_16x16x32_bf16 a[128:131], v[16:19], a[4:7], a[128:131]
    v_mfma_f32_16x16x32_bf16 a[128:131], v[32:35], a[8:11], a[128:131]
    buffer_load_dwordx4 a[104:107], v223, s[8:11], s54 offen offset:1024 sc1
    v_permlane16_swap_b32 v120, v122
    v_mfma_f32_16x16x32_bf16 a[132:135], v[36:39], a[8:11], a[132:135]
    v_mfma_f32_16x16x32_bf16 a[136:139], v[40:43], a[8:11], a[136:139]
    v_permlane16_swap_b32 v121, v123
    v_mfma_f32_16x16x32_bf16 a[140:143], v[44:47], a[8:11], a[140:143]
    v_mfma_f32_16x16x32_bf16 a[140:143], v[60:63], a[12:15], a[140:143]
    buffer_load_dwordx4 a[108:111], v223, s[8:11], s55 offen offset:1024 sc1
    v_permlane16_swap_b32 v124, v126
    v_mfma_f32_16x16x32_bf16 a[136:139], v[56:59], a[12:15], a[136:139]
    v_mfma_f32_16x16x32_bf16 a[132:135], v[52:55], a[12:15], a[132:135]
    v_permlane16_swap_b32 v125, v127
    v_mfma_f32_16x16x32_bf16 a[128:131], v[48:51], a[12:15], a[128:131]
    v_mfma_f32_16x16x32_bf16 a[128:131], v[64:67], a[16:19], a[128:131]
    buffer_load_dwordx4 a[112:115], v223, s[8:11], s88 offen offset:1024 sc1
    v_lshlrev_b32 v144, 16, v112
    v_mfma_f32_16x16x32_bf16 a[132:135], v[68:71], a[16:19], a[132:135]
    v_mfma_f32_16x16x32_bf16 a[136:139], v[72:75], a[16:19], a[136:139]
    v_and_b32 v145, 0xffff0000, v112
    v_mfma_f32_16x16x32_bf16 a[140:143], v[76:79], a[16:19], a[140:143]
    buffer_load_dwordx4 a[116:119], v223, s[8:11], s89 offen offset:1024 sc1
    v_mfma_f32_16x16x32_bf16 a[140:143], v[92:95], a[20:23], a[140:143]
    v_mfma_f32_16x16x32_bf16 a[136:139], v[88:91], a[20:23], a[136:139]
    v_mfma_f32_16x16x32_bf16 a[132:135], v[84:87], a[20:23], a[132:135]
    v_mfma_f32_16x16x32_bf16 a[128:131], v[80:83], a[20:23], a[128:131]
    buffer_load_dwordx4 a[120:123], v223, s[8:11], s90 offen offset:1024 sc1
    v_mfma_f32_16x16x32_bf16 a[128:131], v[96:99], a[24:27], a[128:131]
    v_mfma_f32_16x16x32_bf16 a[132:135], v[100:103], a[24:27], a[132:135]
    v_mfma_f32_16x16x32_bf16 a[136:139], v[104:107], a[24:27], a[136:139]
    v_mfma_f32_16x16x32_bf16 a[140:143], v[108:111], a[24:27], a[140:143]
    buffer_load_dwordx4 a[124:127], v223, s[8:11], s91 offen offset:1024 sc1
    v_mfma_f32_16x16x32_bf16 a[140:143], v[140:143], a[28:31], a[140:143]
    v_mfma_f32_16x16x32_bf16 a[136:139], v[136:139], a[28:31], a[136:139]
    v_mfma_f32_16x16x32_bf16 a[132:135], v[132:135], a[28:31], a[132:135]
    v_mfma_f32_16x16x32_bf16 a[128:131], v[128:131], a[28:31], a[128:131]
    s_waitcnt vmcnt(16)
    v_mfma_f32_16x16x32_bf16 a[144:147], v[0:3], a[32:35], a[144:147]
    v_lshlrev_b32 v146, 16, v113
    v_mfma_f32_16x16x32_bf16 a[148:151], v[4:7], a[32:35], a[148:151]
    buffer_load_dwordx4 a[0:3], v246, s[8:11], s52 offen offset:0 sc1
    v_mfma_f32_16x16x32_bf16 a[152:155], v[8:11], a[32:35], a[152:155]
    v_and_b32 v147, 0xffff0000, v113
    v_mfma_f32_16x16x32_bf16 a[156:159], v[12:15], a[32:35], a[156:159]
    v_mfma_f32_16x16x32_bf16 a[156:159], v[28:31], a[36:39], a[156:159]
    buffer_load_dwordx4 a[4:7], v246, s[8:11], s53 offen offset:0 sc1
    v_lshlrev_b32 v148, 16, v114
    v_mfma_f32_16x16x32_bf16 a[152:155], v[24:27], a[36:39], a[152:155]
    v_mfma_f32_16x16x32_bf16 a[148:151], v[20:23], a[36:39], a[148:151]
    v_and_b32 v149, 0xffff0000, v114
    v_mfma_f32_16x16x32_bf16 a[144:147], v[16:19], a[36:39], a[144:147]
    v_mfma_f32_16x16x32_bf16 a[144:147], v[32:35], a[40:43], a[144:147]
    buffer_load_dwordx4 a[8:11], v246, s[8:11], s54 offen offset:0 sc1
    ds_write_b128 v238, a[128:131] offset:0
    v_mfma_f32_16x16x32_bf16 a[148:151], v[36:39], a[40:43], a[148:151]
    v_lshlrev_b32 v150, 16, v115
    v_mfma_f32_16x16x32_bf16 a[152:155], v[40:43], a[40:43], a[152:155]
    v_and_b32 v151, 0xffff0000, v115
    v_mfma_f32_16x16x32_bf16 a[156:159], v[44:47], a[40:43], a[156:159]
    v_mfma_f32_16x16x32_bf16 a[156:159], v[60:63], a[44:47], a[156:159]
    buffer_load_dwordx4 a[12:15], v246, s[8:11], s55 offen offset:0 sc1
    ds_write_b128 v238, a[132:135] offset:1024
    v_mfma_f32_16x16x32_bf16 a[152:155], v[56:59], a[44:47], a[152:155]
    v_lshlrev_b32 v152, 16, v116
    v_mfma_f32_16x16x32_bf16 a[148:151], v[52:55], a[44:47], a[148:151]
    v_and_b32 v153, 0xffff0000, v116
    v_mfma_f32_16x16x32_bf16 a[144:147], v[48:51], a[44:47], a[144:147]
    v_mfma_f32_16x16x32_bf16 a[144:147], v[64:67], a[48:51], a[144:147]
    buffer_load_dwordx4 a[16:19], v246, s[8:11], s88 offen offset:0 sc1
    ds_write_b128 v238, a[136:139] offset:2048
    v_mfma_f32_16x16x32_bf16 a[148:151], v[68:71], a[48:51], a[148:151]
    v_lshlrev_b32 v154, 16, v117
    v_mfma_f32_16x16x32_bf16 a[152:155], v[72:75], a[48:51], a[152:155]
    v_and_b32 v155, 0xffff0000, v117
    v_mfma_f32_16x16x32_bf16 a[156:159], v[76:79], a[48:51], a[156:159]
    buffer_load_dwordx4 a[20:23], v246, s[8:11], s89 offen offset:0 sc1
    v_mfma_f32_16x16x32_bf16 a[156:159], v[92:95], a[52:55], a[156:159]
    ds_write_b128 v238, a[140:143] offset:3072
    v_mfma_f32_16x16x32_bf16 a[152:155], v[88:91], a[52:55], a[152:155]
    v_mfma_f32_16x16x32_bf16 a[148:151], v[84:87], a[52:55], a[148:151]
    v_mfma_f32_16x16x32_bf16 a[144:147], v[80:83], a[52:55], a[144:147]
    buffer_load_dwordx4 a[24:27], v246, s[8:11], s90 offen offset:0 sc1
    v_mfma_f32_16x16x32_bf16 a[144:147], v[96:99], a[56:59], a[144:147]
    v_mfma_f32_16x16x32_bf16 a[148:151], v[100:103], a[56:59], a[148:151]
    v_mfma_f32_16x16x32_bf16 a[152:155], v[104:107], a[56:59], a[152:155]
    v_mfma_f32_16x16x32_bf16 a[156:159], v[108:111], a[56:59], a[156:159]
    buffer_load_dwordx4 a[28:31], v246, s[8:11], s91 offen offset:0 sc1
    v_mfma_f32_16x16x32_bf16 a[156:159], v[140:143], a[60:63], a[156:159]
    v_mfma_f32_16x16x32_bf16 a[152:155], v[136:139], a[60:63], a[152:155]
    v_mfma_f32_16x16x32_bf16 a[148:151], v[132:135], a[60:63], a[148:151]
    v_mfma_f32_16x16x32_bf16 a[144:147], v[128:131], a[60:63], a[144:147]
    s_waitcnt vmcnt(16)
    v_mfma_f32_16x16x32_bf16 a[160:163], v[0:3], a[64:67], a[160:163]
    v_lshlrev_b32 v156, 16, v118
    v_mfma_f32_16x16x32_bf16 a[164:167], v[4:7], a[64:67], a[164:167]
    buffer_load_dwordx4 a[32:35], v246, s[8:11], s52 offen offset:1024 sc1
    v_mfma_f32_16x16x32_bf16 a[168:171], v[8:11], a[64:67], a[168:171]
    v_and_b32 v157, 0xffff0000, v118
    v_mfma_f32_16x16x32_bf16 a[172:175], v[12:15], a[64:67], a[172:175]
    v_mfma_f32_16x16x32_bf16 a[172:175], v[28:31], a[68:71], a[172:175]
    buffer_load_dwordx4 a[36:39], v246, s[8:11], s53 offen offset:1024 sc1
    v_lshlrev_b32 v158, 16, v119
    v_mfma_f32_16x16x32_bf16 a[168:171], v[24:27], a[68:71], a[168:171]
    v_mfma_f32_16x16x32_bf16 a[164:167], v[20:23], a[68:71], a[164:167]
    v_and_b32 v159, 0xffff0000, v119
    v_mfma_f32_16x16x32_bf16 a[160:163], v[16:19], a[68:71], a[160:163]
    v_mfma_f32_16x16x32_bf16 a[160:163], v[32:35], a[72:75], a[160:163]
    buffer_load_dwordx4 a[40:43], v246, s[8:11], s54 offen offset:1024 sc1
    ds_write_b128 v238, a[144:147] offset:16384
    v_mfma_f32_16x16x32_bf16 a[164:167], v[36:39], a[72:75], a[164:167]
    v_lshlrev_b32 v160, 16, v120
    v_mfma_f32_16x16x32_bf16 a[168:171], v[40:43], a[72:75], a[168:171]
    v_and_b32 v161, 0xffff0000, v120
    v_mfma_f32_16x16x32_bf16 a[172:175], v[44:47], a[72:75], a[172:175]
    v_mfma_f32_16x16x32_bf16 a[172:175], v[60:63], a[76:79], a[172:175]
    buffer_load_dwordx4 a[44:47], v246, s[8:11], s55 offen offset:1024 sc1
    ds_write_b128 v238, a[148:151] offset:17408
    v_mfma_f32_16x16x32_bf16 a[168:171], v[56:59], a[76:79], a[168:171]
    v_lshlrev_b32 v162, 16, v121
    v_mfma_f32_16x16x32_bf16 a[164:167], v[52:55], a[76:79], a[164:167]
    v_and_b32 v163, 0xffff0000, v121
    v_mfma_f32_16x16x32_bf16 a[160:163], v[48:51], a[76:79], a[160:163]
    v_mfma_f32_16x16x32_bf16 a[160:163], v[64:67], a[80:83], a[160:163]
    buffer_load_dwordx4 a[48:51], v246, s[8:11], s88 offen offset:1024 sc1
    ds_write_b128 v238, a[152:155] offset:18432
    v_mfma_f32_16x16x32_bf16 a[164:167], v[68:71], a[80:83], a[164:167]
    v_lshlrev_b32 v164, 16, v122
    v_mfma_f32_16x16x32_bf16 a[168:171], v[72:75], a[80:83], a[168:171]
    v_and_b32 v165, 0xffff0000, v122
    v_mfma_f32_16x16x32_bf16 a[172:175], v[76:79], a[80:83], a[172:175]
    buffer_load_dwordx4 a[52:55], v246, s[8:11], s89 offen offset:1024 sc1
    v_mfma_f32_16x16x32_bf16 a[172:175], v[92:95], a[84:87], a[172:175]
    ds_write_b128 v238, a[156:159] offset:19456
    v_mfma_f32_16x16x32_bf16 a[168:171], v[88:91], a[84:87], a[168:171]
    v_mfma_f32_16x16x32_bf16 a[164:167], v[84:87], a[84:87], a[164:167]
    v_mfma_f32_16x16x32_bf16 a[160:163], v[80:83], a[84:87], a[160:163]
    buffer_load_dwordx4 a[56:59], v246, s[8:11], s90 offen offset:1024 sc1
    v_mfma_f32_16x16x32_bf16 a[160:163], v[96:99], a[88:91], a[160:163]
    v_mfma_f32_16x16x32_bf16 a[164:167], v[100:103], a[88:91], a[164:167]
    v_mfma_f32_16x16x32_bf16 a[168:171], v[104:107], a[88:91], a[168:171]
    v_mfma_f32_16x16x32_bf16 a[172:175], v[108:111], a[88:91], a[172:175]
    buffer_load_dwordx4 a[60:63], v246, s[8:11], s91 offen offset:1024 sc1
    v_mfma_f32_16x16x32_bf16 a[172:175], v[140:143], a[92:95], a[172:175]
    v_mfma_f32_16x16x32_bf16 a[168:171], v[136:139], a[92:95], a[168:171]
    v_mfma_f32_16x16x32_bf16 a[164:167], v[132:135], a[92:95], a[164:167]
    v_mfma_f32_16x16x32_bf16 a[160:163], v[128:131], a[92:95], a[160:163]
    s_waitcnt vmcnt(16)
    v_mfma_f32_16x16x32_bf16 a[176:179], v[0:3], a[96:99], a[176:179]
    v_lshlrev_b32 v166, 16, v123
    v_mfma_f32_16x16x32_bf16 a[180:183], v[4:7], a[96:99], a[180:183]
    buffer_load_dwordx4 a[64:67], v247, s[8:11], s52 offen offset:0 sc1
    v_mfma_f32_16x16x32_bf16 a[184:187], v[8:11], a[96:99], a[184:187]
    v_and_b32 v167, 0xffff0000, v123
    v_mfma_f32_16x16x32_bf16 a[188:191], v[12:15], a[96:99], a[188:191]
    v_mfma_f32_16x16x32_bf16 a[188:191], v[28:31], a[100:103], a[188:191]
    buffer_load_dwordx4 a[68:71], v247, s[8:11], s53 offen offset:0 sc1
    v_lshlrev_b32 v168, 16, v124
    v_mfma_f32_16x16x32_bf16 a[184:187], v[24:27], a[100:103], a[184:187]
    v_mfma_f32_16x16x32_bf16 a[180:183], v[20:23], a[100:103], a[180:183]
    v_and_b32 v169, 0xffff0000, v124
    v_mfma_f32_16x16x32_bf16 a[176:179], v[16:19], a[100:103], a[176:179]
    v_mfma_f32_16x16x32_bf16 a[176:179], v[32:35], a[104:107], a[176:179]
    buffer_load_dwordx4 a[72:75], v247, s[8:11], s54 offen offset:0 sc1
    ds_write_b128 v238, a[160:163] offset:32768
    v_mfma_f32_16x16x32_bf16 a[180:183], v[36:39], a[104:107], a[180:183]
    v_lshlrev_b32 v170, 16, v125
    v_mfma_f32_16x16x32_bf16 a[184:187], v[40:43], a[104:107], a[184:187]
    v_and_b32 v171, 0xffff0000, v125
    v_mfma_f32_16x16x32_bf16 a[188:191], v[44:47], a[104:107], a[188:191]
    v_mfma_f32_16x16x32_bf16 a[188:191], v[60:63], a[108:111], a[188:191]
    buffer_load_dwordx4 a[76:79], v247, s[8:11], s55 offen offset:0 sc1
    ds_write_b128 v238, a[164:167] offset:33792
    v_mfma_f32_16x16x32_bf16 a[184:187], v[56:59], a[108:111], a[184:187]
    v_lshlrev_b32 v172, 16, v126
    v_mfma_f32_16x16x32_bf16 a[180:183], v[52:55], a[108:111], a[180:183]
    v_and_b32 v173, 0xffff0000, v126
    v_mfma_f32_16x16x32_bf16 a[176:179], v[48:51], a[108:111], a[176:179]
    v_mfma_f32_16x16x32_bf16 a[176:179], v[64:67], a[112:115], a[176:179]
    buffer_load_dwordx4 a[80:83], v247, s[8:11], s88 offen offset:0 sc1
    ds_write_b128 v238, a[168:171] offset:34816
    v_mfma_f32_16x16x32_bf16 a[180:183], v[68:71], a[112:115], a[180:183]
    v_lshlrev_b32 v174, 16, v127
    v_mfma_f32_16x16x32_bf16 a[184:187], v[72:75], a[112:115], a[184:187]
    v_and_b32 v175, 0xffff0000, v127
    v_mfma_f32_16x16x32_bf16 a[188:191], v[76:79], a[112:115], a[188:191]
    buffer_load_dwordx4 a[84:87], v247, s[8:11], s89 offen offset:0 sc1
    v_mfma_f32_16x16x32_bf16 a[188:191], v[92:95], a[116:119], a[188:191]
    ds_write_b128 v238, a[172:175] offset:35840
    v_mfma_f32_16x16x32_bf16 a[184:187], v[88:91], a[116:119], a[184:187]
    v_mfma_f32_16x16x32_bf16 a[180:183], v[84:87], a[116:119], a[180:183]
    v_mfma_f32_16x16x32_bf16 a[176:179], v[80:83], a[116:119], a[176:179]
    buffer_load_dwordx4 a[88:91], v247, s[8:11], s90 offen offset:0 sc1
    v_mfma_f32_16x16x32_bf16 a[176:179], v[96:99], a[120:123], a[176:179]
    v_mfma_f32_16x16x32_bf16 a[180:183], v[100:103], a[120:123], a[180:183]
    v_mfma_f32_16x16x32_bf16 a[184:187], v[104:107], a[120:123], a[184:187]
    v_mfma_f32_16x16x32_bf16 a[188:191], v[108:111], a[120:123], a[188:191]
    buffer_load_dwordx4 a[92:95], v247, s[8:11], s91 offen offset:0 sc1
    v_mfma_f32_16x16x32_bf16 a[188:191], v[140:143], a[124:127], a[188:191]
    v_mfma_f32_16x16x32_bf16 a[184:187], v[136:139], a[124:127], a[184:187]
    v_mfma_f32_16x16x32_bf16 a[180:183], v[132:135], a[124:127], a[180:183]
    v_mfma_f32_16x16x32_bf16 a[176:179], v[128:131], a[124:127], a[176:179]
    s_waitcnt vmcnt(16)
    v_mfma_f32_16x16x32_bf16 a[192:195], v[0:3], a[0:3], a[192:195]
    v_mfma_f32_16x16x32_bf16 a[196:199], v[4:7], a[0:3], a[196:199]
    buffer_load_dwordx4 a[96:99], v247, s[8:11], s52 offen offset:1024 sc1
    v_mfma_f32_16x16x32_bf16 a[200:203], v[8:11], a[0:3], a[200:203]
    v_mfma_f32_16x16x32_bf16 a[204:207], v[12:15], a[0:3], a[204:207]
    v_mfma_f32_16x16x32_bf16 a[204:207], v[28:31], a[4:7], a[204:207]
    buffer_load_dwordx4 a[100:103], v247, s[8:11], s53 offen offset:1024 sc1
    v_mfma_f32_16x16x32_bf16 a[200:203], v[24:27], a[4:7], a[200:203]
    v_mfma_f32_16x16x32_bf16 a[196:199], v[20:23], a[4:7], a[196:199]
    v_mfma_f32_16x16x32_bf16 a[192:195], v[16:19], a[4:7], a[192:195]
    v_mfma_f32_16x16x32_bf16 a[192:195], v[32:35], a[8:11], a[192:195]
    buffer_load_dwordx4 a[104:107], v247, s[8:11], s54 offen offset:1024 sc1
    ds_write_b128 v238, a[176:179] offset:49152
    v_mfma_f32_16x16x32_bf16 a[196:199], v[36:39], a[8:11], a[196:199]
    v_mfma_f32_16x16x32_bf16 a[200:203], v[40:43], a[8:11], a[200:203]
    v_mfma_f32_16x16x32_bf16 a[204:207], v[44:47], a[8:11], a[204:207]
    v_mfma_f32_16x16x32_bf16 a[204:207], v[60:63], a[12:15], a[204:207]
    buffer_load_dwordx4 a[108:111], v247, s[8:11], s55 offen offset:1024 sc1
    ds_write_b128 v238, a[180:183] offset:50176
    v_mfma_f32_16x16x32_bf16 a[200:203], v[56:59], a[12:15], a[200:203]
    v_mfma_f32_16x16x32_bf16 a[196:199], v[52:55], a[12:15], a[196:199]
    v_mfma_f32_16x16x32_bf16 a[192:195], v[48:51], a[12:15], a[192:195]
    v_mfma_f32_16x16x32_bf16 a[192:195], v[64:67], a[16:19], a[192:195]
    buffer_load_dwordx4 a[112:115], v247, s[8:11], s88 offen offset:1024 sc1
    ds_write_b128 v238, a[184:187] offset:51200
    v_mfma_f32_16x16x32_bf16 a[196:199], v[68:71], a[16:19], a[196:199]
    v_mfma_f32_16x16x32_bf16 a[200:203], v[72:75], a[16:19], a[200:203]
    v_mfma_f32_16x16x32_bf16 a[204:207], v[76:79], a[16:19], a[204:207]
    buffer_load_dwordx4 a[116:119], v247, s[8:11], s89 offen offset:1024 sc1
    v_mfma_f32_16x16x32_bf16 a[204:207], v[92:95], a[20:23], a[204:207]
    ds_write_b128 v238, a[188:191] offset:52224
    v_mfma_f32_16x16x32_bf16 a[200:203], v[88:91], a[20:23], a[200:203]
    v_mfma_f32_16x16x32_bf16 a[196:199], v[84:87], a[20:23], a[196:199]
    v_mfma_f32_16x16x32_bf16 a[192:195], v[80:83], a[20:23], a[192:195]
    buffer_load_dwordx4 a[120:123], v247, s[8:11], s90 offen offset:1024 sc1
    v_mfma_f32_16x16x32_bf16 a[192:195], v[96:99], a[24:27], a[192:195]
    v_add_u32 v238, 0x10000, v238
    v_mfma_f32_16x16x32_bf16 a[196:199], v[100:103], a[24:27], a[196:199]
    v_mfma_f32_16x16x32_bf16 a[200:203], v[104:107], a[24:27], a[200:203]
    v_mfma_f32_16x16x32_bf16 a[204:207], v[108:111], a[24:27], a[204:207]
    buffer_load_dwordx4 a[124:127], v247, s[8:11], s91 offen offset:1024 sc1
    v_mfma_f32_16x16x32_bf16 a[204:207], v[140:143], a[28:31], a[204:207]
    v_mfma_f32_16x16x32_bf16 a[200:203], v[136:139], a[28:31], a[200:203]
    v_mfma_f32_16x16x32_bf16 a[196:199], v[132:135], a[28:31], a[196:199]
    v_mfma_f32_16x16x32_bf16 a[192:195], v[128:131], a[28:31], a[192:195]
    s_waitcnt vmcnt(16)
    v_mfma_f32_16x16x32_bf16 a[208:211], v[0:3], a[32:35], a[208:211]
    v_mfma_f32_16x16x32_bf16 a[212:215], v[4:7], a[32:35], a[212:215]
    v_mfma_f32_16x16x32_bf16 a[216:219], v[8:11], a[32:35], a[216:219]
    v_mfma_f32_16x16x32_bf16 a[220:223], v[12:15], a[32:35], a[220:223]
    v_mfma_f32_16x16x32_bf16 a[220:223], v[28:31], a[36:39], a[220:223]
    v_mfma_f32_16x16x32_bf16 a[216:219], v[24:27], a[36:39], a[216:219]
    v_mfma_f32_16x16x32_bf16 a[212:215], v[20:23], a[36:39], a[212:215]
    v_mfma_f32_16x16x32_bf16 a[208:211], v[16:19], a[36:39], a[208:211]
    v_mfma_f32_16x16x32_bf16 a[208:211], v[32:35], a[40:43], a[208:211]
    ds_write_b128 v238, a[192:195] offset:0
    v_mfma_f32_16x16x32_bf16 a[212:215], v[36:39], a[40:43], a[212:215]
    v_mfma_f32_16x16x32_bf16 a[216:219], v[40:43], a[40:43], a[216:219]
    v_mfma_f32_16x16x32_bf16 a[220:223], v[44:47], a[40:43], a[220:223]
    v_mfma_f32_16x16x32_bf16 a[220:223], v[60:63], a[44:47], a[220:223]
    ds_write_b128 v238, a[196:199] offset:1024
    v_mfma_f32_16x16x32_bf16 a[216:219], v[56:59], a[44:47], a[216:219]
    v_mfma_f32_16x16x32_bf16 a[212:215], v[52:55], a[44:47], a[212:215]
    v_mfma_f32_16x16x32_bf16 a[208:211], v[48:51], a[44:47], a[208:211]
    v_mfma_f32_16x16x32_bf16 a[208:211], v[64:67], a[48:51], a[208:211]
    ds_write_b128 v238, a[200:203] offset:2048
    v_mfma_f32_16x16x32_bf16 a[212:215], v[68:71], a[48:51], a[212:215]
    v_mfma_f32_16x16x32_bf16 a[216:219], v[72:75], a[48:51], a[216:219]
    v_mfma_f32_16x16x32_bf16 a[220:223], v[76:79], a[48:51], a[220:223]
    v_mfma_f32_16x16x32_bf16 a[220:223], v[92:95], a[52:55], a[220:223]
    ds_write_b128 v238, a[204:207] offset:3072
    v_mfma_f32_16x16x32_bf16 a[216:219], v[88:91], a[52:55], a[216:219]
    v_mfma_f32_16x16x32_bf16 a[212:215], v[84:87], a[52:55], a[212:215]
    v_mfma_f32_16x16x32_bf16 a[208:211], v[80:83], a[52:55], a[208:211]
    v_mfma_f32_16x16x32_bf16 a[208:211], v[96:99], a[56:59], a[208:211]
    v_mfma_f32_16x16x32_bf16 a[212:215], v[100:103], a[56:59], a[212:215]
    v_mfma_f32_16x16x32_bf16 a[216:219], v[104:107], a[56:59], a[216:219]
    v_mfma_f32_16x16x32_bf16 a[220:223], v[108:111], a[56:59], a[220:223]
    v_mfma_f32_16x16x32_bf16 a[220:223], v[140:143], a[60:63], a[220:223]
    v_mfma_f32_16x16x32_bf16 a[216:219], v[136:139], a[60:63], a[216:219]
    v_mfma_f32_16x16x32_bf16 a[212:215], v[132:135], a[60:63], a[212:215]
    v_mfma_f32_16x16x32_bf16 a[208:211], v[128:131], a[60:63], a[208:211]
    s_waitcnt vmcnt(8)
    v_mfma_f32_16x16x32_bf16 a[224:227], v[0:3], a[64:67], a[224:227]
    v_mfma_f32_16x16x32_bf16 a[228:231], v[4:7], a[64:67], a[228:231]
    v_mfma_f32_16x16x32_bf16 a[232:235], v[8:11], a[64:67], a[232:235]
    v_mfma_f32_16x16x32_bf16 a[236:239], v[12:15], a[64:67], a[236:239]
    v_mfma_f32_16x16x32_bf16 a[236:239], v[28:31], a[68:71], a[236:239]
    v_mfma_f32_16x16x32_bf16 a[232:235], v[24:27], a[68:71], a[232:235]
    v_mfma_f32_16x16x32_bf16 a[228:231], v[20:23], a[68:71], a[228:231]
    v_mfma_f32_16x16x32_bf16 a[224:227], v[16:19], a[68:71], a[224:227]
    v_mfma_f32_16x16x32_bf16 a[224:227], v[32:35], a[72:75], a[224:227]
    ds_write_b128 v238, a[208:211] offset:16384
    v_mfma_f32_16x16x32_bf16 a[228:231], v[36:39], a[72:75], a[228:231]
    v_mfma_f32_16x16x32_bf16 a[232:235], v[40:43], a[72:75], a[232:235]
    v_mfma_f32_16x16x32_bf16 a[236:239], v[44:47], a[72:75], a[236:239]
    v_mfma_f32_16x16x32_bf16 a[236:239], v[60:63], a[76:79], a[236:239]
    ds_write_b128 v238, a[212:215] offset:17408
    v_mfma_f32_16x16x32_bf16 a[232:235], v[56:59], a[76:79], a[232:235]
    v_mfma_f32_16x16x32_bf16 a[228:231], v[52:55], a[76:79], a[228:231]
    v_mfma_f32_16x16x32_bf16 a[224:227], v[48:51], a[76:79], a[224:227]
    v_mfma_f32_16x16x32_bf16 a[224:227], v[64:67], a[80:83], a[224:227]
    ds_write_b128 v238, a[216:219] offset:18432
    v_mfma_f32_16x16x32_bf16 a[228:231], v[68:71], a[80:83], a[228:231]
    v_mfma_f32_16x16x32_bf16 a[232:235], v[72:75], a[80:83], a[232:235]
    v_mfma_f32_16x16x32_bf16 a[236:239], v[76:79], a[80:83], a[236:239]
    v_mfma_f32_16x16x32_bf16 a[236:239], v[92:95], a[84:87], a[236:239]
    ds_write_b128 v238, a[220:223] offset:19456
    v_mfma_f32_16x16x32_bf16 a[232:235], v[88:91], a[84:87], a[232:235]
    v_mfma_f32_16x16x32_bf16 a[228:231], v[84:87], a[84:87], a[228:231]
    v_mfma_f32_16x16x32_bf16 a[224:227], v[80:83], a[84:87], a[224:227]
    v_mfma_f32_16x16x32_bf16 a[224:227], v[96:99], a[88:91], a[224:227]
    v_mfma_f32_16x16x32_bf16 a[228:231], v[100:103], a[88:91], a[228:231]
    v_mfma_f32_16x16x32_bf16 a[232:235], v[104:107], a[88:91], a[232:235]
    v_mfma_f32_16x16x32_bf16 a[236:239], v[108:111], a[88:91], a[236:239]
    v_mfma_f32_16x16x32_bf16 a[236:239], v[140:143], a[92:95], a[236:239]
    v_mfma_f32_16x16x32_bf16 a[232:235], v[136:139], a[92:95], a[232:235]
    v_mfma_f32_16x16x32_bf16 a[228:231], v[132:135], a[92:95], a[228:231]
    v_mfma_f32_16x16x32_bf16 a[224:227], v[128:131], a[92:95], a[224:227]
    s_waitcnt lgkmcnt(0)
    s_barrier
    s_waitcnt vmcnt(0)
    v_mfma_f32_16x16x32_bf16 a[240:243], v[0:3], a[96:99], a[240:243]
    ds_read_b128 v[176:179], v233 offset:0
    v_mfma_f32_16x16x32_bf16 a[244:247], v[4:7], a[96:99], a[244:247]
    ds_read_b128 v[180:183], v233 offset:1024
    v_mfma_f32_16x16x32_bf16 a[248:251], v[8:11], a[96:99], a[248:251]
    ds_read_b128 v[184:187], v233 offset:2048
    v_mfma_f32_16x16x32_bf16 a[252:255], v[12:15], a[96:99], a[252:255]
    ds_read_b128 v[188:191], v233 offset:3072
    v_mfma_f32_16x16x32_bf16 a[252:255], v[28:31], a[100:103], a[252:255]
    ds_read_b128 v[192:195], v233 offset:16384
    v_mfma_f32_16x16x32_bf16 a[248:251], v[24:27], a[100:103], a[248:251]
    ds_read_b128 v[196:199], v233 offset:17408
    v_mfma_f32_16x16x32_bf16 a[244:247], v[20:23], a[100:103], a[244:247]
    ds_read_b128 v[200:203], v233 offset:18432
    v_mfma_f32_16x16x32_bf16 a[240:243], v[16:19], a[100:103], a[240:243]
    ds_read_b128 v[204:207], v233 offset:19456
    v_mfma_f32_16x16x32_bf16 a[240:243], v[32:35], a[104:107], a[240:243]
    v_mfma_f32_16x16x32_bf16 a[244:247], v[36:39], a[104:107], a[244:247]
    ds_read_b128 v[0:3], v234 offset:0
    v_mfma_f32_16x16x32_bf16 a[248:251], v[40:43], a[104:107], a[248:251]
    ds_read_b128 v[4:7], v234 offset:1024
    v_accvgpr_read_b32 v112, a224
    v_mfma_f32_16x16x32_bf16 a[252:255], v[44:47], a[104:107], a[252:255]
    ds_read_b128 v[8:11], v234 offset:2048
    v_accvgpr_read_b32 v113, a225
    v_mfma_f32_16x16x32_bf16 a[252:255], v[60:63], a[108:111], a[252:255]
    ds_read_b128 v[12:15], v234 offset:3072
    v_accvgpr_read_b32 v114, a226
    v_mfma_f32_16x16x32_bf16 a[248:251], v[56:59], a[108:111], a[248:251]
    ds_read_b128 v[16:19], v234 offset:16384
    v_accvgpr_read_b32 v115, a227
    v_mfma_f32_16x16x32_bf16 a[244:247], v[52:55], a[108:111], a[244:247]
    ds_read_b128 v[20:23], v234 offset:17408
    v_accvgpr_read_b32 v116, a228
    v_mfma_f32_16x16x32_bf16 a[240:243], v[48:51], a[108:111], a[240:243]
    ds_read_b128 v[24:27], v234 offset:18432
    v_accvgpr_read_b32 v117, a229
    v_mfma_f32_16x16x32_bf16 a[240:243], v[64:67], a[112:115], a[240:243]
    ds_read_b128 v[28:31], v234 offset:19456
    v_accvgpr_read_b32 v118, a230
    v_mfma_f32_16x16x32_bf16 a[244:247], v[68:71], a[112:115], a[244:247]
    ds_read_b128 v[32:35], v235 offset:0
    v_accvgpr_read_b32 v119, a231
    v_mfma_f32_16x16x32_bf16 a[248:251], v[72:75], a[112:115], a[248:251]
    ds_read_b128 v[36:39], v235 offset:1024
    v_accvgpr_read_b32 v120, a232
    v_mfma_f32_16x16x32_bf16 a[252:255], v[76:79], a[112:115], a[252:255]
    ds_read_b128 v[40:43], v235 offset:2048
    v_accvgpr_read_b32 v121, a233
    v_mfma_f32_16x16x32_bf16 a[252:255], v[92:95], a[116:119], a[252:255]
    ds_read_b128 v[44:47], v235 offset:3072
    v_accvgpr_read_b32 v122, a234
    v_mfma_f32_16x16x32_bf16 a[248:251], v[88:91], a[116:119], a[248:251]
    ds_read_b128 v[48:51], v235 offset:16384
    v_accvgpr_read_b32 v123, a235
    v_mfma_f32_16x16x32_bf16 a[244:247], v[84:87], a[116:119], a[244:247]
    ds_read_b128 v[52:55], v235 offset:17408
    v_accvgpr_read_b32 v124, a236
    v_mfma_f32_16x16x32_bf16 a[240:243], v[80:83], a[116:119], a[240:243]
    ds_read_b128 v[56:59], v235 offset:18432
    v_accvgpr_read_b32 v125, a237
    v_mfma_f32_16x16x32_bf16 a[240:243], v[96:99], a[120:123], a[240:243]
    ds_read_b128 v[60:63], v235 offset:19456
    v_accvgpr_read_b32 v126, a238
    v_mfma_f32_16x16x32_bf16 a[244:247], v[100:103], a[120:123], a[244:247]
    v_accvgpr_read_b32 v127, a239
    v_mfma_f32_16x16x32_bf16 a[248:251], v[104:107], a[120:123], a[248:251]
    v_mfma_f32_16x16x32_bf16 a[252:255], v[108:111], a[120:123], a[252:255]
    v_mfma_f32_16x16x32_bf16 a[252:255], v[140:143], a[124:127], a[252:255]
    v_mfma_f32_16x16x32_bf16 a[248:251], v[136:139], a[124:127], a[248:251]
    v_mfma_f32_16x16x32_bf16 a[244:247], v[132:135], a[124:127], a[244:247]
    v_mfma_f32_16x16x32_bf16 a[240:243], v[128:131], a[124:127], a[240:243]
    s_waitcnt lgkmcnt(0)
    v_pk_add_f32 v[176:177], v[176:177], v[0:1]
    v_pk_add_f32 v[178:179], v[178:179], v[2:3]
    v_pk_add_f32 v[112:113], v[112:113], v[32:33]
    v_pk_add_f32 v[114:115], v[114:115], v[34:35]
    v_pk_add_f32 v[112:113], v[112:113], v[176:177]
    v_pk_add_f32 v[114:115], v[114:115], v[178:179]
    v_pk_fma_f32 v[112:113], v[112:113], v[244:245], v[144:145] op_sel_hi:[1,0,1]
    v_pk_fma_f32 v[114:115], v[114:115], v[244:245], v[146:147] op_sel_hi:[1,0,1]
    v_cvt_pk_bf16_f32 v128, v112, v113
    v_cvt_pk_bf16_f32 v129, v114, v115
    v_pk_add_f32 v[180:181], v[180:181], v[4:5]
    v_pk_add_f32 v[182:183], v[182:183], v[6:7]
    v_pk_add_f32 v[116:117], v[116:117], v[36:37]
    v_pk_add_f32 v[118:119], v[118:119], v[38:39]
    v_pk_add_f32 v[116:117], v[116:117], v[180:181]
    v_pk_add_f32 v[118:119], v[118:119], v[182:183]
    v_pk_fma_f32 v[116:117], v[116:117], v[244:245], v[148:149] op_sel_hi:[1,0,1]
    v_pk_fma_f32 v[118:119], v[118:119], v[244:245], v[150:151] op_sel_hi:[1,0,1]
    v_cvt_pk_bf16_f32 v130, v116, v117
    v_cvt_pk_bf16_f32 v131, v118, v119
    s_nop 1
    v_permlane16_swap_b32 v128, v130
    v_permlane16_swap_b32 v129, v131
    buffer_store_dwordx4 v[128:131], v239, s[24:27], 0 offen offset:0 sc1
    v_accvgpr_read_b32 v80, a240
    v_accvgpr_read_b32 v81, a241
    v_accvgpr_read_b32 v82, a242
    v_accvgpr_read_b32 v83, a243
    v_accvgpr_read_b32 v84, a244
    v_accvgpr_read_b32 v85, a245
    v_accvgpr_read_b32 v86, a246
    v_accvgpr_read_b32 v87, a247
    v_accvgpr_read_b32 v88, a248
    v_accvgpr_read_b32 v89, a249
    v_accvgpr_read_b32 v90, a250
    v_accvgpr_read_b32 v91, a251
    v_accvgpr_read_b32 v92, a252
    v_accvgpr_read_b32 v93, a253
    v_accvgpr_read_b32 v94, a254
    v_accvgpr_read_b32 v95, a255
    v_pk_add_f32 v[184:185], v[184:185], v[8:9]
    v_pk_add_f32 v[186:187], v[186:187], v[10:11]
    v_pk_add_f32 v[120:121], v[120:121], v[40:41]
    v_pk_add_f32 v[122:123], v[122:123], v[42:43]
    v_pk_add_f32 v[120:121], v[120:121], v[184:185]
    v_pk_add_f32 v[122:123], v[122:123], v[186:187]
    v_pk_fma_f32 v[120:121], v[120:121], v[244:245], v[152:153] op_sel_hi:[1,0,1]
    v_pk_fma_f32 v[122:123], v[122:123], v[244:245], v[154:155] op_sel_hi:[1,0,1]
    v_cvt_pk_bf16_f32 v132, v120, v121
    v_cvt_pk_bf16_f32 v133, v122, v123
    v_pk_add_f32 v[188:189], v[188:189], v[12:13]
    v_pk_add_f32 v[190:191], v[190:191], v[14:15]
    v_pk_add_f32 v[124:125], v[124:125], v[44:45]
    v_pk_add_f32 v[126:127], v[126:127], v[46:47]
    v_pk_add_f32 v[124:125], v[124:125], v[188:189]
    v_pk_add_f32 v[126:127], v[126:127], v[190:191]
    v_pk_fma_f32 v[124:125], v[124:125], v[244:245], v[156:157] op_sel_hi:[1,0,1]
    v_pk_fma_f32 v[126:127], v[126:127], v[244:245], v[158:159] op_sel_hi:[1,0,1]
    v_cvt_pk_bf16_f32 v134, v124, v125
    v_cvt_pk_bf16_f32 v135, v126, v127
    s_nop 1
    v_permlane16_swap_b32 v132, v134
    v_permlane16_swap_b32 v133, v135
    buffer_store_dwordx4 v[132:135], v239, s[24:27], 0 offen offset:64 sc1
    v_pk_add_f32 v[192:193], v[192:193], v[16:17]
    v_pk_add_f32 v[194:195], v[194:195], v[18:19]
    v_pk_add_f32 v[80:81], v[80:81], v[48:49]
    v_pk_add_f32 v[82:83], v[82:83], v[50:51]
    v_pk_add_f32 v[80:81], v[80:81], v[192:193]
    v_pk_add_f32 v[82:83], v[82:83], v[194:195]
    v_pk_fma_f32 v[80:81], v[80:81], v[244:245], v[160:161] op_sel:[0,1,0]
    v_pk_fma_f32 v[82:83], v[82:83], v[244:245], v[162:163] op_sel:[0,1,0]
    v_cvt_pk_bf16_f32 v136, v80, v81
    v_cvt_pk_bf16_f32 v137, v82, v83
    v_pk_add_f32 v[196:197], v[196:197], v[20:21]
    v_pk_add_f32 v[198:199], v[198:199], v[22:23]
    v_pk_add_f32 v[84:85], v[84:85], v[52:53]
    v_pk_add_f32 v[86:87], v[86:87], v[54:55]
    v_pk_add_f32 v[84:85], v[84:85], v[196:197]
    v_pk_add_f32 v[86:87], v[86:87], v[198:199]
    v_pk_fma_f32 v[84:85], v[84:85], v[244:245], v[164:165] op_sel:[0,1,0]
    v_pk_fma_f32 v[86:87], v[86:87], v[244:245], v[166:167] op_sel:[0,1,0]
    v_cvt_pk_bf16_f32 v138, v84, v85
    v_cvt_pk_bf16_f32 v139, v86, v87
    s_nop 1
    v_permlane16_swap_b32 v136, v138
    v_permlane16_swap_b32 v137, v139
    buffer_store_dwordx4 v[136:139], v239, s[24:27], s58 offen offset:0 sc1
    v_pk_add_f32 v[200:201], v[200:201], v[24:25]
    v_pk_add_f32 v[202:203], v[202:203], v[26:27]
    v_pk_add_f32 v[88:89], v[88:89], v[56:57]
    v_pk_add_f32 v[90:91], v[90:91], v[58:59]
    v_pk_add_f32 v[88:89], v[88:89], v[200:201]
    v_pk_add_f32 v[90:91], v[90:91], v[202:203]
    v_pk_fma_f32 v[88:89], v[88:89], v[244:245], v[168:169] op_sel:[0,1,0]
    v_pk_fma_f32 v[90:91], v[90:91], v[244:245], v[170:171] op_sel:[0,1,0]
    v_cvt_pk_bf16_f32 v140, v88, v89
    v_cvt_pk_bf16_f32 v141, v90, v91
    v_pk_add_f32 v[204:205], v[204:205], v[28:29]
    v_pk_add_f32 v[206:207], v[206:207], v[30:31]
    v_pk_add_f32 v[92:93], v[92:93], v[60:61]
    v_pk_add_f32 v[94:95], v[94:95], v[62:63]
    v_pk_add_f32 v[92:93], v[92:93], v[204:205]
    v_pk_add_f32 v[94:95], v[94:95], v[206:207]
    v_pk_fma_f32 v[92:93], v[92:93], v[244:245], v[172:173] op_sel:[0,1,0]
    v_pk_fma_f32 v[94:95], v[94:95], v[244:245], v[174:175] op_sel:[0,1,0]
    v_cvt_pk_bf16_f32 v142, v92, v93
    v_cvt_pk_bf16_f32 v143, v94, v95
    s_nop 1
    v_permlane16_swap_b32 v140, v142
    v_permlane16_swap_b32 v141, v143
    buffer_store_dwordx4 v[140:143], v239, s[24:27], s58 offen offset:64 sc1
L_end:
    s_endpgm
L_at_slow:
    s_lshl_b32 s57, s100, 18
    s_add_u32 s57, s57, 8388608
    v_mov_b32 v48, 0xff800000
    v_mov_b32 v64, 0xff800000
    v_mov_b32 v80, 0
    v_mov_b32 v81, 0
    v_mov_b32 v82, 0
    v_mov_b32 v83, 0
    v_mov_b32 v84, 0
    v_mov_b32 v85, 0
    v_mov_b32 v86, 0
    v_mov_b32 v87, 0
    v_mov_b32 v88, 0
    v_mov_b32 v89, 0
    v_mov_b32 v90, 0
    v_mov_b32 v91, 0
    v_mov_b32 v92, 0
    v_mov_b32 v93, 0
    v_mov_b32 v94, 0
    v_mov_b32 v95, 0
    v_mov_b32 v96, 0
    v_mov_b32 v97, 0
    v_mov_b32 v98, 0
    v_mov_b32 v99, 0
    v_mov_b32 v100, 0
    v_mov_b32 v101, 0
    v_mov_b32 v102, 0
    v_mov_b32 v103, 0
    v_mov_b32 v104, 0
    v_mov_b32 v105, 0
    v_mov_b32 v106, 0
    v_mov_b32 v107, 0
    v_mov_b32 v108, 0
    v_mov_b32 v109, 0
    v_mov_b32 v110, 0
    v_mov_b32 v111, 0
    v_mov_b32 v112, 0
    v_mov_b32 v113, 0
    v_mov_b32 v114, 0
    v_mov_b32 v115, 0
    v_mov_b32 v116, 0
    v_mov_b32 v117, 0
    v_mov_b32 v118, 0
    v_mov_b32 v119, 0
    s_mov_b32 s96, 0
L_at_sloop:
    buffer_load_dwordx4 v[152:155], v251, s[8:11], s57 offen sc1
    buffer_load_dwordx4 v[156:159], v251, s[8:11], s57 offen offset:1024 sc1
    buffer_load_dwordx4 v[168:171], v251, s[8:11], s57 offen offset:2048 sc1
    buffer_load_dwordx4 v[172:175], v251, s[8:11], s57 offen offset:3072 sc1
    s_waitcnt vmcnt(0)
    v_mfma_f32_32x32x16_bf16 v[16:31], v[152:155], v[0:3], 0
    v_mfma_f32_32x32x16_bf16 v[16:31], v[156:159], v[4:7], v[16:31]
    s_nop 15
    v_max3_f32 v232, v16, v17, v18
    v_max3_f32 v232, v232, v19, v20
    v_max3_f32 v232, v232, v21, v22
    v_max3_f32 v232, v232, v23, v24
    v_max3_f32 v232, v232, v25, v26
    v_max3_f32 v232, v232, v27, v28
    v_max3_f32 v232, v232, v29, v30
    v_max_f32 v232, v232, v31
    v_mov_b32 v233, v232
    s_nop 1
    v_permlane32_swap_b32 v232, v233
    v_max3_f32 v50, v232, v233, v48
    v_sub_f32 v49, v48, v50
    v_exp_f32 v49, v49
    v_mov_b32 v48, v50
    v_sub_f32 v16, v16, v50
    v_sub_f32 v17, v17, v50
    v_sub_f32 v18, v18, v50
    v_sub_f32 v19, v19, v50
    v_sub_f32 v20, v20, v50
    v_sub_f32 v21, v21, v50
    v_sub_f32 v22, v22, v50
    v_sub_f32 v23, v23, v50
    v_sub_f32 v24, v24, v50
    v_sub_f32 v25, v25, v50
    v_sub_f32 v26, v26, v50
    v_sub_f32 v27, v27, v50
    v_sub_f32 v28, v28, v50
    v_sub_f32 v29, v29, v50
    v_sub_f32 v30, v30, v50
    v_sub_f32 v31, v31, v50
    v_exp_f32 v120, v16
    v_exp_f32 v121, v17
    v_exp_f32 v122, v18
    v_exp_f32 v123, v19
    v_exp_f32 v124, v20
    v_exp_f32 v125, v21
    v_exp_f32 v126, v22
    v_exp_f32 v127, v23
    v_exp_f32 v128, v24
    v_exp_f32 v129, v25
    v_exp_f32 v130, v26
    v_exp_f32 v131, v27
    v_exp_f32 v132, v28
    v_exp_f32 v133, v29
    v_exp_f32 v134, v30
    v_exp_f32 v135, v31
    v_mul_f32 v80, v80, v49
    v_mul_f32 v81, v81, v49
    v_mul_f32 v82, v82, v49
    v_mul_f32 v83, v83, v49
    v_mul_f32 v84, v84, v49
    v_mul_f32 v85, v85, v49
    v_mul_f32 v86, v86, v49
    v_mul_f32 v87, v87, v49
    v_mul_f32 v88, v88, v49
    v_mul_f32 v89, v89, v49
    v_mul_f32 v90, v90, v49
    v_mul_f32 v91, v91, v49
    v_mul_f32 v92, v92, v49
    v_mul_f32 v93, v93, v49
    v_mul_f32 v94, v94, v49
    v_mul_f32 v95, v95, v49
    v_mul_f32 v112, v112, v49
    s_nop 1
    v_smfmac_f32_16x16x64_bf16 v[112:115], v[184:187], v[120:127], v221
    v_smfmac_f32_16x16x64_bf16 v[112:115], v[184:187], v[128:135], v221
    v_smfmac_f32_32x32x32_bf16 v[80:95], v[168:171], v[120:127], v221
    v_smfmac_f32_32x32x32_bf16 v[80:95], v[172:175], v[128:135], v221
    s_nop 15
    v_mfma_f32_32x32x16_bf16 v[32:47], v[152:155], v[8:11], 0
    v_mfma_f32_32x32x16_bf16 v[32:47], v[156:159], v[12:15], v[32:47]
    s_nop 15
    v_max3_f32 v232, v32, v33, v34
    v_max3_f32 v232, v232, v35, v36
    v_max3_f32 v232, v232, v37, v38
    v_max3_f32 v232, v232, v39, v40
    v_max3_f32 v232, v232, v41, v42
    v_max3_f32 v232, v232, v43, v44
    v_max3_f32 v232, v232, v45, v46
    v_max_f32 v232, v232, v47
    v_mov_b32 v233, v232
    s_nop 1
    v_permlane32_swap_b32 v232, v233
    v_max3_f32 v66, v232, v233, v64
    v_sub_f32 v65, v64, v66
    v_exp_f32 v65, v65
    v_mov_b32 v64, v66
    v_sub_f32 v32, v32, v66
    v_sub_f32 v33, v33, v66
    v_sub_f32 v34, v34, v66
    v_sub_f32 v35, v35, v66
    v_sub_f32 v36, v36, v66
    v_sub_f32 v37, v37, v66
    v_sub_f32 v38, v38, v66
    v_sub_f32 v39, v39, v66
    v_sub_f32 v40, v40, v66
    v_sub_f32 v41, v41, v66
    v_sub_f32 v42, v42, v66
    v_sub_f32 v43, v43, v66
    v_sub_f32 v44, v44, v66
    v_sub_f32 v45, v45, v66
    v_sub_f32 v46, v46, v66
    v_sub_f32 v47, v47, v66
    v_exp_f32 v136, v32
    v_exp_f32 v137, v33
    v_exp_f32 v138, v34
    v_exp_f32 v139, v35
    v_exp_f32 v140, v36
    v_exp_f32 v141, v37
    v_exp_f32 v142, v38
    v_exp_f32 v143, v39
    v_exp_f32 v144, v40
    v_exp_f32 v145, v41
    v_exp_f32 v146, v42
    v_exp_f32 v147, v43
    v_exp_f32 v148, v44
    v_exp_f32 v149, v45
    v_exp_f32 v150, v46
    v_exp_f32 v151, v47
    v_mul_f32 v96, v96, v65
    v_mul_f32 v97, v97, v65
    v_mul_f32 v98, v98, v65
    v_mul_f32 v99, v99, v65
    v_mul_f32 v100, v100, v65
    v_mul_f32 v101, v101, v65
    v_mul_f32 v102, v102, v65
    v_mul_f32 v103, v103, v65
    v_mul_f32 v104, v104, v65
    v_mul_f32 v105, v105, v65
    v_mul_f32 v106, v106, v65
    v_mul_f32 v107, v107, v65
    v_mul_f32 v108, v108, v65
    v_mul_f32 v109, v109, v65
    v_mul_f32 v110, v110, v65
    v_mul_f32 v111, v111, v65
    v_mul_f32 v116, v116, v65
    s_nop 1
    v_smfmac_f32_16x16x64_bf16 v[116:119], v[184:187], v[136:143], v221
    v_smfmac_f32_16x16x64_bf16 v[116:119], v[184:187], v[144:151], v221
    v_smfmac_f32_32x32x32_bf16 v[96:111], v[168:171], v[136:143], v221
    v_smfmac_f32_32x32x32_bf16 v[96:111], v[172:175], v[144:151], v221
    s_nop 15
    s_add_u32 s57, s57, 4096
    s_add_u32 s96, s96, 1
    s_cmp_lt_u32 s96, 64
    s_cbranch_scc1 L_at_sloop
    s_branch L_at_fin
L_hk5_ffn:
    s_cmp_lg_u32 s47, 5
    s_cbranch_scc1 L_hk4_ffn
    v_mfma_f32_32x32x16_bf16 a[128:143], a[176:179], a[176:179], 0
    v_mfma_f32_32x32x16_bf16 a[144:159], a[176:179], a[176:179], 0
    v_mfma_f32_32x32x16_bf16 a[160:175], a[176:179], a[176:179], 0
    s_mov_b32 s57, 0
    s_branch L_pc1
L_pl1:
    buffer_load_dwordx2 v[254:255], off, s[88:91], 0  sc1
    s_waitcnt vmcnt(0)
L_pc1:
    v_cmp_eq_u64 vcc, 0, v[254:255]
    s_add_u32 s57, s57, 1
    s_nop 0
    s_cbranch_vccz L_pd1
    s_sleep 6
    s_cmp_lt_u32 s57, 0x40000
    s_cbranch_scc1 L_pl1
L_pd1:
    v_readfirstlane_b32 s6, v254
    v_readfirstlane_b32 s7, v255
    s_lshl_b32 s52, s2, 5
    s_add_u32 s52, s52, 8192
    s_cmp_lg_u32 s40, 0
    s_cbranch_scc1 L_pb2
    v_mov_b32 v238, s6
    v_mov_b32 v239, s7
    buffer_store_dwordx2 v[238:239], off, s[8:11], s52 sc1
L_pb2:
    s_branch L_g1_ffn_loop
L_hk4_ffn:
    s_cmp_lg_u32 s47, 4
    s_cbranch_scc1 L_hk3_ffn
    s_lshl_b32 s52, s50, 5
    v_add_u32 v238, s52, v250
    s_and_b32 s52, s2, 0xc7
    v_and_b32 v239, 7, v250
    v_lshl_add_u32 v239, v239, 3, s52
    v_cmp_gt_u32 vcc, 32, v250
    s_nop 1
    v_cndmask_b32 v239, v239, v238, vcc
    v_lshlrev_b32 v239, 5, v239
    v_add_u32 v239, 8192, v239
    buffer_load_dwordx2 v[254:255], v239, s[8:11], 0 offen sc1
    s_branch L_g1_ffn_loop
L_hk3_ffn:
    s_cmp_eq_u32 s47, 3
    s_cbranch_scc1 L_hk3b_ffn
    s_add_u32 s24, s32, 0
    s_addc_u32 s25, s33, 0
    s_mov_b32 s26, 2097152
    s_mov_b32 s27, 0x00020000
    s_and_b32 s58, s58, 1048575
    s_getpc_b64 s[52:53]
L_pc_3:
    s_sub_u32 s52, s52, L_pc_3-parallel_sum__softmax_full_mha__dense_activation_relu__prompt_kernel
    s_subb_u32 s53, s53, 0
    s_lshl_b32 s54, s42, 2
    s_add_u32 s54, s54, s40
    s_and_b32 s54, s54, 63
    s_lshl_b32 s54, s54, 10
    v_add_u32 v254, s54, v251
    v_min_u32 v254, L_code_end-parallel_sum__softmax_full_mha__dense_activation_relu__prompt_kernel-16, v254
    v_mov_b32 v255, s53
    v_add_co_u32 v254, vcc, s52, v254
    s_nop 1
    v_addc_co_u32 v255, vcc, 0, v255, vcc
    global_load_dwordx4 a[120:123], v[254:255], off
    s_branch L_g1_ffn_loop
L_hk3b_ffn:
    s_mov_b32 s57, 0
    s_branch L_pc4
L_pl4:
    buffer_load_dwordx2 v[254:255], v239, s[8:11], 0 offen sc1
    s_waitcnt vmcnt(0)
L_pc4:
    v_cmp_ne_u64 vcc, s[6:7], v[254:255]
    s_add_u32 s57, s57, 1
    s_nop 0
    s_cbranch_vccz L_pd4
    s_sleep 6
    s_cmp_lt_u32 s57, 0x40000
    s_cbranch_scc1 L_pl4
L_pd4:
    s_lshl_b32 s52, s40, 8
    v_lshl_add_u32 v238, v250, 2, s52
    s_lshl_b32 s52, s101, 13
    s_add_u32 s52, s52, 65536
    s_add_u32 s53, s52, 4096
    buffer_load_dword v240, v238, s[8:11], s52 offen offset:0 sc1
    buffer_load_dword v241, v238, s[8:11], s52 offen offset:1024 sc1
    buffer_load_dword v242, v238, s[8:11], s52 offen offset:2048 sc1
    buffer_load_dword v243, v238, s[8:11], s52 offen offset:3072 sc1
    buffer_load_dword v244, v238, s[8:11], s53 offen offset:0 sc1
    buffer_load_dword v245, v238, s[8:11], s53 offen offset:1024 sc1
    buffer_load_dword v246, v238, s[8:11], s53 offen offset:2048 sc1
    buffer_load_dword v247, v238, s[8:11], s53 offen offset:3072 sc1
    s_lshl_b32 s52, s50, 10
    s_add_u32 s52, s52, 16384
    s_add_u32 s53, s52, 8192
    buffer_load_dword v248, v238, s[8:11], s52 offen sc1
    buffer_load_dword v249, v238, s[8:11], s53 offen sc1
    s_branch L_g1_ffn_loop
L_hk5_qkv:
    s_cmp_lg_u32 s47, 5
    s_cbranch_scc1 L_hk4_qkv
    v_mfma_f32_32x32x16_bf16 a[128:143], a[176:179], a[176:179], 0
    v_mfma_f32_32x32x16_bf16 a[144:159], a[176:179], a[176:179], 0
    v_mfma_f32_32x32x16_bf16 a[160:175], a[176:179], a[176:179], 0
    s_mov_b32 s57, 0
    s_branch L_pc8
L_pl8:
    buffer_load_dwordx2 v[254:255], off, s[88:91], 0  sc1
    s_waitcnt vmcnt(0)
L_pc8:
    v_cmp_eq_u64 vcc, 0, v[254:255]
    s_add_u32 s57, s57, 1
    s_nop 0
    s_cbranch_vccz L_pd8
    s_sleep 6
    s_cmp_lt_u32 s57, 0x40000
    s_cbranch_scc1 L_pl8
L_pd8:
    v_readfirstlane_b32 s6, v254
    v_readfirstlane_b32 s7, v255
    s_lshl_b32 s52, s2, 5
    s_add_u32 s52, s52, 8192
    s_cmp_lg_u32 s40, 0
    s_cbranch_scc1 L_pb9
    v_mov_b32 v238, s6
    v_mov_b32 v239, s7
    buffer_store_dwordx2 v[238:239], off, s[8:11], s52 sc1
L_pb9:
    s_branch L_g1_qkv_loop
L_hk4_qkv:
    s_cmp_lg_u32 s47, 4
    s_cbranch_scc1 L_hk3_qkv
    s_lshl_b32 s52, s50, 5
    v_add_u32 v238, s52, v250
    s_and_b32 s52, s2, 0xc7
    v_and_b32 v239, 7, v250
    v_lshl_add_u32 v239, v239, 3, s52
    v_cmp_gt_u32 vcc, 32, v250
    s_nop 1
    v_cndmask_b32 v239, v239, v238, vcc
    v_lshlrev_b32 v239, 5, v239
    v_add_u32 v239, 8192, v239
    buffer_load_dwordx2 v[254:255], v239, s[8:11], 0 offen sc1
    s_branch L_g1_qkv_loop
L_hk3_qkv:
    s_cmp_eq_u32 s47, 3
    s_cbranch_scc1 L_hk3b_qkv
    s_add_u32 s24, s32, 0
    s_addc_u32 s25, s33, 0
    s_mov_b32 s26, 2097152
    s_mov_b32 s27, 0x00020000
    s_and_b32 s58, s58, 1048575
    s_getpc_b64 s[52:53]
L_pc_10:
    s_sub_u32 s52, s52, L_pc_10-parallel_sum__softmax_full_mha__dense_activation_relu__prompt_kernel
    s_subb_u32 s53, s53, 0
    s_lshl_b32 s54, s42, 2
    s_add_u32 s54, s54, s40
    s_and_b32 s54, s54, 63
    s_lshl_b32 s54, s54, 10
    v_add_u32 v254, s54, v251
    v_min_u32 v254, L_code_end-parallel_sum__softmax_full_mha__dense_activation_relu__prompt_kernel-16, v254
    v_mov_b32 v255, s53
    v_add_co_u32 v254, vcc, s52, v254
    s_nop 1
    v_addc_co_u32 v255, vcc, 0, v255, vcc
    global_load_dwordx4 a[120:123], v[254:255], off
    s_branch L_g1_qkv_loop
L_hk3b_qkv:
    s_mov_b32 s57, 0
    s_branch L_pc11
L_pl11:
    buffer_load_dwordx2 v[254:255], v239, s[8:11], 0 offen sc1
    s_waitcnt vmcnt(0)
L_pc11:
    v_cmp_ne_u64 vcc, s[6:7], v[254:255]
    s_add_u32 s57, s57, 1
    s_nop 0
    s_cbranch_vccz L_pd11
    s_sleep 6
    s_cmp_lt_u32 s57, 0x40000
    s_cbranch_scc1 L_pl11
L_pd11:
    s_lshl_b32 s52, s40, 8
    v_lshl_add_u32 v238, v250, 2, s52
    s_lshl_b32 s52, s101, 13
    s_add_u32 s52, s52, 65536
    s_add_u32 s53, s52, 4096
    buffer_load_dword v240, v238, s[8:11], s52 offen offset:0 sc1
    buffer_load_dword v241, v238, s[8:11], s52 offen offset:1024 sc1
    buffer_load_dword v242, v238, s[8:11], s52 offen offset:2048 sc1
    buffer_load_dword v243, v238, s[8:11], s52 offen offset:3072 sc1
    buffer_load_dword v244, v238, s[8:11], s53 offen offset:0 sc1
    buffer_load_dword v245, v238, s[8:11], s53 offen offset:1024 sc1
    buffer_load_dword v246, v238, s[8:11], s53 offen offset:2048 sc1
    buffer_load_dword v247, v238, s[8:11], s53 offen offset:3072 sc1
    s_lshl_b32 s52, s50, 10
    s_add_u32 s52, s52, 16384
    s_add_u32 s53, s52, 8192
    buffer_load_dword v248, v238, s[8:11], s52 offen sc1
    buffer_load_dword v249, v238, s[8:11], s53 offen sc1
    s_branch L_g1_qkv_loop
L_cb_sw:
    v_mov_b32 v240, v224
    v_mov_b32 v241, v225
    v_mov_b32 v242, v226
    v_mov_b32 v243, v227
    s_add_u32 s16, s32, 0
    s_addc_u32 s17, s33, 0
    s_mov_b32 s18, 2097152
    s_mov_b32 s19, 0x00020000
    s_lshl_b32 s94, s40, 19
    s_mov_b32 s3, 65536
    s_mov_b32 s47, -1
    s_branch L_cb_loop
.p2align 4
L_code_end:
.section .rodata,"a"
.p2align 6
.amdhsa_kernel parallel_sum__softmax_full_mha__dense_activation_relu__prompt_kernel
  .amdhsa_next_free_vgpr 512
  .amdhsa_next_free_sgpr 102
  .amdhsa_accum_offset 256
  .amdhsa_group_segment_fixed_size 0
  .amdhsa_kernarg_size 72
  .amdhsa_user_sgpr_count 2
  .amdhsa_user_sgpr_kernarg_segment_ptr 1
  .amdhsa_system_sgpr_workgroup_id_x 1
.end_amdhsa_kernel
```
